```python
import torch

def _softmax(x, axis=-1):
    return torch.softmax(x, dim=axis)

def _gelu(x):
    return torch.nn.functional.gelu(x, approximate='tanh')

def _silu(x):
    return torch.nn.functional.silu(x)

def _sigmoid(x):
    return torch.sigmoid(x)

def _layernorm(x, axis=-1, eps=1e-05):
    m = x.mean(dim=axis, keepdim=True)
    v = x.var(dim=axis, keepdim=True, unbiased=False)
    return (x - m) / torch.sqrt(v + eps)

def _scatter_add(tgt, idx, src, axis=0):
    return tgt.clone().index_add_(axis, idx, src)

def _segment_sum(src, seg, n):
    out = torch.zeros((n,) + src.shape[1:], dtype=src.dtype)
    return out.index_add_(0, seg, src)

def _pad(x, pw):
    flat = tuple((v for pair in reversed(pw) for v in pair))
    return torch.nn.functional.pad(x, flat)
kernel_name = 'adaLN_cond__spectral_fnet__mixer_gmlp__prompt'

def setup_inputs():

    _w = lambda a: (lambda t: t.to(torch.bfloat16) if t.is_floating_point() else t)(torch.as_tensor(a))

    def _A_setup():
        B, S, D = (1, 2048, 640)
        ns = torch.arange(S)[:, None] * torch.arange(S)[None, :]
        nd = torch.arange(D)[:, None] * torch.arange(D)[None, :]
        Ws_re = torch.cos(-2.0 * torch.pi * ns / S).to(float)
        Ws_im = torch.sin(-2.0 * torch.pi * ns / S).to(float)
        Wd_re = torch.cos(-2.0 * torch.pi * nd / D).to(float)
        Wd_im = torch.sin(-2.0 * torch.pi * nd / D).to(float)
        return {'x': _w((lambda *s: torch.randn(*s, dtype=torch.bfloat16) * 0.1)(B, S, D)), 'dft_seq_re': _w(Ws_re), 'dft_seq_im': _w(Ws_im), 'dft_hid_re': _w(Wd_re), 'dft_hid_im': _w(Wd_im)}
    _A_in = _A_setup()

    def _B_setup():
        B, S, D, F = (1, 2048, 640, 1728)
        Fh = F // 2
        return {'x': _w((lambda *s: torch.randn(*s, dtype=torch.bfloat16) * 0.1)(B, S, D)), 'w_in': _w((lambda *s: torch.randn(*s, dtype=torch.bfloat16) * 3.2)(D, 2 * Fh)), 'w_sp': _w(0.01 * (lambda *s: torch.randn(*s, dtype=torch.bfloat16) * 3.2)(S, S)), 'b_sp': _w(1.0 + 0.01 * (lambda *s: torch.randn(*s, dtype=torch.bfloat16) * 1.6)(S)), 'w_out': _w((lambda *s: torch.randn(*s, dtype=torch.bfloat16) * 1.6)(Fh, D))}
    _B_in = _B_setup()
    return {'A_x': _A_in['x'], 'A_dft_seq_re': _A_in['dft_seq_re'], 'A_dft_seq_im': _A_in['dft_seq_im'], 'A_dft_hid_re': _A_in['dft_hid_re'], 'A_dft_hid_im': _A_in['dft_hid_im'], 'B_x': _B_in['x'], 'B_w_in': _B_in['w_in'], 'B_w_sp': _B_in['w_sp'], 'B_b_sp': _B_in['b_sp'], 'B_w_out': _B_in['w_out'], 'c': _w((lambda *s: torch.randn(*s, dtype=torch.bfloat16) * 0.2)(1, 640) * 8.0), 'w_mod': _w((lambda *s: torch.randn(*s, dtype=torch.bfloat16) * 0.2)(640, 6 * 640) * 640 ** (-0.5) * 8.0)}

def reference(A_x, A_dft_seq_re, A_dft_seq_im, A_dft_hid_re, A_dft_hid_im, B_x, B_w_in, B_w_sp, B_b_sp, B_w_out, c, w_mod):

    def _A_ref(x, dft_seq_re, dft_seq_im, dft_hid_re, dft_hid_im):
        a = torch.einsum('bsd,ed->bse', x, dft_hid_re)
        b = torch.einsum('bsd,ed->bse', x, dft_hid_im)
        y = torch.einsum('ts,bse->bte', dft_seq_re, a) - torch.einsum('ts,bse->bte', dft_seq_im, b)
        return y

    def _B_ref(x, w_in, w_sp, b_sp, w_out):
        B, S, D = x.shape
        F = w_in.shape[-1]
        Fh = F // 2
        z = _gelu(torch.einsum('bsd,df->bsf', x, w_in))
        z1 = z[..., :Fh].clone()
        z2 = _layernorm(z[..., Fh:], axis=-1)
        g = torch.einsum('ts,bsf->btf', w_sp, z2) + b_sp[None, :, None]
        return torch.einsum('bsf,fd->bsd', z1 * g, w_out)
    x = A_x
    mod = (_silu(c) @ w_mod).reshape(c.shape[0], 6, 1, -1)
    sa, ca, ga, sb, cb, gb = (mod[:, 0].clone(), mod[:, 1].clone(), mod[:, 2].clone(), mod[:, 3].clone(), mod[:, 4].clone(), mod[:, 5].clone())
    h = _layernorm(x, axis=-1) * (1 + ca) + sa
    x = x + ga * _A_ref(h, A_dft_seq_re, A_dft_seq_im, A_dft_hid_re, A_dft_hid_im)
    h = _layernorm(x, axis=-1) * (1 + cb) + sb
    x = x + gb * _B_ref(h, B_w_in, B_w_sp, B_b_sp, B_w_out)
    return x
```

```asm
; @launch kernel=kg_kernel grid=(256,1,1) block=(256,1,1) lds=159744
.amdgcn_target "amdgcn-amd-amdhsa--gfx950"
.text
.p2align 8
.type kg_kernel,@function
kg_kernel:
  s_cmp_ge_u32 s2, 256
  s_cbranch_scc1 kg_done
  s_load_dwordx2 s[4:5], s[0:1], 112
  s_mov_b32 s6, 27754496
  s_mov_b32 s7, 0x20000
  s_load_dwordx2 s[16:17], s[0:1], 0
  s_mov_b32 s18, 2621440
  s_mov_b32 s19, 0x20000
  s_cmp_ge_u32 s2, 16
  s_cbranch_scc1 kg_nosf
  s_getpc_b64 s[12:13]
kg_kernel_pc1:
  s_add_u32 s12, s12, kg_nosf-kg_kernel_pc1
  s_addc_u32 s13, s13, 0
  s_mov_b32 s14, pa_done-kg_nosf
  s_mov_b32 s15, 0x20000
  v_lshlrev_b32 v1, 6, v0
  buffer_load_dword a156, v1, s[12:15], 0 offen
kg_nosf:
  s_getpc_b64 s[12:13]
kg_kernel_pc2:
  s_add_u32 s12, s12, ctab-kg_kernel_pc2
  s_addc_u32 s13, s13, 0
  s_mov_b32 s14, 24576
  s_mov_b32 s15, 0x20000
  v_readfirstlane_b32 s20, v0
  v_and_b32 v1, 63, v0
  v_lshlrev_b32 v2, 4, v1
  s_and_b32 s27, s2, 3
  s_bfe_u32 s28, s2, 0x20003
  s_lshl2_add_u32 s29, s27, s28
  s_bfe_u32 s26, s2, 0x10002
  s_lshr_b32 s25, s2, 5
  s_lshl1_add_u32 s23, s25, s26
  s_lshr_b32 s20, s20, 6
  s_lshl2_add_u32 s22, s29, s20
  s_lshl_b32 s21, s20, 10
  s_sub_u32 s27, s2, 8
  s_mov_b32 s24, -1
  s_cmp_ge_u32 s27, 160
  s_cbranch_scc1 pa_other
  s_lshr_b32 s28, s27, 3
  s_and_b32 s31, s27, 7
  s_and_b32 s29, s28, 3
  s_lshl3_add_u32 s31, s29, s31
  s_lshr_b32 s32, s28, 2
  v_and_b32 v18, 15, v0
  v_lshrrev_b32 v19, 4, v0
  s_mul_i32 s28, s31, 1280
  s_lshl_b32 s29, s32, 8
  v_lshl_add_u32 v20, v18, 4, s29
  v_mul_u32_u24 v4, 40960, v19
  v_add_u32 v21, v20, v4
  s_waitcnt lgkmcnt(0)
  buffer_load_dwordx4 v[36:39], v21, s[16:19], s28 offen
  v_add_u32 v22, 0xfffffc00, v20
  v_add_u32 v5, 256, v20
  v_min_u32 v22, v22, v5
  v_add_u32 v22, v22, v4
  buffer_load_dwordx4 v[40:43], v22, s[16:19], s28 offen
  v_add_u32 v23, 0xfffffd00, v20
  v_add_u32 v5, 512, v20
  v_min_u32 v23, v23, v5
  v_add_u32 v23, v23, v4
  buffer_load_dwordx4 v[44:47], v23, s[16:19], s28 offen
  v_add_u32 v24, 0xfffffe00, v20
  v_add_u32 v5, 768, v20
  v_min_u32 v24, v24, v5
  v_add_u32 v24, v24, v4
  buffer_load_dwordx4 v[48:51], v24, s[16:19], s28 offen
  v_add_u32 v25, 0xffffff00, v20
  v_add_u32 v5, 1024, v20
  v_min_u32 v25, v25, v5
  v_add_u32 v25, v25, v4
  buffer_load_dwordx4 v[52:55], v25, s[16:19], s28 offen
  s_add_u32 s33, s28, 655360
  buffer_load_dwordx4 v[56:59], v21, s[16:19], s33 offen
  buffer_load_dwordx4 v[60:63], v22, s[16:19], s33 offen
  buffer_load_dwordx4 v[64:67], v23, s[16:19], s33 offen
  buffer_load_dwordx4 v[68:71], v24, s[16:19], s33 offen
  buffer_load_dwordx4 v[72:75], v25, s[16:19], s33 offen
  s_mov_b32 s35, s27
  s_add_u32 s33, s33, 655360
  buffer_load_dwordx4 v[76:79], v21, s[16:19], s33 offen
  v_mov_b32 v132, 0x3f803f80
  v_mov_b32 v124, 0
  v_mov_b32 v125, 0
  v_mov_b32 v126, 0
  v_mov_b32 v127, 0
  v_mov_b32 v128, 0
  v_mov_b32 v129, 0
  v_mov_b32 v130, 0
  v_mov_b32 v131, 0
  v_mul_u32_u24 v189, 264, v19
  v_lshl_add_u32 v189, v18, 4, v189
  v_bfe_u32 v190, v0, 2, 4
  v_mul_u32_u24 v190, 264, v190
  v_and_b32 v4, 3, v0
  v_lshl_add_u32 v190, v4, 5, v190
  s_mul_i32 s27, s20, 4352
  buffer_load_dwordx4 v[80:83], v22, s[16:19], s33 offen
  s_add_u32 s27, s27, 16896
  v_bfe_u32 v188, v0, 4, 2
  v_mul_u32_u24 v192, 272, v18
  v_lshl_add_u32 v192, v188, 5, v192
  v_add_u32 v192, s27, v192
  v_mul_u32_u24 v193, 272, v188
  v_lshl_add_u32 v193, v18, 4, v193
  v_add_u32 v193, s27, v193
  s_and_b32 s27, s31, 7
  s_lshl_b32 s27, s27, 1
  v_xor_b32 v4, s27, v18
  v_mul_u32_u24 v191, 81920, v188
  v_lshl_add_u32 v191, v4, 4, v191
  s_and_b32 s27, s20, 1
  s_mul_i32 s27, s27, 1310720
  s_lshr_b32 s28, s20, 1
  buffer_load_dwordx4 v[84:87], v23, s[16:19], s33 offen
  s_lshl_b32 s28, s28, 13
  s_add_u32 s27, s27, s28
  s_lshl_b32 s28, s32, 14
  s_add_u32 s27, s27, s28
  s_lshl_b32 s28, s31, 8
  s_add_u32 s30, s27, s28
  s_mov_b32 s27, s35
  s_load_dwordx2 s[8:9], s[0:1], 48
  s_mov_b32 s10, 2211840
  s_mov_b32 s11, 0x20000
  s_mov_b32 s35, 0
  s_sub_u32 s28, s20, 1
  s_cmp_ge_u32 s28, 2
  s_cbranch_scc1 pa_noa
  s_lshl1_add_u32 s24, s27, s28
  s_and_b32 s32, s24, 15
  s_lshr_b32 s29, s24, 4
  s_mul_i32 s27, s32, 112
  s_lshr_b32 s28, s32, 2
  s_lshl_b32 s28, s28, 4
  s_sub_u32 s27, s27, s28
  s_mul_i32 s28, s29, 110592
  s_add_u32 s35, s27, s28
pa_noa:
  buffer_load_dwordx4 v[88:91], v24, s[16:19], s33 offen
  s_waitcnt vmcnt(13)
  v_dot2c_f32_bf16 v124, v36, v132
  v_dot2c_f32_bf16 v125, v36, v36
  v_dot2c_f32_bf16 v124, v37, v132
  v_dot2c_f32_bf16 v125, v37, v37
  v_dot2c_f32_bf16 v124, v38, v132
  v_dot2c_f32_bf16 v125, v38, v38
  v_dot2c_f32_bf16 v124, v39, v132
  v_dot2c_f32_bf16 v125, v39, v39
  s_waitcnt vmcnt(12)
  v_dot2c_f32_bf16 v124, v40, v132
  buffer_load_dwordx4 v[92:95], v25, s[16:19], s33 offen
  v_dot2c_f32_bf16 v125, v40, v40
  v_dot2c_f32_bf16 v124, v41, v132
  v_dot2c_f32_bf16 v125, v41, v41
  v_dot2c_f32_bf16 v124, v42, v132
  v_dot2c_f32_bf16 v125, v42, v42
  v_dot2c_f32_bf16 v124, v43, v132
  v_dot2c_f32_bf16 v125, v43, v43
  s_waitcnt vmcnt(12)
  v_dot2c_f32_bf16 v124, v44, v132
  v_dot2c_f32_bf16 v125, v44, v44
  s_add_u32 s33, s33, 655360
  buffer_load_dwordx4 v[96:99], v21, s[16:19], s33 offen
  v_dot2c_f32_bf16 v124, v45, v132
  v_dot2c_f32_bf16 v125, v45, v45
  v_dot2c_f32_bf16 v124, v46, v132
  v_dot2c_f32_bf16 v125, v46, v46
  v_dot2c_f32_bf16 v124, v47, v132
  v_dot2c_f32_bf16 v125, v47, v47
  s_waitcnt vmcnt(12)
  v_dot2c_f32_bf16 v124, v48, v132
  v_dot2c_f32_bf16 v125, v48, v48
  v_dot2c_f32_bf16 v124, v49, v132
  buffer_load_dwordx4 v[100:103], v22, s[16:19], s33 offen
  v_dot2c_f32_bf16 v125, v49, v49
  v_dot2c_f32_bf16 v124, v50, v132
  v_dot2c_f32_bf16 v125, v50, v50
  v_dot2c_f32_bf16 v124, v51, v132
  v_dot2c_f32_bf16 v125, v51, v51
  s_waitcnt vmcnt(12)
  v_dot2c_f32_bf16 v124, v52, v132
  v_dot2c_f32_bf16 v125, v52, v52
  v_dot2c_f32_bf16 v124, v53, v132
  v_dot2c_f32_bf16 v125, v53, v53
  buffer_load_dwordx4 v[104:107], v23, s[16:19], s33 offen
  v_dot2c_f32_bf16 v124, v54, v132
  v_dot2c_f32_bf16 v125, v54, v54
  v_dot2c_f32_bf16 v124, v55, v132
  v_dot2c_f32_bf16 v125, v55, v55
  s_waitcnt vmcnt(12)
  v_dot2c_f32_bf16 v126, v56, v132
  v_dot2c_f32_bf16 v127, v56, v56
  v_dot2c_f32_bf16 v126, v57, v132
  v_dot2c_f32_bf16 v127, v57, v57
  v_dot2c_f32_bf16 v126, v58, v132
  buffer_load_dwordx4 v[108:111], v24, s[16:19], s33 offen
  v_dot2c_f32_bf16 v127, v58, v58
  v_dot2c_f32_bf16 v126, v59, v132
  v_dot2c_f32_bf16 v127, v59, v59
  s_waitcnt vmcnt(12)
  v_dot2c_f32_bf16 v126, v60, v132
  v_dot2c_f32_bf16 v127, v60, v60
  v_dot2c_f32_bf16 v126, v61, v132
  v_dot2c_f32_bf16 v127, v61, v61
  v_dot2c_f32_bf16 v126, v62, v132
  v_dot2c_f32_bf16 v127, v62, v62
  buffer_load_dwordx4 v[112:115], v25, s[16:19], s33 offen
  v_dot2c_f32_bf16 v126, v63, v132
  v_dot2c_f32_bf16 v127, v63, v63
  s_waitcnt vmcnt(12)
  v_dot2c_f32_bf16 v126, v64, v132
  v_dot2c_f32_bf16 v127, v64, v64
  v_dot2c_f32_bf16 v126, v65, v132
  v_dot2c_f32_bf16 v127, v65, v65
  v_dot2c_f32_bf16 v126, v66, v132
  v_dot2c_f32_bf16 v127, v66, v66
  v_dot2c_f32_bf16 v126, v67, v132
  s_lshl_b32 s33, s20, 11
  s_add_u32 s33, s33, 16384
  buffer_load_dwordx4 v[116:119], v2, s[12:15], s33 offen offset:0
  v_dot2c_f32_bf16 v127, v67, v67
  s_waitcnt vmcnt(12)
  v_dot2c_f32_bf16 v126, v68, v132
  v_dot2c_f32_bf16 v127, v68, v68
  v_dot2c_f32_bf16 v126, v69, v132
  v_dot2c_f32_bf16 v127, v69, v69
  v_dot2c_f32_bf16 v126, v70, v132
  v_dot2c_f32_bf16 v127, v70, v70
  v_dot2c_f32_bf16 v126, v71, v132
  v_dot2c_f32_bf16 v127, v71, v71
  buffer_load_dwordx4 v[120:123], v2, s[12:15], s33 offen offset:1024
  s_waitcnt vmcnt(12)
  v_dot2c_f32_bf16 v126, v72, v132
  v_dot2c_f32_bf16 v127, v72, v72
  v_dot2c_f32_bf16 v126, v73, v132
  v_dot2c_f32_bf16 v127, v73, v73
  v_dot2c_f32_bf16 v126, v74, v132
  v_dot2c_f32_bf16 v127, v74, v74
  v_dot2c_f32_bf16 v126, v75, v132
  v_dot2c_f32_bf16 v127, v75, v75
  v_add_f32_dpp v124, v124, v124 row_ror:8 row_mask:0xf bank_mask:0xf
  v_add_f32_dpp v125, v125, v125 row_ror:8 row_mask:0xf bank_mask:0xf
  v_add_f32_dpp v126, v126, v126 row_ror:8 row_mask:0xf bank_mask:0xf
  v_add_f32_dpp v127, v127, v127 row_ror:8 row_mask:0xf bank_mask:0xf
  v_add_f32_dpp v124, v124, v124 row_ror:4 row_mask:0xf bank_mask:0xf
  v_add_f32_dpp v125, v125, v125 row_ror:4 row_mask:0xf bank_mask:0xf
  v_add_f32_dpp v126, v126, v126 row_ror:4 row_mask:0xf bank_mask:0xf
  v_add_f32_dpp v127, v127, v127 row_ror:4 row_mask:0xf bank_mask:0xf
  v_add_f32_dpp v124, v124, v124 row_ror:2 row_mask:0xf bank_mask:0xf
  v_add_f32_dpp v125, v125, v125 row_ror:2 row_mask:0xf bank_mask:0xf
  v_add_f32_dpp v126, v126, v126 row_ror:2 row_mask:0xf bank_mask:0xf
  v_add_f32_dpp v127, v127, v127 row_ror:2 row_mask:0xf bank_mask:0xf
  v_add_f32_dpp v124, v124, v124 row_ror:1 row_mask:0xf bank_mask:0xf
  v_add_f32_dpp v125, v125, v125 row_ror:1 row_mask:0xf bank_mask:0xf
  v_add_f32_dpp v126, v126, v126 row_ror:1 row_mask:0xf bank_mask:0xf
  v_add_f32_dpp v127, v127, v127 row_ror:1 row_mask:0xf bank_mask:0xf
  v_mul_f32 v124, 0xbacccccd, v124
  v_mul_f32 v125, 0x3acccccd, v125
  v_mul_f32 v126, 0xbacccccd, v126
  v_mul_f32 v127, 0x3acccccd, v127
  v_fma_f32 v125, -v124, v124, v125
  v_fma_f32 v127, -v126, v126, v127
  v_max_f32 v125, 0, v125
  v_max_f32 v127, 0, v127
  v_add_f32 v125, 0x3727c5ac, v125
  v_add_f32 v127, 0x3727c5ac, v127
  v_rsq_f32 v125, v125
  v_rsq_f32 v127, v127
  v_mul_f32 v124, v124, v125
  v_mul_f32 v126, v126, v127
  v_lshlrev_b32 v133, 16, v36
  v_and_b32 v134, 0xffff0000, v36
  v_fma_f32 v133, v133, v125, v124
  v_fma_f32 v134, v134, v125, v124
  v_cvt_pk_bf16_f32 v36, v133, v134
  v_lshlrev_b32 v135, 16, v37
  v_and_b32 v136, 0xffff0000, v37
  v_fma_f32 v135, v135, v125, v124
  v_fma_f32 v136, v136, v125, v124
  v_cvt_pk_bf16_f32 v37, v135, v136
  v_lshlrev_b32 v133, 16, v38
  v_and_b32 v134, 0xffff0000, v38
  v_fma_f32 v133, v133, v125, v124
  v_fma_f32 v134, v134, v125, v124
  v_cvt_pk_bf16_f32 v38, v133, v134
  v_lshlrev_b32 v135, 16, v39
  v_and_b32 v136, 0xffff0000, v39
  v_fma_f32 v135, v135, v125, v124
  v_fma_f32 v136, v136, v125, v124
  v_cvt_pk_bf16_f32 v39, v135, v136
  ds_write_b64 v189, v[36:37] offset:0
  ds_write_b64 v189, v[38:39] offset:8
  v_lshlrev_b32 v133, 16, v56
  v_and_b32 v134, 0xffff0000, v56
  v_fma_f32 v133, v133, v127, v126
  v_fma_f32 v134, v134, v127, v126
  v_cvt_pk_bf16_f32 v56, v133, v134
  v_lshlrev_b32 v135, 16, v57
  v_and_b32 v136, 0xffff0000, v57
  v_fma_f32 v135, v135, v127, v126
  v_fma_f32 v136, v136, v127, v126
  v_cvt_pk_bf16_f32 v57, v135, v136
  v_lshlrev_b32 v133, 16, v58
  v_and_b32 v134, 0xffff0000, v58
  v_fma_f32 v133, v133, v127, v126
  v_fma_f32 v134, v134, v127, v126
  v_cvt_pk_bf16_f32 v58, v133, v134
  v_lshlrev_b32 v135, 16, v59
  v_and_b32 v136, 0xffff0000, v59
  v_fma_f32 v135, v135, v127, v126
  v_fma_f32 v136, v136, v127, v126
  v_cvt_pk_bf16_f32 v59, v135, v136
  ds_write_b64 v189, v[56:57] offset:4224
  ds_write_b64 v189, v[58:59] offset:4232
  s_waitcnt vmcnt(11)
  v_dot2c_f32_bf16 v128, v76, v132
  v_dot2c_f32_bf16 v129, v76, v76
  v_dot2c_f32_bf16 v128, v77, v132
  v_dot2c_f32_bf16 v129, v77, v77
  v_dot2c_f32_bf16 v128, v78, v132
  v_dot2c_f32_bf16 v129, v78, v78
  v_dot2c_f32_bf16 v128, v79, v132
  v_dot2c_f32_bf16 v129, v79, v79
  s_waitcnt vmcnt(10)
  v_dot2c_f32_bf16 v128, v80, v132
  v_dot2c_f32_bf16 v129, v80, v80
  v_dot2c_f32_bf16 v128, v81, v132
  v_dot2c_f32_bf16 v129, v81, v81
  v_dot2c_f32_bf16 v128, v82, v132
  v_dot2c_f32_bf16 v129, v82, v82
  v_dot2c_f32_bf16 v128, v83, v132
  v_dot2c_f32_bf16 v129, v83, v83
  s_waitcnt vmcnt(9)
  v_dot2c_f32_bf16 v128, v84, v132
  v_dot2c_f32_bf16 v129, v84, v84
  v_dot2c_f32_bf16 v128, v85, v132
  v_dot2c_f32_bf16 v129, v85, v85
  v_dot2c_f32_bf16 v128, v86, v132
  v_dot2c_f32_bf16 v129, v86, v86
  v_dot2c_f32_bf16 v128, v87, v132
  v_dot2c_f32_bf16 v129, v87, v87
  s_waitcnt vmcnt(8)
  v_dot2c_f32_bf16 v128, v88, v132
  v_dot2c_f32_bf16 v129, v88, v88
  v_dot2c_f32_bf16 v128, v89, v132
  v_dot2c_f32_bf16 v129, v89, v89
  v_dot2c_f32_bf16 v128, v90, v132
  v_dot2c_f32_bf16 v129, v90, v90
  v_dot2c_f32_bf16 v128, v91, v132
  v_dot2c_f32_bf16 v129, v91, v91
  s_waitcnt vmcnt(7)
  v_dot2c_f32_bf16 v128, v92, v132
  v_dot2c_f32_bf16 v129, v92, v92
  v_dot2c_f32_bf16 v128, v93, v132
  v_dot2c_f32_bf16 v129, v93, v93
  v_dot2c_f32_bf16 v128, v94, v132
  v_dot2c_f32_bf16 v129, v94, v94
  v_dot2c_f32_bf16 v128, v95, v132
  v_dot2c_f32_bf16 v129, v95, v95
  s_nop 1
  v_add_f32_dpp v128, v128, v128 row_ror:8 row_mask:0xf bank_mask:0xf
  v_add_f32_dpp v129, v129, v129 row_ror:8 row_mask:0xf bank_mask:0xf
  s_nop 0
  v_add_f32_dpp v128, v128, v128 row_ror:4 row_mask:0xf bank_mask:0xf
  v_add_f32_dpp v129, v129, v129 row_ror:4 row_mask:0xf bank_mask:0xf
  s_nop 0
  v_add_f32_dpp v128, v128, v128 row_ror:2 row_mask:0xf bank_mask:0xf
  v_add_f32_dpp v129, v129, v129 row_ror:2 row_mask:0xf bank_mask:0xf
  s_nop 0
  v_add_f32_dpp v128, v128, v128 row_ror:1 row_mask:0xf bank_mask:0xf
  v_add_f32_dpp v129, v129, v129 row_ror:1 row_mask:0xf bank_mask:0xf
  v_mul_f32 v128, 0xbacccccd, v128
  v_mul_f32 v129, 0x3acccccd, v129
  v_fma_f32 v129, -v128, v128, v129
  v_max_f32 v129, 0, v129
  v_add_f32 v129, 0x3727c5ac, v129
  v_rsq_f32 v129, v129
  s_nop 0
  v_mul_f32 v128, v128, v129
  v_lshlrev_b32 v133, 16, v76
  v_and_b32 v134, 0xffff0000, v76
  v_fma_f32 v133, v133, v129, v128
  v_fma_f32 v134, v134, v129, v128
  v_cvt_pk_bf16_f32 v76, v133, v134
  v_lshlrev_b32 v135, 16, v77
  v_and_b32 v136, 0xffff0000, v77
  v_fma_f32 v135, v135, v129, v128
  v_fma_f32 v136, v136, v129, v128
  v_cvt_pk_bf16_f32 v77, v135, v136
  v_lshlrev_b32 v133, 16, v78
  v_and_b32 v134, 0xffff0000, v78
  v_fma_f32 v133, v133, v129, v128
  v_fma_f32 v134, v134, v129, v128
  v_cvt_pk_bf16_f32 v78, v133, v134
  v_lshlrev_b32 v135, 16, v79
  v_and_b32 v136, 0xffff0000, v79
  v_fma_f32 v135, v135, v129, v128
  v_fma_f32 v136, v136, v129, v128
  v_cvt_pk_bf16_f32 v79, v135, v136
  ds_write_b64 v189, v[76:77] offset:8448
  ds_write_b64 v189, v[78:79] offset:8456
  s_waitcnt vmcnt(6)
  v_dot2c_f32_bf16 v130, v96, v132
  v_dot2c_f32_bf16 v131, v96, v96
  v_dot2c_f32_bf16 v130, v97, v132
  v_dot2c_f32_bf16 v131, v97, v97
  v_dot2c_f32_bf16 v130, v98, v132
  v_dot2c_f32_bf16 v131, v98, v98
  v_dot2c_f32_bf16 v130, v99, v132
  v_dot2c_f32_bf16 v131, v99, v99
  s_waitcnt vmcnt(5)
  v_dot2c_f32_bf16 v130, v100, v132
  v_dot2c_f32_bf16 v131, v100, v100
  v_dot2c_f32_bf16 v130, v101, v132
  v_dot2c_f32_bf16 v131, v101, v101
  v_dot2c_f32_bf16 v130, v102, v132
  v_dot2c_f32_bf16 v131, v102, v102
  v_dot2c_f32_bf16 v130, v103, v132
  v_dot2c_f32_bf16 v131, v103, v103
  s_waitcnt vmcnt(4)
  v_dot2c_f32_bf16 v130, v104, v132
  v_dot2c_f32_bf16 v131, v104, v104
  v_dot2c_f32_bf16 v130, v105, v132
  v_dot2c_f32_bf16 v131, v105, v105
  v_dot2c_f32_bf16 v130, v106, v132
  v_dot2c_f32_bf16 v131, v106, v106
  v_dot2c_f32_bf16 v130, v107, v132
  v_dot2c_f32_bf16 v131, v107, v107
  s_waitcnt vmcnt(3)
  v_dot2c_f32_bf16 v130, v108, v132
  v_dot2c_f32_bf16 v131, v108, v108
  v_dot2c_f32_bf16 v130, v109, v132
  v_dot2c_f32_bf16 v131, v109, v109
  v_dot2c_f32_bf16 v130, v110, v132
  v_dot2c_f32_bf16 v131, v110, v110
  v_dot2c_f32_bf16 v130, v111, v132
  v_dot2c_f32_bf16 v131, v111, v111
  s_waitcnt vmcnt(2)
  v_dot2c_f32_bf16 v130, v112, v132
  v_dot2c_f32_bf16 v131, v112, v112
  v_dot2c_f32_bf16 v130, v113, v132
  v_dot2c_f32_bf16 v131, v113, v113
  v_dot2c_f32_bf16 v130, v114, v132
  v_dot2c_f32_bf16 v131, v114, v114
  v_dot2c_f32_bf16 v130, v115, v132
  v_dot2c_f32_bf16 v131, v115, v115
  s_nop 1
  v_add_f32_dpp v130, v130, v130 row_ror:8 row_mask:0xf bank_mask:0xf
  v_add_f32_dpp v131, v131, v131 row_ror:8 row_mask:0xf bank_mask:0xf
  s_nop 0
  v_add_f32_dpp v130, v130, v130 row_ror:4 row_mask:0xf bank_mask:0xf
  v_add_f32_dpp v131, v131, v131 row_ror:4 row_mask:0xf bank_mask:0xf
  s_nop 0
  v_add_f32_dpp v130, v130, v130 row_ror:2 row_mask:0xf bank_mask:0xf
  v_add_f32_dpp v131, v131, v131 row_ror:2 row_mask:0xf bank_mask:0xf
  s_nop 0
  v_add_f32_dpp v130, v130, v130 row_ror:1 row_mask:0xf bank_mask:0xf
  v_add_f32_dpp v131, v131, v131 row_ror:1 row_mask:0xf bank_mask:0xf
  v_mul_f32 v130, 0xbacccccd, v130
  v_mul_f32 v131, 0x3acccccd, v131
  v_fma_f32 v131, -v130, v130, v131
  v_max_f32 v131, 0, v131
  v_add_f32 v131, 0x3727c5ac, v131
  v_rsq_f32 v131, v131
  s_nop 0
  v_mul_f32 v130, v130, v131
  v_lshlrev_b32 v133, 16, v96
  v_and_b32 v134, 0xffff0000, v96
  v_fma_f32 v133, v133, v131, v130
  v_fma_f32 v134, v134, v131, v130
  v_cvt_pk_bf16_f32 v96, v133, v134
  v_lshlrev_b32 v135, 16, v97
  v_and_b32 v136, 0xffff0000, v97
  v_fma_f32 v135, v135, v131, v130
  v_fma_f32 v136, v136, v131, v130
  v_cvt_pk_bf16_f32 v97, v135, v136
  v_lshlrev_b32 v133, 16, v98
  v_and_b32 v134, 0xffff0000, v98
  v_fma_f32 v133, v133, v131, v130
  v_fma_f32 v134, v134, v131, v130
  v_cvt_pk_bf16_f32 v98, v133, v134
  v_lshlrev_b32 v135, 16, v99
  v_and_b32 v136, 0xffff0000, v99
  v_fma_f32 v135, v135, v131, v130
  v_fma_f32 v136, v136, v131, v130
  v_cvt_pk_bf16_f32 v99, v135, v136
  ds_write_b64 v189, v[96:97] offset:12672
  ds_write_b64 v189, v[98:99] offset:12680
  s_waitcnt vmcnt(0)
  s_load_dwordx2 s[40:41], s[0:1], 104
  s_mov_b32 s42, 256
  s_mov_b32 s43, 0x20000
  v_mov_b32 v6, 0
  s_waitcnt lgkmcnt(0)
  buffer_load_dword v7, v6, s[40:43], 0 offen sc0 sc1
  s_barrier
  ds_read_b64_tr_b16 a[0:1], v190 offset:0
  ds_read_b64_tr_b16 a[2:3], v190 offset:4224
  ds_read_b64_tr_b16 a[32:33], v190 offset:8448
  ds_read_b64_tr_b16 a[34:35], v190 offset:12672
  ds_read_b64_tr_b16 a[4:5], v190 offset:8
  ds_read_b64_tr_b16 a[6:7], v190 offset:4232
  ds_read_b64_tr_b16 a[36:37], v190 offset:8456
  ds_read_b64_tr_b16 a[38:39], v190 offset:12680
  ds_read_b64_tr_b16 a[8:9], v190 offset:16
  ds_read_b64_tr_b16 a[10:11], v190 offset:4240
  ds_read_b64_tr_b16 a[40:41], v190 offset:8464
  ds_read_b64_tr_b16 a[42:43], v190 offset:12688
  ds_read_b64_tr_b16 a[12:13], v190 offset:24
  ds_read_b64_tr_b16 a[14:15], v190 offset:4248
  ds_read_b64_tr_b16 a[44:45], v190 offset:8472
  ds_read_b64_tr_b16 a[46:47], v190 offset:12696
  ds_read_b64_tr_b16 a[16:17], v190 offset:128
  ds_read_b64_tr_b16 a[18:19], v190 offset:4352
  ds_read_b64_tr_b16 a[48:49], v190 offset:8576
  ds_read_b64_tr_b16 a[50:51], v190 offset:12800
  ds_read_b64_tr_b16 a[20:21], v190 offset:136
  ds_read_b64_tr_b16 a[22:23], v190 offset:4360
  ds_read_b64_tr_b16 a[52:53], v190 offset:8584
  ds_read_b64_tr_b16 a[54:55], v190 offset:12808
  ds_read_b64_tr_b16 a[24:25], v190 offset:144
  ds_read_b64_tr_b16 a[26:27], v190 offset:4368
  ds_read_b64_tr_b16 a[56:57], v190 offset:8592
  ds_read_b64_tr_b16 a[58:59], v190 offset:12816
  ds_read_b64_tr_b16 a[28:29], v190 offset:152
  ds_read_b64_tr_b16 a[30:31], v190 offset:4376
  ds_read_b64_tr_b16 a[60:61], v190 offset:8600
  ds_read_b64_tr_b16 a[62:63], v190 offset:12824
  s_waitcnt lgkmcnt(15)
  v_mfma_f32_16x16x32_bf16 v[140:143], a[0:3], v[116:119], 0
  v_mfma_f32_16x16x32_bf16 v[140:143], a[32:35], v[120:123], v[140:143]
  v_mfma_f32_16x16x32_bf16 v[144:147], a[4:7], v[116:119], 0
  v_mfma_f32_16x16x32_bf16 v[144:147], a[36:39], v[120:123], v[144:147]
  v_mfma_f32_16x16x32_bf16 v[148:151], a[8:11], v[116:119], 0
  v_mfma_f32_16x16x32_bf16 v[148:151], a[40:43], v[120:123], v[148:151]
  v_mfma_f32_16x16x32_bf16 v[152:155], a[12:15], v[116:119], 0
  v_mfma_f32_16x16x32_bf16 v[152:155], a[44:47], v[120:123], v[152:155]
  s_waitcnt lgkmcnt(14)
  v_mfma_f32_16x16x32_bf16 v[156:159], a[16:19], v[116:119], 0
  s_waitcnt lgkmcnt(12)
  v_mfma_f32_16x16x32_bf16 v[156:159], a[48:51], v[120:123], v[156:159]
  s_waitcnt lgkmcnt(10)
  v_mfma_f32_16x16x32_bf16 v[160:163], a[20:23], v[116:119], 0
  s_waitcnt lgkmcnt(8)
  v_mfma_f32_16x16x32_bf16 v[160:163], a[52:55], v[120:123], v[160:163]
  s_waitcnt lgkmcnt(6)
  v_mfma_f32_16x16x32_bf16 v[164:167], a[24:27], v[116:119], 0
  s_waitcnt lgkmcnt(4)
  v_mfma_f32_16x16x32_bf16 v[164:167], a[56:59], v[120:123], v[164:167]
  s_waitcnt lgkmcnt(2)
  v_mfma_f32_16x16x32_bf16 v[168:171], a[28:31], v[116:119], 0
  s_waitcnt lgkmcnt(0)
  v_mfma_f32_16x16x32_bf16 v[168:171], a[60:63], v[120:123], v[168:171]
  v_cvt_pk_bf16_f32 v172, v140, v141
  v_cvt_pk_bf16_f32 v173, v142, v143
  v_cvt_pk_bf16_f32 v174, v144, v145
  v_cvt_pk_bf16_f32 v175, v146, v147
  ds_write_b128 v192, v[172:175] offset:0
  v_cvt_pk_bf16_f32 v176, v148, v149
  v_cvt_pk_bf16_f32 v177, v150, v151
  v_cvt_pk_bf16_f32 v178, v152, v153
  v_cvt_pk_bf16_f32 v179, v154, v155
  ds_write_b128 v192, v[176:179] offset:16
  v_cvt_pk_bf16_f32 v180, v156, v157
  v_cvt_pk_bf16_f32 v181, v158, v159
  v_cvt_pk_bf16_f32 v182, v160, v161
  v_cvt_pk_bf16_f32 v183, v162, v163
  ds_write_b128 v192, v[180:183] offset:128
  v_cvt_pk_bf16_f32 v184, v164, v165
  v_cvt_pk_bf16_f32 v185, v166, v167
  v_cvt_pk_bf16_f32 v186, v168, v169
  v_cvt_pk_bf16_f32 v187, v170, v171
  ds_write_b128 v192, v[184:187] offset:144
  ds_read_b128 v[36:39], v193 offset:0
  ds_read_b128 v[40:43], v193 offset:1088
  ds_read_b128 v[44:47], v193 offset:2176
  ds_read_b128 v[48:51], v193 offset:3264
  s_mov_b32 s36, 0
  s_waitcnt vmcnt(0)
  v_cmp_eq_u32 vcc, 0, v7
  s_nop 0
  s_cmp_eq_u64 vcc, 0
  s_cbranch_scc1 kg_tf_ok
kg_tf_again:
  s_sleep 2
  buffer_load_dword v7, v6, s[40:43], 0 offen sc0 sc1
  s_add_u32 s36, s36, 1
  s_waitcnt vmcnt(0)
  v_cmp_eq_u32 vcc, 0, v7
  s_nop 0
  s_cmp_eq_u64 vcc, 0
  s_cbranch_scc1 kg_tf_ok
  s_cmp_lt_u32 s36, 100000
  s_cbranch_scc1 kg_tf_again
kg_tf_ok:
  v_readfirstlane_b32 s3, v7
  s_waitcnt lgkmcnt(3)
  buffer_store_dwordx4 v[36:39], v191, s[4:7], s30 offen sc1
  s_add_u32 s30, s30, 327680
  s_waitcnt lgkmcnt(2)
  buffer_store_dwordx4 v[40:43], v191, s[4:7], s30 offen sc1
  s_add_u32 s30, s30, 327680
  s_waitcnt lgkmcnt(1)
  buffer_store_dwordx4 v[44:47], v191, s[4:7], s30 offen sc1
  s_add_u32 s30, s30, 327680
  s_waitcnt lgkmcnt(0)
  buffer_store_dwordx4 v[48:51], v191, s[4:7], s30 offen sc1
  s_lshl_b32 s37, s20, 12
  s_add_u32 m0, s37, 114816
  s_nop 0
  buffer_load_dwordx4 v2, s[12:15], s37 offen offset:0 lds
  buffer_load_dwordx4 v2, s[12:15], s37 offen offset:1024 lds
  buffer_load_dwordx4 v2, s[12:15], s37 offen offset:2048 lds
  buffer_load_dwordx4 v2, s[12:15], s37 offen offset:3072 lds
  s_cmp_eq_u32 s24, -1
  s_cbranch_scc1 pa_drain
  s_mul_i32 s28, s20, 65664
  s_add_u32 m0, s28, 16256
  v_add_u32 v26, 0, v1
  v_mul_u32_u24 v4, 4682, v26
  v_lshrrev_b32 v4, 16, v4
  v_mul_u32_u24 v5, 14, v4
  v_sub_u32 v5, v26, v5
  v_mul_u32_u24 v26, 3456, v4
  v_lshl_add_u32 v26, v5, 4, v26
  v_cmp_gt_u32 vcc, 7, v5
  v_add_u32 v4, 1728, v26
  v_subrev_u32 v26, 112, v26
  v_cndmask_b32 v26, v26, v4, vcc
  buffer_load_dwordx4 v26, s[8:11], s35 offen lds
  s_add_u32 m0, m0, 1024
  v_add_u32 v27, 64, v1
  v_mul_u32_u24 v4, 4682, v27
  v_lshrrev_b32 v4, 16, v4
  v_mul_u32_u24 v5, 14, v4
  v_sub_u32 v5, v27, v5
  v_mul_u32_u24 v27, 3456, v4
  v_lshl_add_u32 v27, v5, 4, v27
  v_cmp_gt_u32 vcc, 7, v5
  v_add_u32 v4, 1728, v27
  v_subrev_u32 v27, 112, v27
  v_cndmask_b32 v27, v27, v4, vcc
  buffer_load_dwordx4 v27, s[8:11], s35 offen lds
  s_add_u32 m0, m0, 1024
  v_add_u32 v28, 128, v1
  v_mul_u32_u24 v4, 4682, v28
  v_lshrrev_b32 v4, 16, v4
  v_mul_u32_u24 v5, 14, v4
  v_sub_u32 v5, v28, v5
  v_mul_u32_u24 v28, 3456, v4
  v_lshl_add_u32 v28, v5, 4, v28
  v_cmp_gt_u32 vcc, 7, v5
  v_add_u32 v4, 1728, v28
  v_subrev_u32 v28, 112, v28
  v_cndmask_b32 v28, v28, v4, vcc
  buffer_load_dwordx4 v28, s[8:11], s35 offen lds
  s_add_u32 m0, m0, 1024
  v_add_u32 v29, 192, v1
  v_mul_u32_u24 v4, 4682, v29
  v_lshrrev_b32 v4, 16, v4
  v_mul_u32_u24 v5, 14, v4
  v_sub_u32 v5, v29, v5
  v_mul_u32_u24 v29, 3456, v4
  v_lshl_add_u32 v29, v5, 4, v29
  v_cmp_gt_u32 vcc, 7, v5
  v_add_u32 v4, 1728, v29
  v_subrev_u32 v29, 112, v29
  v_cndmask_b32 v29, v29, v4, vcc
  buffer_load_dwordx4 v29, s[8:11], s35 offen lds
  s_add_u32 m0, m0, 1024
  v_add_u32 v30, 256, v1
  v_mul_u32_u24 v4, 4682, v30
  v_lshrrev_b32 v4, 16, v4
  v_mul_u32_u24 v5, 14, v4
  v_sub_u32 v5, v30, v5
  v_mul_u32_u24 v30, 3456, v4
  v_lshl_add_u32 v30, v5, 4, v30
  v_cmp_gt_u32 vcc, 7, v5
  v_add_u32 v4, 1728, v30
  v_subrev_u32 v30, 112, v30
  v_cndmask_b32 v30, v30, v4, vcc
  buffer_load_dwordx4 v30, s[8:11], s35 offen lds
  s_add_u32 m0, m0, 1024
  v_add_u32 v31, 320, v1
  v_mul_u32_u24 v4, 4682, v31
  v_lshrrev_b32 v4, 16, v4
  v_mul_u32_u24 v5, 14, v4
  v_sub_u32 v5, v31, v5
  v_mul_u32_u24 v31, 3456, v4
  v_lshl_add_u32 v31, v5, 4, v31
  v_cmp_gt_u32 vcc, 7, v5
  v_add_u32 v4, 1728, v31
  v_subrev_u32 v31, 112, v31
  v_cndmask_b32 v31, v31, v4, vcc
  buffer_load_dwordx4 v31, s[8:11], s35 offen lds
  s_add_u32 m0, m0, 1024
  v_add_u32 v32, 384, v1
  v_mul_u32_u24 v4, 4682, v32
  v_lshrrev_b32 v4, 16, v4
  v_mul_u32_u24 v5, 14, v4
  v_sub_u32 v5, v32, v5
  v_mul_u32_u24 v32, 3456, v4
  v_lshl_add_u32 v32, v5, 4, v32
  v_cmp_gt_u32 vcc, 7, v5
  v_add_u32 v4, 1728, v32
  v_subrev_u32 v32, 112, v32
  v_cndmask_b32 v32, v32, v4, vcc
  buffer_load_dwordx4 v32, s[8:11], s35 offen lds
  s_waitcnt vmcnt(11)
  s_branch pa_done
pa_other:
  s_cmp_ge_u32 s2, 228
  s_cbranch_scc1 pa_wo
  s_cmp_ge_u32 s2, 168
  s_cbranch_scc1 pa_gv
  s_add_u32 s27, s2, s20
  s_cmp_lg_u32 s27, 0
  s_cbranch_scc1 pa_notok
  s_load_dwordx2 s[40:41], s[0:1], 104
  s_mov_b32 s42, 256
  s_mov_b32 s43, 0x20000
  s_memrealtime s[8:9]
  v_mov_b32 v4, 0
  s_waitcnt lgkmcnt(0)
  s_or_b32 s27, s8, 1
  v_mov_b32 v5, s27
  s_mov_b64 exec, 1
  buffer_store_dword v5, v4, s[40:43], 0 offen sc0 sc1
  s_mov_b64 exec, -1
pa_notok:
  v_and_b32 v4, 63, v0
  s_lshl_b32 s27, s2, 13
  s_add_u32 s27, s27, 3031040
  s_mul_i32 s28, s2, 5120
  s_add_u32 s28, s28, 3293184
  s_cmp_eq_u32 s20, 1
  s_cselect_b32 s27, s27, s28
  v_lshlrev_b32 v4, 7, v4
  s_waitcnt lgkmcnt(0)
  buffer_load_dword a158, v4, s[4:7], s27 offen sc0 sc1
  v_lshlrev_b32 v4, 4, v0
  v_mov_b32 v20, -1
  v_mov_b32 v21, -1
  v_mov_b32 v22, -1
  v_mov_b32 v23, -1
  s_mul_i32 s27, s2, 49152
  s_add_u32 s27, s27, 2637824
  buffer_store_dwordx4 v[20:23], v4, s[4:7], s27 offen sc1
  s_add_u32 s27, s27, 4096
  buffer_store_dwordx4 v[20:23], v4, s[4:7], s27 offen sc1
  s_add_u32 s27, s27, 4096
  buffer_store_dwordx4 v[20:23], v4, s[4:7], s27 offen sc1
  s_add_u32 s27, s27, 4096
  buffer_store_dwordx4 v[20:23], v4, s[4:7], s27 offen sc1
  s_add_u32 s27, s27, 4096
  buffer_store_dwordx4 v[20:23], v4, s[4:7], s27 offen sc1
  s_add_u32 s27, s27, 4096
  buffer_store_dwordx4 v[20:23], v4, s[4:7], s27 offen sc1
  s_add_u32 s27, s27, 4096
  buffer_store_dwordx4 v[20:23], v4, s[4:7], s27 offen sc1
  s_add_u32 s27, s27, 4096
  buffer_store_dwordx4 v[20:23], v4, s[4:7], s27 offen sc1
  s_add_u32 s27, s27, 4096
  buffer_store_dwordx4 v[20:23], v4, s[4:7], s27 offen sc1
  s_add_u32 s27, s27, 4096
  buffer_store_dwordx4 v[20:23], v4, s[4:7], s27 offen sc1
  s_add_u32 s27, s27, 4096
  buffer_store_dwordx4 v[20:23], v4, s[4:7], s27 offen sc1
  s_add_u32 s27, s27, 4096
  buffer_store_dwordx4 v[20:23], v4, s[4:7], s27 offen sc1
  s_lshl_b32 s37, s20, 12
  s_add_u32 m0, s37, 114816
  s_nop 0
  buffer_load_dwordx4 v2, s[12:15], s37 offen offset:0 lds
  buffer_load_dwordx4 v2, s[12:15], s37 offen offset:1024 lds
  buffer_load_dwordx4 v2, s[12:15], s37 offen offset:2048 lds
  buffer_load_dwordx4 v2, s[12:15], s37 offen offset:3072 lds
  s_load_dwordx2 s[40:41], s[0:1], 104
  s_mov_b32 s42, 256
  s_mov_b32 s43, 0x20000
  v_mov_b32 v6, 0
  s_waitcnt lgkmcnt(0)
  buffer_load_dword v7, v6, s[40:43], 0 offen sc0 sc1
  s_mov_b32 s36, 0
  s_waitcnt vmcnt(0)
  v_cmp_eq_u32 vcc, 0, v7
  s_nop 0
  s_cmp_eq_u64 vcc, 0
  s_cbranch_scc1 kg_tp_ok
kg_tp_again:
  s_sleep 2
  buffer_load_dword v7, v6, s[40:43], 0 offen sc0 sc1
  s_add_u32 s36, s36, 1
  s_waitcnt vmcnt(0)
  v_cmp_eq_u32 vcc, 0, v7
  s_nop 0
  s_cmp_eq_u64 vcc, 0
  s_cbranch_scc1 kg_tp_ok
  s_cmp_lt_u32 s36, 100000
  s_cbranch_scc1 kg_tp_again
kg_tp_ok:
  v_readfirstlane_b32 s3, v7
  s_getpc_b64 s[8:9]
kg_kernel_pc4:
  s_add_u32 s8, s8, pa_done-kg_kernel_pc4
  s_addc_u32 s9, s9, 0
  s_mov_b32 s10, ctab-pa_done
  s_mov_b32 s11, 0x20000
  v_lshlrev_b32 v5, 6, v0
  buffer_load_dword a152, v5, s[8:11], 0 offen
  v_add_u32 v5, 16384, v5
  buffer_load_dword a153, v5, s[8:11], 0 offen
  v_add_u32 v5, 16384, v5
  buffer_load_dword a154, v5, s[8:11], 0 offen
kg_kernel_nopf3:
  s_branch pa_done
pa_gv:
  s_sub_u32 s31, s2, 168
  s_load_dwordx2 s[8:9], s[0:1], 88
  s_mov_b32 s10, 4915200
  s_mov_b32 s11, 0x20000
  s_load_dwordx2 s[40:41], s[0:1], 80
  s_mov_b32 s42, 1280
  s_mov_b32 s43, 0x20000
  v_lshrrev_b32 v18, 3, v0
  v_mul_u32_u24 v20, 40, v18
  v_mul_u32_u24 v19, 153600, v18
  v_and_b32 v4, 7, v0
  v_lshl_add_u32 v19, v4, 4, v19
  s_lshl_b32 s27, s31, 7
  s_waitcnt lgkmcnt(0)
  buffer_load_dwordx4 v[24:27], v20, s[40:43], 0 offen
  buffer_load_dwordx4 v[28:31], v20, s[40:43], 0 offen offset:16
  buffer_load_dwordx2 v[32:33], v20, s[40:43], 0 offen offset:32
  buffer_load_dwordx4 v[36:39], v19, s[8:11], s27 offen
  s_add_u32 s27, s27, 7680
  buffer_load_dwordx4 v[40:43], v19, s[8:11], s27 offen
  s_add_u32 s27, s27, 7680
  buffer_load_dwordx4 v[44:47], v19, s[8:11], s27 offen
  s_add_u32 s27, s27, 7680
  buffer_load_dwordx4 v[48:51], v19, s[8:11], s27 offen
  s_add_u32 s27, s27, 7680
  buffer_load_dwordx4 v[52:55], v19, s[8:11], s27 offen
  s_add_u32 s27, s27, 7680
  buffer_load_dwordx4 v[56:59], v19, s[8:11], s27 offen
  s_add_u32 s27, s27, 7680
  buffer_load_dwordx4 v[60:63], v19, s[8:11], s27 offen
  s_add_u32 s27, s27, 7680
  buffer_load_dwordx4 v[64:67], v19, s[8:11], s27 offen
  s_add_u32 s27, s27, 7680
  buffer_load_dwordx4 v[68:71], v19, s[8:11], s27 offen
  s_add_u32 s27, s27, 7680
  buffer_load_dwordx4 v[72:75], v19, s[8:11], s27 offen
  s_add_u32 s27, s27, 7680
  buffer_load_dwordx4 v[76:79], v19, s[8:11], s27 offen
  s_add_u32 s27, s27, 7680
  buffer_load_dwordx4 v[80:83], v19, s[8:11], s27 offen
  s_add_u32 s27, s27, 7680
  buffer_load_dwordx4 v[84:87], v19, s[8:11], s27 offen
  s_add_u32 s27, s27, 7680
  buffer_load_dwordx4 v[88:91], v19, s[8:11], s27 offen
  s_add_u32 s27, s27, 7680
  buffer_load_dwordx4 v[92:95], v19, s[8:11], s27 offen
  s_add_u32 s27, s27, 7680
  buffer_load_dwordx4 v[96:99], v19, s[8:11], s27 offen
  s_add_u32 s27, s27, 7680
  buffer_load_dwordx4 v[100:103], v19, s[8:11], s27 offen
  s_add_u32 s27, s27, 7680
  buffer_load_dwordx4 v[104:107], v19, s[8:11], s27 offen
  s_add_u32 s27, s27, 7680
  buffer_load_dwordx4 v[108:111], v19, s[8:11], s27 offen
  s_add_u32 s27, s27, 7680
  buffer_load_dwordx4 v[112:115], v19, s[8:11], s27 offen
  s_lshl_b32 s37, s20, 12
  s_add_u32 m0, s37, 114816
  s_nop 0
  buffer_load_dwordx4 v2, s[12:15], s37 offen offset:0 lds
  buffer_load_dwordx4 v2, s[12:15], s37 offen offset:1024 lds
  buffer_load_dwordx4 v2, s[12:15], s37 offen offset:2048 lds
  buffer_load_dwordx4 v2, s[12:15], s37 offen offset:3072 lds
  s_waitcnt vmcnt(24)
  s_load_dwordx2 s[40:41], s[0:1], 104
  s_mov_b32 s42, 256
  s_mov_b32 s43, 0x20000
  v_mov_b32 v6, 0
  s_waitcnt lgkmcnt(0)
  buffer_load_dword v7, v6, s[40:43], 0 offen sc0 sc1
  v_mov_b32 v116, 0
  v_mov_b32 v117, 0
  v_mov_b32 v118, 0
  v_mov_b32 v119, 0
  v_mov_b32 v120, 0
  v_mov_b32 v121, 0
  v_mov_b32 v122, 0
  v_mov_b32 v123, 0
  s_mov_b32 s29, 0x05040100
  s_mov_b32 s30, 0x07060302
  v_lshlrev_b32 v124, 16, v24
  v_and_b32 v125, 0xffff0000, v24
  v_lshlrev_b32 v126, 16, v25
  v_and_b32 v127, 0xffff0000, v25
  v_lshlrev_b32 v128, 16, v26
  v_and_b32 v129, 0xffff0000, v26
  v_lshlrev_b32 v130, 16, v27
  v_and_b32 v131, 0xffff0000, v27
  v_lshlrev_b32 v132, 16, v28
  v_and_b32 v133, 0xffff0000, v28
  v_lshlrev_b32 v134, 16, v29
  v_and_b32 v135, 0xffff0000, v29
  v_lshlrev_b32 v136, 16, v30
  v_and_b32 v137, 0xffff0000, v30
  v_lshlrev_b32 v138, 16, v31
  v_and_b32 v139, 0xffff0000, v31
  v_lshlrev_b32 v140, 16, v32
  v_and_b32 v141, 0xffff0000, v32
  v_lshlrev_b32 v142, 16, v33
  v_and_b32 v143, 0xffff0000, v33
  v_mul_f32 v144, 0xbfb8aa3b, v124
  v_mul_f32 v145, 0xbfb8aa3b, v125
  v_mul_f32 v146, 0xbfb8aa3b, v126
  v_mul_f32 v147, 0xbfb8aa3b, v127
  v_mul_f32 v148, 0xbfb8aa3b, v128
  v_mul_f32 v149, 0xbfb8aa3b, v129
  v_mul_f32 v150, 0xbfb8aa3b, v130
  v_mul_f32 v151, 0xbfb8aa3b, v131
  v_mul_f32 v152, 0xbfb8aa3b, v132
  v_mul_f32 v153, 0xbfb8aa3b, v133
  v_mul_f32 v154, 0xbfb8aa3b, v134
  v_mul_f32 v155, 0xbfb8aa3b, v135
  v_mul_f32 v156, 0xbfb8aa3b, v136
  v_mul_f32 v157, 0xbfb8aa3b, v137
  v_mul_f32 v158, 0xbfb8aa3b, v138
  v_mul_f32 v159, 0xbfb8aa3b, v139
  v_mul_f32 v160, 0xbfb8aa3b, v140
  v_mul_f32 v161, 0xbfb8aa3b, v141
  v_mul_f32 v162, 0xbfb8aa3b, v142
  v_mul_f32 v163, 0xbfb8aa3b, v143
  v_exp_f32 v144, v144
  v_exp_f32 v145, v145
  v_exp_f32 v146, v146
  v_exp_f32 v147, v147
  v_exp_f32 v148, v148
  v_exp_f32 v149, v149
  v_exp_f32 v150, v150
  v_exp_f32 v151, v151
  v_exp_f32 v152, v152
  v_exp_f32 v153, v153
  v_exp_f32 v154, v154
  v_exp_f32 v155, v155
  v_exp_f32 v156, v156
  v_exp_f32 v157, v157
  v_exp_f32 v158, v158
  v_exp_f32 v159, v159
  v_exp_f32 v160, v160
  v_exp_f32 v161, v161
  v_exp_f32 v162, v162
  v_exp_f32 v163, v163
  v_add_f32 v144, 1.0, v144
  v_add_f32 v145, 1.0, v145
  v_add_f32 v146, 1.0, v146
  v_add_f32 v147, 1.0, v147
  v_add_f32 v148, 1.0, v148
  v_add_f32 v149, 1.0, v149
  v_add_f32 v150, 1.0, v150
  v_add_f32 v151, 1.0, v151
  v_add_f32 v152, 1.0, v152
  v_add_f32 v153, 1.0, v153
  v_add_f32 v154, 1.0, v154
  v_add_f32 v155, 1.0, v155
  v_add_f32 v156, 1.0, v156
  v_add_f32 v157, 1.0, v157
  v_add_f32 v158, 1.0, v158
  v_add_f32 v159, 1.0, v159
  v_add_f32 v160, 1.0, v160
  v_add_f32 v161, 1.0, v161
  v_add_f32 v162, 1.0, v162
  v_add_f32 v163, 1.0, v163
  v_rcp_f32 v144, v144
  v_rcp_f32 v145, v145
  v_rcp_f32 v146, v146
  v_rcp_f32 v147, v147
  v_rcp_f32 v148, v148
  v_rcp_f32 v149, v149
  v_rcp_f32 v150, v150
  v_rcp_f32 v151, v151
  v_rcp_f32 v152, v152
  v_rcp_f32 v153, v153
  v_rcp_f32 v154, v154
  v_rcp_f32 v155, v155
  v_rcp_f32 v156, v156
  v_rcp_f32 v157, v157
  v_rcp_f32 v158, v158
  v_rcp_f32 v159, v159
  v_rcp_f32 v160, v160
  v_rcp_f32 v161, v161
  v_rcp_f32 v162, v162
  v_rcp_f32 v163, v163
  v_mul_f32 v124, v124, v144
  v_mul_f32 v125, v125, v145
  v_mul_f32 v126, v126, v146
  v_mul_f32 v127, v127, v147
  v_mul_f32 v128, v128, v148
  v_mul_f32 v129, v129, v149
  v_mul_f32 v130, v130, v150
  v_mul_f32 v131, v131, v151
  v_mul_f32 v132, v132, v152
  v_mul_f32 v133, v133, v153
  v_mul_f32 v134, v134, v154
  v_mul_f32 v135, v135, v155
  v_mul_f32 v136, v136, v156
  v_mul_f32 v137, v137, v157
  v_mul_f32 v138, v138, v158
  v_mul_f32 v139, v139, v159
  v_mul_f32 v140, v140, v160
  v_mul_f32 v141, v141, v161
  v_mul_f32 v142, v142, v162
  v_mul_f32 v143, v143, v163
  v_cvt_pk_bf16_f32 v164, v124, v125
  v_cvt_pk_bf16_f32 v165, v126, v127
  v_cvt_pk_bf16_f32 v166, v128, v129
  v_cvt_pk_bf16_f32 v167, v130, v131
  v_cvt_pk_bf16_f32 v168, v132, v133
  v_cvt_pk_bf16_f32 v169, v134, v135
  v_cvt_pk_bf16_f32 v170, v136, v137
  v_cvt_pk_bf16_f32 v171, v138, v139
  v_cvt_pk_bf16_f32 v172, v140, v141
  v_cvt_pk_bf16_f32 v173, v142, v143
  s_waitcnt vmcnt(23)
  v_perm_b32 v144, v40, v36, s29
  v_perm_b32 v145, v40, v36, s30
  v_perm_b32 v146, v41, v37, s29
  v_perm_b32 v147, v41, v37, s30
  v_perm_b32 v148, v42, v38, s29
  v_perm_b32 v149, v42, v38, s30
  v_perm_b32 v150, v43, v39, s29
  v_perm_b32 v151, v43, v39, s30
  v_dot2c_f32_bf16 v116, v144, v164
  v_dot2c_f32_bf16 v117, v145, v164
  v_dot2c_f32_bf16 v118, v146, v164
  v_dot2c_f32_bf16 v119, v147, v164
  v_dot2c_f32_bf16 v120, v148, v164
  v_dot2c_f32_bf16 v121, v149, v164
  v_dot2c_f32_bf16 v122, v150, v164
  v_dot2c_f32_bf16 v123, v151, v164
  s_waitcnt vmcnt(21)
  v_perm_b32 v144, v48, v44, s29
  v_perm_b32 v145, v48, v44, s30
  v_perm_b32 v146, v49, v45, s29
  v_perm_b32 v147, v49, v45, s30
  v_perm_b32 v148, v50, v46, s29
  v_perm_b32 v149, v50, v46, s30
  v_perm_b32 v150, v51, v47, s29
  v_perm_b32 v151, v51, v47, s30
  v_dot2c_f32_bf16 v116, v144, v165
  v_dot2c_f32_bf16 v117, v145, v165
  v_dot2c_f32_bf16 v118, v146, v165
  v_dot2c_f32_bf16 v119, v147, v165
  v_dot2c_f32_bf16 v120, v148, v165
  v_dot2c_f32_bf16 v121, v149, v165
  v_dot2c_f32_bf16 v122, v150, v165
  v_dot2c_f32_bf16 v123, v151, v165
  s_waitcnt vmcnt(19)
  v_perm_b32 v144, v56, v52, s29
  v_perm_b32 v145, v56, v52, s30
  v_perm_b32 v146, v57, v53, s29
  v_perm_b32 v147, v57, v53, s30
  v_perm_b32 v148, v58, v54, s29
  v_perm_b32 v149, v58, v54, s30
  v_perm_b32 v150, v59, v55, s29
  v_perm_b32 v151, v59, v55, s30
  v_dot2c_f32_bf16 v116, v144, v166
  v_dot2c_f32_bf16 v117, v145, v166
  v_dot2c_f32_bf16 v118, v146, v166
  v_dot2c_f32_bf16 v119, v147, v166
  v_dot2c_f32_bf16 v120, v148, v166
  v_dot2c_f32_bf16 v121, v149, v166
  v_dot2c_f32_bf16 v122, v150, v166
  v_dot2c_f32_bf16 v123, v151, v166
  s_waitcnt vmcnt(17)
  v_perm_b32 v144, v64, v60, s29
  v_perm_b32 v145, v64, v60, s30
  v_perm_b32 v146, v65, v61, s29
  v_perm_b32 v147, v65, v61, s30
  v_perm_b32 v148, v66, v62, s29
  v_perm_b32 v149, v66, v62, s30
  v_perm_b32 v150, v67, v63, s29
  v_perm_b32 v151, v67, v63, s30
  v_dot2c_f32_bf16 v116, v144, v167
  v_dot2c_f32_bf16 v117, v145, v167
  v_dot2c_f32_bf16 v118, v146, v167
  v_dot2c_f32_bf16 v119, v147, v167
  v_dot2c_f32_bf16 v120, v148, v167
  v_dot2c_f32_bf16 v121, v149, v167
  v_dot2c_f32_bf16 v122, v150, v167
  v_dot2c_f32_bf16 v123, v151, v167
  s_waitcnt vmcnt(15)
  v_perm_b32 v144, v72, v68, s29
  v_perm_b32 v145, v72, v68, s30
  v_perm_b32 v146, v73, v69, s29
  v_perm_b32 v147, v73, v69, s30
  v_perm_b32 v148, v74, v70, s29
  v_perm_b32 v149, v74, v70, s30
  v_perm_b32 v150, v75, v71, s29
  v_perm_b32 v151, v75, v71, s30
  v_dot2c_f32_bf16 v116, v144, v168
  v_dot2c_f32_bf16 v117, v145, v168
  v_dot2c_f32_bf16 v118, v146, v168
  v_dot2c_f32_bf16 v119, v147, v168
  v_dot2c_f32_bf16 v120, v148, v168
  v_dot2c_f32_bf16 v121, v149, v168
  v_dot2c_f32_bf16 v122, v150, v168
  v_dot2c_f32_bf16 v123, v151, v168
  s_waitcnt vmcnt(13)
  v_perm_b32 v144, v80, v76, s29
  v_perm_b32 v145, v80, v76, s30
  v_perm_b32 v146, v81, v77, s29
  v_perm_b32 v147, v81, v77, s30
  v_perm_b32 v148, v82, v78, s29
  v_perm_b32 v149, v82, v78, s30
  v_perm_b32 v150, v83, v79, s29
  v_perm_b32 v151, v83, v79, s30
  v_dot2c_f32_bf16 v116, v144, v169
  v_dot2c_f32_bf16 v117, v145, v169
  v_dot2c_f32_bf16 v118, v146, v169
  v_dot2c_f32_bf16 v119, v147, v169
  v_dot2c_f32_bf16 v120, v148, v169
  v_dot2c_f32_bf16 v121, v149, v169
  v_dot2c_f32_bf16 v122, v150, v169
  v_dot2c_f32_bf16 v123, v151, v169
  s_waitcnt vmcnt(11)
  v_perm_b32 v144, v88, v84, s29
  v_perm_b32 v145, v88, v84, s30
  v_perm_b32 v146, v89, v85, s29
  v_perm_b32 v147, v89, v85, s30
  v_perm_b32 v148, v90, v86, s29
  v_perm_b32 v149, v90, v86, s30
  v_perm_b32 v150, v91, v87, s29
  v_perm_b32 v151, v91, v87, s30
  v_dot2c_f32_bf16 v116, v144, v170
  v_dot2c_f32_bf16 v117, v145, v170
  v_dot2c_f32_bf16 v118, v146, v170
  v_dot2c_f32_bf16 v119, v147, v170
  v_dot2c_f32_bf16 v120, v148, v170
  v_dot2c_f32_bf16 v121, v149, v170
  v_dot2c_f32_bf16 v122, v150, v170
  v_dot2c_f32_bf16 v123, v151, v170
  s_waitcnt vmcnt(9)
  v_perm_b32 v144, v96, v92, s29
  v_perm_b32 v145, v96, v92, s30
  v_perm_b32 v146, v97, v93, s29
  v_perm_b32 v147, v97, v93, s30
  v_perm_b32 v148, v98, v94, s29
  v_perm_b32 v149, v98, v94, s30
  v_perm_b32 v150, v99, v95, s29
  v_perm_b32 v151, v99, v95, s30
  v_dot2c_f32_bf16 v116, v144, v171
  v_dot2c_f32_bf16 v117, v145, v171
  v_dot2c_f32_bf16 v118, v146, v171
  v_dot2c_f32_bf16 v119, v147, v171
  v_dot2c_f32_bf16 v120, v148, v171
  v_dot2c_f32_bf16 v121, v149, v171
  v_dot2c_f32_bf16 v122, v150, v171
  v_dot2c_f32_bf16 v123, v151, v171
  s_waitcnt vmcnt(7)
  v_perm_b32 v144, v104, v100, s29
  v_perm_b32 v145, v104, v100, s30
  v_perm_b32 v146, v105, v101, s29
  v_perm_b32 v147, v105, v101, s30
  v_perm_b32 v148, v106, v102, s29
  v_perm_b32 v149, v106, v102, s30
  v_perm_b32 v150, v107, v103, s29
  v_perm_b32 v151, v107, v103, s30
  v_dot2c_f32_bf16 v116, v144, v172
  v_dot2c_f32_bf16 v117, v145, v172
  v_dot2c_f32_bf16 v118, v146, v172
  v_dot2c_f32_bf16 v119, v147, v172
  v_dot2c_f32_bf16 v120, v148, v172
  v_dot2c_f32_bf16 v121, v149, v172
  v_dot2c_f32_bf16 v122, v150, v172
  v_dot2c_f32_bf16 v123, v151, v172
  s_waitcnt vmcnt(5)
  v_perm_b32 v144, v112, v108, s29
  v_perm_b32 v145, v112, v108, s30
  v_perm_b32 v146, v113, v109, s29
  v_perm_b32 v147, v113, v109, s30
  v_perm_b32 v148, v114, v110, s29
  v_perm_b32 v149, v114, v110, s30
  v_perm_b32 v150, v115, v111, s29
  v_perm_b32 v151, v115, v111, s30
  v_dot2c_f32_bf16 v116, v144, v173
  v_dot2c_f32_bf16 v117, v145, v173
  v_dot2c_f32_bf16 v118, v146, v173
  v_dot2c_f32_bf16 v119, v147, v173
  v_dot2c_f32_bf16 v120, v148, v173
  v_dot2c_f32_bf16 v121, v149, v173
  v_dot2c_f32_bf16 v122, v150, v173
  v_dot2c_f32_bf16 v123, v151, v173
  v_permlane32_swap_b32 v116, v120
  v_permlane32_swap_b32 v117, v121
  v_permlane32_swap_b32 v118, v122
  v_permlane32_swap_b32 v119, v123
  v_add_f32 v116, v116, v120
  v_add_f32 v117, v117, v121
  v_add_f32 v118, v118, v122
  v_add_f32 v119, v119, v123
  s_nop 0
  v_permlane16_swap_b32 v116, v118
  v_permlane16_swap_b32 v117, v119
  v_add_f32 v116, v116, v118
  v_add_f32 v117, v117, v119
  s_nop 0
  v_add_f32_dpp v116, v116, v116 row_ror:8 row_mask:0xf bank_mask:0x3
  s_nop 1
  v_add_f32_dpp v116, v117, v117 row_ror:8 row_mask:0xf bank_mask:0xc
  v_bfe_u32 v19, v0, 5, 1
  v_lshl_add_u32 v19, v4, 1, v19
  v_bfe_u32 v20, v0, 4, 1
  v_lshl_add_u32 v19, v19, 1, v20
  v_bfe_u32 v20, v0, 3, 1
  v_lshl_add_u32 v19, v19, 1, v20
  s_lshl_b32 s27, s20, 2
  v_lshl_add_u32 v19, v19, 4, s27
  ds_write_b32 v19, v116
  s_mov_b32 s36, 0
  s_waitcnt vmcnt(0)
  v_cmp_eq_u32 vcc, 0, v7
  s_nop 0
  s_cmp_eq_u64 vcc, 0
  s_cbranch_scc1 kg_tg_ok
kg_tg_again:
  s_sleep 2
  buffer_load_dword v7, v6, s[40:43], 0 offen sc0 sc1
  s_add_u32 s36, s36, 1
  s_waitcnt vmcnt(0)
  v_cmp_eq_u32 vcc, 0, v7
  s_nop 0
  s_cmp_eq_u64 vcc, 0
  s_cbranch_scc1 kg_tg_ok
  s_cmp_lt_u32 s36, 100000
  s_cbranch_scc1 kg_tg_again
kg_tg_ok:
  v_readfirstlane_b32 s3, v7
  s_waitcnt lgkmcnt(0)
  s_barrier
  s_cmp_lg_u32 s20, 0
  s_cbranch_scc1 pa_done
  ds_read_b128 v[36:39], v2
  s_waitcnt lgkmcnt(0)
  v_add_f32 v36, v36, v37
  v_add_f32 v38, v38, v39
  v_add_f32 v36, v36, v38
  v_cvt_pk_bf16_f32 v36, v36, v36
  v_and_b32 v36, 0xffff0000, v36
  s_mul_i32 s27, s31, 6554
  s_lshr_b32 s27, s27, 16
  s_mov_b32 s28, 0
  s_cmp_eq_u32 s27, 1
  s_cselect_b32 s28, 1.0, s28
  s_cmp_eq_u32 s27, 4
  s_cselect_b32 s28, 1.0, s28
  v_add_f32 v36, s28, v36
  v_cvt_pk_bf16_f32 v36, v36, v36
  v_and_b32 v36, 0xffff0000, v36
  s_mul_i32 s28, s27, 10
  s_sub_u32 s28, s31, s28
  s_lshl_b32 s28, s28, 6
  v_add_u32 v19, s28, v0
  s_cmp_ge_u32 s28, 320
  s_cselect_b32 s28, 40, 0
  v_lshrrev_b32 v20, 3, v19
  v_add_u32 v20, s28, v20
  v_bfe_u32 v18, v19, 2, 1
  v_mad_u32_u24 v20, v18, 40, v20
  v_and_b32 v18, 3, v19
  v_lshl_add_u32 v20, v20, 2, v18
  s_sub_u32 s28, s27, 2
  s_cmp_lt_u32 s28, 3
  s_cselect_b64 vcc, -1, 0
  v_cndmask_b32 v19, v19, v20, vcc
  v_lshlrev_b32 v19, 2, v19
  s_mul_i32 s27, s27, 2560
  s_add_u32 s27, s27, 2621440
  buffer_store_dword v36, v19, s[4:7], s27 offen sc1
  s_branch pa_drain
pa_wo:
  s_load_dwordx2 s[8:9], s[0:1], 72
  s_mov_b32 s10, 1105920
  s_mov_b32 s11, 0x20000
  s_sub_u32 s31, s2, 228
  v_lshrrev_b32 v18, 4, v0
  s_lshl_b32 s27, s31, 5
  s_add_u32 s27, s27, 0
  v_add_u32 v23, s27, v18
  v_mul_u32_u24 v4, 1171, v23
  v_lshrrev_b32 v4, 16, v4
  v_mul_u32_u24 v21, 56, v4
  v_sub_u32 v5, v23, v21
  v_lshrrev_b32 v20, 2, v4
  v_lshlrev_b32 v20, 3, v20
  v_sub_u32 v23, v21, v20
  v_and_b32 v22, 3, v4
  v_lshrrev_b32 v4, 3, v5
  v_and_b32 v20, 3, v5
  v_lshl_add_u32 v20, v4, 2, v20
  v_bfe_u32 v4, v5, 2, 1
  v_lshl_add_u32 v19, v4, 4, v20
  v_cmp_le_u32 vcc, 32, v5
  v_mul_u32_u24 v4, 56, v22
  s_nop 0
  v_cndmask_b32 v19, v19, v5, vcc
  v_add_u32 v4, v4, v5
  v_cmp_gt_u32 vcc, 216, v4
  v_add_u32 v23, v23, v19
  v_mul_u32_u24 v23, 1280, v23
  v_and_b32 v5, 15, v0
  v_lshl_add_u32 v23, v5, 4, v23
  v_mov_b32 v4, 0x80000000
  v_cndmask_b32 v23, v4, v23, vcc
  s_waitcnt lgkmcnt(0)
  buffer_load_dwordx4 v[28:31], v23, s[8:11], 0 offen offset:0
  buffer_load_dwordx4 v[32:35], v23, s[8:11], 0 offen offset:256
  buffer_load_dwordx4 v[36:39], v23, s[8:11], 0 offen offset:512
  buffer_load_dwordx4 v[40:43], v23, s[8:11], 0 offen offset:768
  buffer_load_dwordx4 v[44:47], v23, s[8:11], 0 offen offset:1024
  s_lshl_b32 s27, s31, 5
  s_add_u32 s27, s27, 16
  v_add_u32 v24, s27, v18
  v_mul_u32_u24 v4, 1171, v24
  v_lshrrev_b32 v4, 16, v4
  v_mul_u32_u24 v21, 56, v4
  v_sub_u32 v5, v24, v21
  v_lshrrev_b32 v20, 2, v4
  v_lshlrev_b32 v20, 3, v20
  v_sub_u32 v24, v21, v20
  v_and_b32 v22, 3, v4
  v_lshrrev_b32 v4, 3, v5
  v_and_b32 v20, 3, v5
  v_lshl_add_u32 v20, v4, 2, v20
  v_bfe_u32 v4, v5, 2, 1
  v_lshl_add_u32 v19, v4, 4, v20
  v_cmp_le_u32 vcc, 32, v5
  v_mul_u32_u24 v4, 56, v22
  s_nop 0
  v_cndmask_b32 v19, v19, v5, vcc
  v_add_u32 v4, v4, v5
  v_cmp_gt_u32 vcc, 216, v4
  v_add_u32 v24, v24, v19
  v_mul_u32_u24 v24, 1280, v24
  v_and_b32 v5, 15, v0
  v_lshl_add_u32 v24, v5, 4, v24
  v_mov_b32 v4, 0x80000000
  v_cndmask_b32 v24, v4, v24, vcc
  buffer_load_dwordx4 v[48:51], v24, s[8:11], 0 offen offset:0
  buffer_load_dwordx4 v[52:55], v24, s[8:11], 0 offen offset:256
  buffer_load_dwordx4 v[56:59], v24, s[8:11], 0 offen offset:512
  buffer_load_dwordx4 v[60:63], v24, s[8:11], 0 offen offset:768
  buffer_load_dwordx4 v[64:67], v24, s[8:11], 0 offen offset:1024
  s_lshl_b32 s37, s20, 12
  s_add_u32 m0, s37, 114816
  s_nop 0
  buffer_load_dwordx4 v2, s[12:15], s37 offen offset:0 lds
  buffer_load_dwordx4 v2, s[12:15], s37 offen offset:1024 lds
  buffer_load_dwordx4 v2, s[12:15], s37 offen offset:2048 lds
  buffer_load_dwordx4 v2, s[12:15], s37 offen offset:3072 lds
  s_load_dwordx2 s[40:41], s[0:1], 104
  s_mov_b32 s42, 256
  s_mov_b32 s43, 0x20000
  v_mov_b32 v6, 0
  s_waitcnt lgkmcnt(0)
  buffer_load_dword v7, v6, s[40:43], 0 offen sc0 sc1
  v_mul_u32_u24 v19, 1296, v18
  v_lshl_add_u32 v19, v5, 4, v19
  v_bfe_u32 v20, v0, 4, 2
  v_bfe_u32 v4, v0, 2, 2
  v_lshl_add_u32 v20, v20, 3, v4
  v_mul_u32_u24 v20, 1296, v20
  v_and_b32 v4, 3, v0
  v_lshlrev_b32 v4, 3, v4
  s_mul_i32 s29, s20, 320
  v_add3_u32 v20, v20, v4, s29
  s_mul_i32 s27, s20, 56
  s_add_u32 s27, s27, s31
  s_mul_i32 s27, s27, 5120
  s_add_u32 s27, s27, 5627904
  s_waitcnt vmcnt(14)
  ds_write_b128 v19, v[28:31] offset:0
  s_waitcnt vmcnt(13)
  ds_write_b128 v19, v[32:35] offset:256
  s_waitcnt vmcnt(12)
  ds_write_b128 v19, v[36:39] offset:512
  s_waitcnt vmcnt(11)
  ds_write_b128 v19, v[40:43] offset:768
  s_waitcnt vmcnt(10)
  ds_write_b128 v19, v[44:47] offset:1024
  s_waitcnt vmcnt(9)
  ds_write_b128 v19, v[48:51] offset:20736
  s_waitcnt vmcnt(8)
  ds_write_b128 v19, v[52:55] offset:20992
  s_waitcnt vmcnt(7)
  ds_write_b128 v19, v[56:59] offset:21248
  s_waitcnt vmcnt(6)
  ds_write_b128 v19, v[60:63] offset:21504
  s_waitcnt vmcnt(5)
  ds_write_b128 v19, v[64:67] offset:21760
  s_mov_b32 s36, 0
  s_waitcnt vmcnt(0)
  v_cmp_eq_u32 vcc, 0, v7
  s_nop 0
  s_cmp_eq_u64 vcc, 0
  s_cbranch_scc1 kg_tw_ok
kg_tw_again:
  s_sleep 2
  buffer_load_dword v7, v6, s[40:43], 0 offen sc0 sc1
  s_add_u32 s36, s36, 1
  s_waitcnt vmcnt(0)
  v_cmp_eq_u32 vcc, 0, v7
  s_nop 0
  s_cmp_eq_u64 vcc, 0
  s_cbranch_scc1 kg_tw_ok
  s_cmp_lt_u32 s36, 100000
  s_cbranch_scc1 kg_tw_again
kg_tw_ok:
  v_readfirstlane_b32 s3, v7
  s_waitcnt lgkmcnt(0)
  s_barrier
  ds_read_b64_tr_b16 v[68:69], v20 offset:0
  ds_read_b64_tr_b16 v[70:71], v20 offset:5184
  ds_read_b64_tr_b16 v[72:73], v20 offset:32
  ds_read_b64_tr_b16 v[74:75], v20 offset:5216
  ds_read_b64_tr_b16 v[76:77], v20 offset:64
  ds_read_b64_tr_b16 v[78:79], v20 offset:5248
  ds_read_b64_tr_b16 v[80:81], v20 offset:96
  ds_read_b64_tr_b16 v[82:83], v20 offset:5280
  ds_read_b64_tr_b16 v[84:85], v20 offset:128
  ds_read_b64_tr_b16 v[86:87], v20 offset:5312
  ds_read_b64_tr_b16 v[88:89], v20 offset:160
  ds_read_b64_tr_b16 v[90:91], v20 offset:5344
  ds_read_b64_tr_b16 v[92:93], v20 offset:192
  ds_read_b64_tr_b16 v[94:95], v20 offset:5376
  ds_read_b64_tr_b16 v[96:97], v20 offset:224
  ds_read_b64_tr_b16 v[98:99], v20 offset:5408
  ds_read_b64_tr_b16 v[100:101], v20 offset:256
  ds_read_b64_tr_b16 v[102:103], v20 offset:5440
  ds_read_b64_tr_b16 v[104:105], v20 offset:288
  ds_read_b64_tr_b16 v[106:107], v20 offset:5472
  s_add_u32 s29, s27, 4096
  s_waitcnt lgkmcnt(15)
  buffer_store_dwordx4 v[68:71], v2, s[4:7], s27 offen offset:0 sc1
  buffer_store_dwordx4 v[72:75], v2, s[4:7], s27 offen offset:1024 sc1
  s_waitcnt lgkmcnt(14)
  buffer_store_dwordx4 v[76:79], v2, s[4:7], s27 offen offset:2048 sc1
  s_waitcnt lgkmcnt(12)
  buffer_store_dwordx4 v[80:83], v2, s[4:7], s27 offen offset:3072 sc1
  s_waitcnt lgkmcnt(10)
  buffer_store_dwordx4 v[84:87], v2, s[4:7], s29 offen offset:0 sc1
  s_add_u32 s27, s27, 143360
  s_add_u32 s29, s27, 4096
  s_waitcnt lgkmcnt(8)
  buffer_store_dwordx4 v[88:91], v2, s[4:7], s27 offen offset:0 sc1
  s_waitcnt lgkmcnt(6)
  buffer_store_dwordx4 v[92:95], v2, s[4:7], s27 offen offset:1024 sc1
  s_waitcnt lgkmcnt(4)
  buffer_store_dwordx4 v[96:99], v2, s[4:7], s27 offen offset:2048 sc1
  s_waitcnt lgkmcnt(2)
  buffer_store_dwordx4 v[100:103], v2, s[4:7], s27 offen offset:3072 sc1
  s_waitcnt lgkmcnt(0)
  buffer_store_dwordx4 v[104:107], v2, s[4:7], s29 offen offset:0 sc1
pa_drain:
  s_waitcnt vmcnt(0)
pa_done:
  v_lshlrev_b32 v6, 13, v1
  s_lshr_b32 s27, s2, 2
  s_lshl_b32 s27, s27, 7
  s_and_b32 s28, s2, 3
  s_lshl2_add_u32 s27, s28, s27
  s_add_u32 s27, s27, 3031040
  s_barrier
  s_cmp_lg_u32 s20, 0
  s_cbranch_scc1 kg_asent
  s_mov_b64 exec, 0xff
  buffer_store_dword v7, v6, s[4:7], s27 offen sc0 sc1
  s_mov_b64 exec, -1
kg_asent:
  s_load_dwordx2 s[40:41], s[0:1], 56
  s_mov_b32 s42, 8388608
  s_mov_b32 s43, 0x20000
  v_lshrrev_b32 v11, 3, v1
  v_and_b32 v12, 7, v0
  v_bfe_u32 v9, v0, 4, 2
  v_xor_b32 v12, v12, v9
  v_lshlrev_b32 v11, 12, v11
  v_lshl_add_u32 v10, v12, 4, v11
  v_xor_b32 v13, 64, v10
  v_add_u32 v11, 31744, v13
  v_add_u32 v12, 63488, v10
  v_add_u32 v13, 95232, v13
  s_lshl_b32 s38, s22, 17
  s_lshl_b32 s37, s26, 11
  s_add_u32 s38, s38, s37
  s_mul_i32 s37, s20, 24576
  s_cmp_eq_u32 s20, 3
  s_cselect_b32 s37, 89088, s37
  s_add_u32 m0, s37, 0
  s_waitcnt lgkmcnt(0)
  buffer_load_dwordx4 v10, s[40:43], s38 offen offset:0 lds
  buffer_load_dwordx4 v11, s[40:43], s38 offen offset:1024 lds
  buffer_load_dwordx4 v12, s[40:43], s38 offen offset:2048 lds
  buffer_load_dwordx4 v13, s[40:43], s38 offen offset:3072 lds
  s_add_u32 s38, s38, 128
  s_add_u32 m0, s37, 4096
  s_nop 0
  buffer_load_dwordx4 v10, s[40:43], s38 offen offset:0 lds
  buffer_load_dwordx4 v11, s[40:43], s38 offen offset:1024 lds
  buffer_load_dwordx4 v12, s[40:43], s38 offen offset:2048 lds
  buffer_load_dwordx4 v13, s[40:43], s38 offen offset:3072 lds
  s_add_u32 s38, s38, 128
  s_add_u32 m0, s37, 8192
  s_nop 0
  buffer_load_dwordx4 v10, s[40:43], s38 offen offset:0 lds
  buffer_load_dwordx4 v11, s[40:43], s38 offen offset:1024 lds
  buffer_load_dwordx4 v12, s[40:43], s38 offen offset:2048 lds
  buffer_load_dwordx4 v13, s[40:43], s38 offen offset:3072 lds
  s_add_u32 s38, s38, 128
  s_add_u32 m0, s37, 12288
  s_nop 0
  buffer_load_dwordx4 v10, s[40:43], s38 offen offset:0 lds
  buffer_load_dwordx4 v11, s[40:43], s38 offen offset:1024 lds
  buffer_load_dwordx4 v12, s[40:43], s38 offen offset:2048 lds
  buffer_load_dwordx4 v13, s[40:43], s38 offen offset:3072 lds
  s_add_u32 s38, s38, 128
  v_lshrrev_b32 v4, 1, v1
  v_and_b32 v5, 1, v0
  v_lshlrev_b32 v4, 12, v4
  v_lshl_add_u32 v4, v5, 7, v4
  buffer_load_dword a157, v4, s[40:43], s38 offen
  s_mul_i32 s27, s23, 143360
  s_add_u32 s27, s27, 3334144
  s_add_u32 s8, s4, s27
  s_addc_u32 s9, s5, 0
  s_mov_b32 s10, 143360
  s_mov_b32 s11, 0x20000
  s_and_b32 s30, s2, 7
  s_sub_u32 s27, 15, s30
  s_bitcmp1_b32 s2, 5
  s_cselect_b32 s30, s27, s30
  s_bfe_u32 s27, s2, 0x20003
  s_lshl2_add_u32 s30, s30, s27
  s_lshr_b32 s32, s2, 6
  s_sub_u32 s27, 64, s30
  s_min_u32 s33, s27, s30
  s_and_b32 s33, s33, 31
  s_mul_i32 s33, s33, 81920
  s_lshl2_add_u32 s34, s32, s20
  s_lshl_b32 s34, s34, 7
  s_add_u32 s34, s34, s30
  s_mul_i32 s34, s34, 1280
  v_mov_b32 v4, 0x80000000
  v_cmp_gt_u32 vcc, 40, v1
  s_nop 1
  v_cndmask_b32 v36, v4, v2, vcc
  s_cmp_eq_u32 s30, 32
  s_cselect_b32 s35, 0, -1
  s_cselect_b32 s37, 0, 0xbe800000
  s_cmp_gt_u32 s30, 32
  s_cselect_b32 s37, 0x3e800000, s37
  s_cmp_eq_u32 s30, 0
  s_cselect_b32 s36, 0, -1
  s_lshl_b32 s27, s32, 9
  s_add_u32 s27, s27, s30
  v_bfe_u32 v48, v0, 1, 3
  v_lshl_add_u32 v48, v48, 6, s27
  v_cvt_f32_u32 v48, v48
  v_mul_f32 v48, 0x3a000000, v48
  v_bfe_u32 v9, v0, 4, 2
  v_cvt_f32_u32 v49, v9
  v_mul_f32 v49, 4.0, v49
  v_and_b32 v4, 1, v0
  v_cvt_f32_u32 v4, v4
  v_mul_f32 v4, 0x3e800000, v4
  v_fma_f32 v49, v49, v48, v4
  v_add_f32 v50, s37, v49
  v_fmamk_f32 v53, v48, 0x3f800000, v49
  v_fmamk_f32 v54, v48, 0x40000000, v49
  v_fmamk_f32 v55, v48, 0x40400000, v49
  v_fmamk_f32 v56, v48, 0x41800000, v49
  v_fmamk_f32 v57, v48, 0x41880000, v49
  v_fmamk_f32 v58, v48, 0x41900000, v49
  v_fmamk_f32 v59, v48, 0x41980000, v49
  v_cos_f32 v52, v49
  v_cos_f32 v53, v53
  v_cos_f32 v54, v54
  v_cos_f32 v55, v55
  v_cos_f32 v56, v56
  v_cos_f32 v57, v57
  v_cos_f32 v58, v58
  v_cos_f32 v59, v59
  v_cvt_pk_bf16_f32 v40, v52, v53
  v_cvt_pk_bf16_f32 v41, v54, v55
  v_cvt_pk_bf16_f32 v42, v56, v57
  v_cvt_pk_bf16_f32 v43, v58, v59
  v_and_b32 v40, s35, v40
  v_and_b32 v41, s35, v41
  v_and_b32 v42, s35, v42
  v_and_b32 v43, s35, v43
  v_fmamk_f32 v53, v48, 0x3f800000, v50
  v_fmamk_f32 v54, v48, 0x40000000, v50
  v_fmamk_f32 v55, v48, 0x40400000, v50
  v_fmamk_f32 v56, v48, 0x41800000, v50
  v_fmamk_f32 v57, v48, 0x41880000, v50
  v_fmamk_f32 v58, v48, 0x41900000, v50
  v_fmamk_f32 v59, v48, 0x41980000, v50
  v_cos_f32 v52, v50
  v_cos_f32 v53, v53
  v_cos_f32 v54, v54
  v_cos_f32 v55, v55
  v_cos_f32 v56, v56
  v_cos_f32 v57, v57
  v_cos_f32 v58, v58
  v_cos_f32 v59, v59
  v_cvt_pk_bf16_f32 v44, v52, v53
  v_cvt_pk_bf16_f32 v45, v54, v55
  v_cvt_pk_bf16_f32 v46, v56, v57
  v_cvt_pk_bf16_f32 v47, v58, v59
  v_and_b32 v44, s36, v44
  v_and_b32 v45, s36, v45
  v_and_b32 v46, s36, v46
  v_and_b32 v47, s36, v47
  s_mul_i32 s27, s20, 320
  v_lshrrev_b32 v4, 2, v1
  v_and_b32 v5, 3, v0
  v_lshlrev_b32 v5, 3, v5
  v_lshl_add_u32 v78, v4, 8, v5
  v_and_b32 v79, 7, v4
  v_lshlrev_b32 v79, 5, v79
  s_mul_i32 s28, s20, 10
  s_add_u32 s39, s28, 0
  s_lshr_b32 s40, s39, 3
  s_and_b32 s39, s39, 7
  s_lshl_b32 s39, s39, 5
  s_lshl_b32 s40, s40, 14
  v_xor_b32 v68, s39, v79
  v_add3_u32 v68, v68, v78, s40
  s_add_u32 s39, s28, 1
  s_lshr_b32 s40, s39, 3
  s_and_b32 s39, s39, 7
  s_lshl_b32 s39, s39, 5
  s_lshl_b32 s40, s40, 14
  v_xor_b32 v69, s39, v79
  v_add3_u32 v69, v69, v78, s40
  s_add_u32 s39, s28, 2
  s_lshr_b32 s40, s39, 3
  s_and_b32 s39, s39, 7
  s_lshl_b32 s39, s39, 5
  s_lshl_b32 s40, s40, 14
  v_xor_b32 v70, s39, v79
  v_add3_u32 v70, v70, v78, s40
  s_add_u32 s39, s28, 3
  s_lshr_b32 s40, s39, 3
  s_and_b32 s39, s39, 7
  s_lshl_b32 s39, s39, 5
  s_lshl_b32 s40, s40, 14
  v_xor_b32 v71, s39, v79
  v_add3_u32 v71, v71, v78, s40
  s_add_u32 s39, s28, 4
  s_lshr_b32 s40, s39, 3
  s_and_b32 s39, s39, 7
  s_lshl_b32 s39, s39, 5
  s_lshl_b32 s40, s40, 14
  v_xor_b32 v72, s39, v79
  v_add3_u32 v72, v72, v78, s40
  s_add_u32 s39, s28, 5
  s_lshr_b32 s40, s39, 3
  s_and_b32 s39, s39, 7
  s_lshl_b32 s39, s39, 5
  s_lshl_b32 s40, s40, 14
  v_xor_b32 v73, s39, v79
  v_add3_u32 v73, v73, v78, s40
  s_add_u32 s39, s28, 6
  s_lshr_b32 s40, s39, 3
  s_and_b32 s39, s39, 7
  s_lshl_b32 s39, s39, 5
  s_lshl_b32 s40, s40, 14
  v_xor_b32 v74, s39, v79
  v_add3_u32 v74, v74, v78, s40
  s_add_u32 s39, s28, 7
  s_lshr_b32 s40, s39, 3
  s_and_b32 s39, s39, 7
  s_lshl_b32 s39, s39, 5
  s_lshl_b32 s40, s40, 14
  v_xor_b32 v75, s39, v79
  v_add3_u32 v75, v75, v78, s40
  s_add_u32 s39, s28, 8
  s_lshr_b32 s40, s39, 3
  s_and_b32 s39, s39, 7
  s_lshl_b32 s39, s39, 5
  s_lshl_b32 s40, s40, 14
  v_xor_b32 v76, s39, v79
  v_add3_u32 v76, v76, v78, s40
  s_add_u32 s39, s28, 9
  s_lshr_b32 s40, s39, 3
  s_and_b32 s39, s39, 7
  s_lshl_b32 s39, s39, 5
  s_lshl_b32 s40, s40, 14
  v_xor_b32 v77, s39, v79
  v_add3_u32 v77, v77, v78, s40
  s_lshl_b32 s28, s27, 1
  s_add_u32 s28, s28, 131200
  v_lshl_add_u32 v78, v9, 4, s28
  v_and_b32 v8, 15, v0
  v_mul_u32_u24 v79, 1288, v8
  v_lshl_add_u32 v79, v9, 3, v79
  s_add_u32 s27, s27, 94208
  v_add_u32 v79, s27, v79
  s_mul_i32 s27, s20, 5152
  s_add_u32 s27, s27, 94208
  v_lshl_add_u32 v80, v4, 6, v5
  v_add_u32 v80, s27, v80
  v_and_b32 v4, 3, v4
  v_lshl_add_u32 v81, v4, 6, v5
  s_add_u32 s27, s27, 1024
  v_add_u32 v81, s27, v81
  s_mul_i32 s27, s20, 9216
  s_add_u32 s27, s27, 114816
  v_mul_u32_u24 v82, 288, v9
  v_lshl_add_u32 v82, v8, 3, v82
  v_add_u32 v82, s27, v82
  v_mul_u32_u24 v83, 144, v8
  v_lshl_add_u32 v83, v9, 4, v83
  v_add_u32 v83, s27, v83
  v_mul_u32_u24 v84, 80, v8
  v_lshl_add_u32 v84, v9, 4, v84
  v_add_u32 v84, s27, v84
  v_min_u32 v4, 39, v1
  v_lshlrev_b32 v4, 5, v4
  v_add_u32 v85, s27, v4
  v_lshrrev_b32 v4, 1, v4
  v_add_u32 v86, 131200, v4
  v_add_u32 v87, 114816, v2
  s_add_u32 s27, s34, 81920
  buffer_load_dwordx4 v[20:23], v36, s[16:19], s34 offen offset:0
  buffer_load_dwordx4 v[24:27], v36, s[16:19], s34 offen offset:640
  buffer_load_dwordx4 v[28:31], v36, s[16:19], s27 offen offset:0
  buffer_load_dwordx4 v[32:35], v36, s[16:19], s27 offen offset:640
  s_waitcnt vmcnt(28)
  s_mul_i32 s29, s20, 24576
  s_cmp_eq_u32 s20, 3
  s_cselect_b32 s29, 89088, s29
  v_and_b32 v8, 15, v0
  v_bfe_u32 v4, v0, 1, 3
  v_lshrrev_b32 v5, 1, v9
  v_xor_b32 v4, v4, v5
  v_lshlrev_b32 v4, 4, v4
  v_lshl_add_u32 v4, v8, 7, v4
  v_and_b32 v5, 1, v9
  v_lshl_add_u32 v4, v5, 3, v4
  v_add_u32 v14, s29, v4
  v_xor_b32 v15, 32, v14
  v_xor_b32 v16, 64, v14
  v_xor_b32 v17, 96, v14
  s_waitcnt vmcnt(5)
  ds_read_b64 a[160:161], v14 offset:0
  ds_read_b64 a[162:163], v15 offset:0
  ds_read_b64 a[164:165], v14 offset:2048
  ds_read_b64 a[166:167], v15 offset:2048
  ds_read_b64 a[168:169], v16 offset:0
  ds_read_b64 a[170:171], v17 offset:0
  ds_read_b64 a[172:173], v16 offset:2048
  ds_read_b64 a[174:175], v17 offset:2048
  ds_read_b64 a[176:177], v14 offset:4096
  ds_read_b64 a[178:179], v15 offset:4096
  ds_read_b64 a[180:181], v14 offset:6144
  ds_read_b64 a[182:183], v15 offset:6144
  ds_read_b64 a[184:185], v16 offset:4096
  ds_read_b64 a[186:187], v17 offset:4096
  ds_read_b64 a[188:189], v16 offset:6144
  ds_read_b64 a[190:191], v17 offset:6144
  ds_read_b64 a[192:193], v14 offset:8192
  ds_read_b64 a[194:195], v15 offset:8192
  ds_read_b64 a[196:197], v14 offset:10240
  ds_read_b64 a[198:199], v15 offset:10240
  ds_read_b64 a[200:201], v16 offset:8192
  ds_read_b64 a[202:203], v17 offset:8192
  ds_read_b64 a[204:205], v16 offset:10240
  ds_read_b64 a[206:207], v17 offset:10240
  ds_read_b64 a[208:209], v14 offset:12288
  ds_read_b64 a[210:211], v15 offset:12288
  ds_read_b64 a[212:213], v14 offset:14336
  ds_read_b64 a[214:215], v15 offset:14336
  ds_read_b64 a[216:217], v16 offset:12288
  ds_read_b64 a[218:219], v17 offset:12288
  ds_read_b64 a[220:221], v16 offset:14336
  ds_read_b64 a[222:223], v17 offset:14336
  s_waitcnt lgkmcnt(0)
  s_cmp_lg_u32 s20, 0
  s_cbranch_scc1 kg_a_ok
  s_and_b32 s29, s2, 7
  s_lshl_b32 s29, s29, 13
  s_add_u32 s29, s29, 3031040
  v_lshlrev_b32 v6, 7, v1
  v_add_u32 v15, 8192, v6
  v_add_u32 v16, 16384, v6
  v_add_u32 v17, 24576, v6
  buffer_load_dwordx4 v[10:13], v6, s[4:7], s29 offen sc0 sc1
  s_mov_b32 s31, 0
  s_waitcnt vmcnt(0)
  v_xor_b32 v10, s3, v10
  v_xor_b32 v11, s3, v11
  v_xor_b32 v12, s3, v12
  v_xor_b32 v13, s3, v13
  v_or_b32 v10, v10, v11
  v_or_b32 v10, v10, v12
  v_or_b32 v10, v10, v13
  v_cmp_ne_u32 vcc, 0, v10
  s_nop 0
  s_cmp_eq_u64 vcc, 0
  s_cbranch_scc1 kg_a_ok
kg_a_again:
  s_sleep 2
  buffer_load_dwordx4 v[10:13], v6, s[4:7], s29 offen sc0 sc1
  s_add_u32 s31, s31, 1
  s_waitcnt vmcnt(0)
  v_xor_b32 v10, s3, v10
  v_xor_b32 v11, s3, v11
  v_xor_b32 v12, s3, v12
  v_xor_b32 v13, s3, v13
  v_or_b32 v10, v10, v11
  v_or_b32 v10, v10, v12
  v_or_b32 v10, v10, v13
  v_cmp_ne_u32 vcc, 0, v10
  s_nop 0
  s_cmp_eq_u64 vcc, 0
  s_cbranch_scc1 kg_a_ok
  s_cmp_lt_u32 s31, 100000
  s_cbranch_scc1 kg_a_again
kg_a_ok:
  s_barrier
  s_lshl_b32 s28, s20, 12
  s_add_u32 m0, s28, 131200
  s_add_u32 s27, s28, 2621440
  buffer_load_dwordx4 v2, s[4:7], s27 offen offset:0 sc1 lds
  buffer_load_dwordx4 v2, s[4:7], s27 offen offset:1024 sc1 lds
  buffer_load_dwordx4 v2, s[4:7], s27 offen offset:2048 sc1 lds
  buffer_load_dwordx4 v2, s[4:7], s27 offen offset:3072 sc1 lds
  s_mul_i32 s38, s20, 20480
  s_mov_b32 m0, s38
  s_add_u32 s38, s38, s33
  buffer_load_dwordx4 v2, s[4:7], s38 offen offset:0 sc1 lds
  buffer_load_dwordx4 v2, s[4:7], s38 offen offset:1024 sc1 lds
  buffer_load_dwordx4 v2, s[4:7], s38 offen offset:2048 sc1 lds
  buffer_load_dwordx4 v2, s[4:7], s38 offen offset:3072 sc1 lds
  s_add_u32 m0, m0, 4096
  s_add_u32 s38, s38, 4096
  buffer_load_dwordx4 v2, s[4:7], s38 offen offset:0 sc1 lds
  buffer_load_dwordx4 v2, s[4:7], s38 offen offset:1024 sc1 lds
  buffer_load_dwordx4 v2, s[4:7], s38 offen offset:2048 sc1 lds
  buffer_load_dwordx4 v2, s[4:7], s38 offen offset:3072 sc1 lds
  s_add_u32 m0, m0, 4096
  s_add_u32 s38, s38, 4096
  buffer_load_dwordx4 v2, s[4:7], s38 offen offset:0 sc1 lds
  buffer_load_dwordx4 v2, s[4:7], s38 offen offset:1024 sc1 lds
  buffer_load_dwordx4 v2, s[4:7], s38 offen offset:2048 sc1 lds
  buffer_load_dwordx4 v2, s[4:7], s38 offen offset:3072 sc1 lds
  s_add_u32 m0, m0, 4096
  s_add_u32 s38, s38, 4096
  buffer_load_dwordx4 v2, s[4:7], s38 offen offset:0 sc1 lds
  buffer_load_dwordx4 v2, s[4:7], s38 offen offset:1024 sc1 lds
  buffer_load_dwordx4 v2, s[4:7], s38 offen offset:2048 sc1 lds
  buffer_load_dwordx4 v2, s[4:7], s38 offen offset:3072 sc1 lds
  s_add_u32 m0, m0, 4096
  s_add_u32 s38, s38, 4096
  buffer_load_dwordx4 v2, s[4:7], s38 offen offset:0 sc1 lds
  buffer_load_dwordx4 v2, s[4:7], s38 offen offset:1024 sc1 lds
  buffer_load_dwordx4 v2, s[4:7], s38 offen offset:2048 sc1 lds
  buffer_load_dwordx4 v2, s[4:7], s38 offen offset:3072 sc1 lds
  ds_read_b128 a[80:83], v87 offset:0
  ds_read_b128 a[84:87], v87 offset:1024
  ds_read_b128 a[88:91], v87 offset:2048
  ds_read_b128 a[92:95], v87 offset:3072
  ds_read_b128 a[96:99], v87 offset:4096
  ds_read_b128 a[100:103], v87 offset:5120
  ds_read_b128 v[168:171], v87 offset:10240
  ds_read_b128 v[172:175], v87 offset:11264
  ds_read_b128 v[176:179], v87 offset:12288
  ds_read_b128 v[180:183], v87 offset:13312
  ds_read_b128 v[184:187], v87 offset:14336
  ds_read_b128 v[188:191], v87 offset:15360
  ds_read_b128 a[104:107], v87 offset:6144
  ds_read_b128 a[108:111], v87 offset:7168
  ds_read_b128 a[112:115], v87 offset:8192
  ds_read_b128 a[116:119], v87 offset:9216
  s_waitcnt vmcnt(20)
  s_barrier
  ds_read_b128 v[88:91], v78 offset:2560
  ds_read_b128 v[92:95], v78 offset:2624
  ds_read_b128 v[96:99], v78 offset:2688
  ds_read_b128 v[100:103], v78 offset:2752
  ds_read_b128 v[104:107], v78 offset:2816
  ds_read_b128 v[108:111], v78 offset:2880
  ds_read_b128 v[112:115], v78 offset:2944
  ds_read_b128 v[116:119], v78 offset:3008
  ds_read_b128 v[120:123], v78 offset:3072
  ds_read_b128 v[124:127], v78 offset:3136
  ds_read_b128 v[192:195], v86 offset:5120
  ds_read_b128 v[196:199], v86 offset:5760
  ds_read_b128 v[200:203], v86 offset:6400
  ds_read_b128 v[204:207], v86 offset:7040
  ds_read_b128 v[224:227], v86 offset:7680
  ds_read_b128 v[228:231], v86 offset:8320
  ds_read_b128 v[232:235], v86 offset:8960
  ds_read_b128 v[236:239], v86 offset:9600
  ds_read_b128 v[208:211], v86 offset:10240
  ds_read_b128 v[212:215], v86 offset:10880
  ds_read_b128 v[216:219], v86 offset:11520
  ds_read_b128 v[220:223], v86 offset:12160
  s_cmp_eq_u32 s24, -1
  s_cbranch_scc1 pa_fin
  v_bfe_u32 v4, v0, 2, 2
  v_bfe_u32 v5, v0, 4, 2
  v_lshl_add_u32 v4, v5, 3, v4
  v_mul_u32_u24 v4, 224, v4
  s_mul_i32 s28, s20, 65664
  s_add_u32 s28, s28, 16256
  v_and_b32 v5, 3, v0
  v_lshlrev_b32 v5, 3, v5
  v_add3_u32 v48, v4, v5, s28
  v_bfe_u32 v5, v0, 1, 1
  s_and_b32 s39, s24, 15
  s_and_b32 s27, s39, 1
  v_xor_b32 v5, s27, v5
  v_mul_u32_u24 v5, 112, v5
  v_add3_u32 v49, v4, v5, s28
  v_and_b32 v5, 1, v0
  v_lshl_add_u32 v49, v5, 3, v49
  s_waitcnt vmcnt(24)
  ds_read_b64_tr_b16 a[0:1], v48 offset:0
  ds_read_b64_tr_b16 a[2:3], v48 offset:896
  ds_read_b64_tr_b16 a[4:5], v48 offset:32
  ds_read_b64_tr_b16 a[6:7], v48 offset:928
  ds_read_b64_tr_b16 a[8:9], v48 offset:64
  ds_read_b64_tr_b16 a[10:11], v48 offset:960
  ds_read_b64_tr_b16 a[12:13], v49 offset:96
  ds_read_b64_tr_b16 a[14:15], v49 offset:992
  ds_read_b64_tr_b16 a[16:17], v48 offset:112
  ds_read_b64_tr_b16 a[18:19], v48 offset:1008
  ds_read_b64_tr_b16 a[20:21], v48 offset:144
  ds_read_b64_tr_b16 a[22:23], v48 offset:1040
  ds_read_b64_tr_b16 a[24:25], v48 offset:176
  ds_read_b64_tr_b16 a[26:27], v48 offset:1072
  s_and_b32 s35, s39, 3
  s_mul_i32 s39, s39, 143360
  s_add_u32 s39, s39, 3334144
  s_lshr_b32 s36, s24, 4
  s_mul_i32 s27, s36, 3072
  s_add_u32 s27, s27, s39
  s_lshl_b32 s28, s36, 12
  s_add_u32 s28, s28, s39
  s_add_u32 s28, s28, 61440
  s_cmp_lg_u32 s35, 3
  s_cbranch_scc1 pa_keep
  s_waitcnt lgkmcnt(7)
  v_accvgpr_write_b32 a12, 0
  v_accvgpr_write_b32 a13, 0
  s_waitcnt lgkmcnt(6)
  v_accvgpr_write_b32 a14, 0
  v_accvgpr_write_b32 a15, 0
pa_keep:
  s_waitcnt lgkmcnt(12)
  buffer_store_dwordx4 a[0:3], v2, s[4:7], s28 offen offset:0 sc1
  s_waitcnt lgkmcnt(10)
  buffer_store_dwordx4 a[4:7], v2, s[4:7], s28 offen offset:1024 sc1
  s_waitcnt lgkmcnt(8)
  buffer_store_dwordx4 a[8:11], v2, s[4:7], s28 offen offset:2048 sc1
  s_waitcnt lgkmcnt(6)
  buffer_store_dwordx4 a[12:15], v2, s[4:7], s28 offen offset:3072 sc1
  s_waitcnt lgkmcnt(4)
  buffer_store_dwordx4 a[16:19], v2, s[4:7], s27 offen offset:0 sc1
  s_waitcnt lgkmcnt(2)
  buffer_store_dwordx4 a[20:23], v2, s[4:7], s27 offen offset:1024 sc1
  s_waitcnt lgkmcnt(0)
  buffer_store_dwordx4 a[24:27], v2, s[4:7], s27 offen offset:2048 sc1
  s_branch pa_fin2
pa_fin:
  s_waitcnt vmcnt(0)
pa_fin2:
  s_waitcnt vmcnt(7)
  s_barrier
  ds_read_b64_tr_b16 a[0:1], v68 offset:0
  ds_read_b64_tr_b16 a[2:3], v68 offset:4096
  ds_read_b64_tr_b16 a[4:5], v68 offset:8192
  ds_read_b64_tr_b16 a[6:7], v68 offset:12288
  ds_read_b64_tr_b16 a[8:9], v69 offset:0
  ds_read_b64_tr_b16 a[10:11], v69 offset:4096
  ds_read_b64_tr_b16 a[12:13], v69 offset:8192
  ds_read_b64_tr_b16 a[14:15], v69 offset:12288
  ds_read_b64_tr_b16 a[16:17], v70 offset:0
  ds_read_b64_tr_b16 a[18:19], v70 offset:4096
  ds_read_b64_tr_b16 a[20:21], v70 offset:8192
  ds_read_b64_tr_b16 a[22:23], v70 offset:12288
  ds_read_b64_tr_b16 a[24:25], v71 offset:0
  ds_read_b64_tr_b16 a[26:27], v71 offset:4096
  ds_read_b64_tr_b16 a[28:29], v71 offset:8192
  ds_read_b64_tr_b16 a[30:31], v71 offset:12288
  ds_read_b64_tr_b16 a[32:33], v72 offset:0
  ds_read_b64_tr_b16 a[34:35], v72 offset:4096
  ds_read_b64_tr_b16 a[36:37], v72 offset:8192
  ds_read_b64_tr_b16 a[38:39], v72 offset:12288
  ds_read_b64_tr_b16 a[40:41], v73 offset:0
  ds_read_b64_tr_b16 a[42:43], v73 offset:4096
  ds_read_b64_tr_b16 a[44:45], v73 offset:8192
  ds_read_b64_tr_b16 a[46:47], v73 offset:12288
  ds_read_b64_tr_b16 a[48:49], v74 offset:0
  ds_read_b64_tr_b16 a[50:51], v74 offset:4096
  ds_read_b64_tr_b16 a[52:53], v74 offset:8192
  ds_read_b64_tr_b16 a[54:55], v74 offset:12288
  ds_read_b64_tr_b16 a[56:57], v75 offset:0
  ds_read_b64_tr_b16 a[58:59], v75 offset:4096
  ds_read_b64_tr_b16 a[60:61], v75 offset:8192
  ds_read_b64_tr_b16 a[62:63], v75 offset:12288
  ds_read_b64_tr_b16 a[64:65], v76 offset:0
  ds_read_b64_tr_b16 a[66:67], v76 offset:4096
  ds_read_b64_tr_b16 a[68:69], v76 offset:8192
  ds_read_b64_tr_b16 a[70:71], v76 offset:12288
  ds_read_b64_tr_b16 a[72:73], v77 offset:0
  ds_read_b64_tr_b16 a[74:75], v77 offset:4096
  ds_read_b64_tr_b16 a[76:77], v77 offset:8192
  ds_read_b64_tr_b16 a[78:79], v77 offset:12288
  s_waitcnt lgkmcnt(15)
  v_mfma_f32_16x16x32_bf16 v[128:131], a[0:3], v[40:43], 0
  v_mfma_f32_16x16x32_bf16 v[128:131], a[4:7], v[44:47], v[128:131]
  v_mfma_f32_16x16x32_bf16 v[132:135], a[8:11], v[40:43], 0
  v_mfma_f32_16x16x32_bf16 v[132:135], a[12:15], v[44:47], v[132:135]
  v_mfma_f32_16x16x32_bf16 v[136:139], a[16:19], v[40:43], 0
  v_mfma_f32_16x16x32_bf16 v[136:139], a[20:23], v[44:47], v[136:139]
  v_mfma_f32_16x16x32_bf16 v[140:143], a[24:27], v[40:43], 0
  v_mfma_f32_16x16x32_bf16 v[140:143], a[28:31], v[44:47], v[140:143]
  v_mfma_f32_16x16x32_bf16 v[144:147], a[32:35], v[40:43], 0
  v_mfma_f32_16x16x32_bf16 v[144:147], a[36:39], v[44:47], v[144:147]
  v_mfma_f32_16x16x32_bf16 v[148:151], a[40:43], v[40:43], 0
  v_mfma_f32_16x16x32_bf16 v[148:151], a[44:47], v[44:47], v[148:151]
  s_waitcnt lgkmcnt(14)
  v_mfma_f32_16x16x32_bf16 v[152:155], a[48:51], v[40:43], 0
  s_waitcnt lgkmcnt(12)
  v_mfma_f32_16x16x32_bf16 v[152:155], a[52:55], v[44:47], v[152:155]
  s_waitcnt lgkmcnt(10)
  v_mfma_f32_16x16x32_bf16 v[156:159], a[56:59], v[40:43], 0
  s_waitcnt lgkmcnt(8)
  v_mfma_f32_16x16x32_bf16 v[156:159], a[60:63], v[44:47], v[156:159]
  s_waitcnt lgkmcnt(6)
  v_mfma_f32_16x16x32_bf16 v[160:163], a[64:67], v[40:43], 0
  s_waitcnt lgkmcnt(4)
  v_mfma_f32_16x16x32_bf16 v[160:163], a[68:71], v[44:47], v[160:163]
  s_waitcnt lgkmcnt(2)
  v_mfma_f32_16x16x32_bf16 v[164:167], a[72:75], v[40:43], 0
  s_waitcnt lgkmcnt(0)
  v_mfma_f32_16x16x32_bf16 v[164:167], a[76:79], v[44:47], v[164:167]
  s_cmp_eq_u32 s24, -1
  s_cbranch_scc1 pa_nofl
  s_lshl_b32 s27, s24, 7
  s_add_u32 s27, s27, 3293184
  v_mov_b32 v4, 0
  v_mov_b32 v5, s3
  s_waitcnt vmcnt(0)
  s_mov_b64 exec, 1
  buffer_store_dword v5, v4, s[4:7], s27 offen sc0 sc1
  s_mov_b64 exec, -1
pa_nofl:
  v_pk_mul_f32 v[128:129], v[128:129], v[88:89]
  v_pk_mul_f32 v[130:131], v[130:131], v[90:91]
  v_pk_mul_f32 v[132:133], v[132:133], v[92:93]
  v_pk_mul_f32 v[134:135], v[134:135], v[94:95]
  v_pk_mul_f32 v[136:137], v[136:137], v[96:97]
  v_pk_mul_f32 v[138:139], v[138:139], v[98:99]
  v_pk_mul_f32 v[140:141], v[140:141], v[100:101]
  v_pk_mul_f32 v[142:143], v[142:143], v[102:103]
  v_pk_mul_f32 v[144:145], v[144:145], v[104:105]
  v_pk_mul_f32 v[146:147], v[146:147], v[106:107]
  v_pk_mul_f32 v[148:149], v[148:149], v[108:109]
  v_pk_mul_f32 v[150:151], v[150:151], v[110:111]
  v_pk_mul_f32 v[152:153], v[152:153], v[112:113]
  v_pk_mul_f32 v[154:155], v[154:155], v[114:115]
  v_pk_mul_f32 v[156:157], v[156:157], v[116:117]
  v_pk_mul_f32 v[158:159], v[158:159], v[118:119]
  v_pk_mul_f32 v[160:161], v[160:161], v[120:121]
  v_pk_mul_f32 v[162:163], v[162:163], v[122:123]
  v_pk_mul_f32 v[164:165], v[164:165], v[124:125]
  v_pk_mul_f32 v[166:167], v[166:167], v[126:127]
  s_cmp_lg_u32 s2, 0
  s_cbranch_scc1 pb_nodc
  ds_read_b128 v[88:91], v78 offset:0
  ds_read_b128 v[92:95], v78 offset:64
  ds_read_b128 v[96:99], v78 offset:128
  ds_read_b128 v[100:103], v78 offset:192
  ds_read_b128 v[104:107], v78 offset:256
  ds_read_b128 v[108:111], v78 offset:320
  ds_read_b128 v[112:115], v78 offset:384
  ds_read_b128 v[116:119], v78 offset:448
  ds_read_b128 v[120:123], v78 offset:512
  ds_read_b128 v[124:127], v78 offset:576
  v_cmp_eq_u32 vcc, 0, v8
  v_mov_b32 v4, 0x45000000
  s_nop 0
  v_cndmask_b32 v4, 0, v4, vcc
  s_waitcnt lgkmcnt(9)
  v_fmac_f32 v128, v88, v4
  v_fmac_f32 v129, v89, v4
  v_fmac_f32 v130, v90, v4
  v_fmac_f32 v131, v91, v4
  s_waitcnt lgkmcnt(8)
  v_fmac_f32 v132, v92, v4
  v_fmac_f32 v133, v93, v4
  v_fmac_f32 v134, v94, v4
  v_fmac_f32 v135, v95, v4
  s_waitcnt lgkmcnt(7)
  v_fmac_f32 v136, v96, v4
  v_fmac_f32 v137, v97, v4
  v_fmac_f32 v138, v98, v4
  v_fmac_f32 v139, v99, v4
  s_waitcnt lgkmcnt(6)
  v_fmac_f32 v140, v100, v4
  v_fmac_f32 v141, v101, v4
  v_fmac_f32 v142, v102, v4
  v_fmac_f32 v143, v103, v4
  s_waitcnt lgkmcnt(5)
  v_fmac_f32 v144, v104, v4
  v_fmac_f32 v145, v105, v4
  v_fmac_f32 v146, v106, v4
  v_fmac_f32 v147, v107, v4
  s_waitcnt lgkmcnt(4)
  v_fmac_f32 v148, v108, v4
  v_fmac_f32 v149, v109, v4
  v_fmac_f32 v150, v110, v4
  v_fmac_f32 v151, v111, v4
  s_waitcnt lgkmcnt(3)
  v_fmac_f32 v152, v112, v4
  v_fmac_f32 v153, v113, v4
  v_fmac_f32 v154, v114, v4
  v_fmac_f32 v155, v115, v4
  s_waitcnt lgkmcnt(2)
  v_fmac_f32 v156, v116, v4
  v_fmac_f32 v157, v117, v4
  v_fmac_f32 v158, v118, v4
  v_fmac_f32 v159, v119, v4
  s_waitcnt lgkmcnt(1)
  v_fmac_f32 v160, v120, v4
  v_fmac_f32 v161, v121, v4
  v_fmac_f32 v162, v122, v4
  v_fmac_f32 v163, v123, v4
  s_waitcnt lgkmcnt(0)
  v_fmac_f32 v164, v124, v4
  v_fmac_f32 v165, v125, v4
  v_fmac_f32 v166, v126, v4
  v_fmac_f32 v167, v127, v4
pb_nodc:
  v_cvt_pk_bf16_f32 v128, v128, v129
  v_cvt_pk_bf16_f32 v129, v130, v131
  ds_write_b64 v79, v[128:129] offset:0
  v_cvt_pk_bf16_f32 v132, v132, v133
  v_cvt_pk_bf16_f32 v133, v134, v135
  ds_write_b64 v79, v[132:133] offset:32
  v_cvt_pk_bf16_f32 v136, v136, v137
  v_cvt_pk_bf16_f32 v137, v138, v139
  ds_write_b64 v79, v[136:137] offset:64
  v_cvt_pk_bf16_f32 v140, v140, v141
  v_cvt_pk_bf16_f32 v141, v142, v143
  ds_write_b64 v79, v[140:141] offset:96
  v_cvt_pk_bf16_f32 v144, v144, v145
  v_cvt_pk_bf16_f32 v145, v146, v147
  ds_write_b64 v79, v[144:145] offset:128
  v_cvt_pk_bf16_f32 v148, v148, v149
  v_cvt_pk_bf16_f32 v149, v150, v151
  ds_write_b64 v79, v[148:149] offset:160
  v_cvt_pk_bf16_f32 v152, v152, v153
  v_cvt_pk_bf16_f32 v153, v154, v155
  ds_write_b64 v79, v[152:153] offset:192
  v_cvt_pk_bf16_f32 v156, v156, v157
  v_cvt_pk_bf16_f32 v157, v158, v159
  ds_write_b64 v79, v[156:157] offset:224
  v_cvt_pk_bf16_f32 v160, v160, v161
  v_cvt_pk_bf16_f32 v161, v162, v163
  ds_write_b64 v79, v[160:161] offset:256
  v_cvt_pk_bf16_f32 v164, v164, v165
  v_cvt_pk_bf16_f32 v165, v166, v167
  ds_write_b64 v79, v[164:165] offset:288
  s_waitcnt lgkmcnt(0)
  s_barrier
  ds_read_b64_tr_b16 a[120:121], v80 offset:0
  ds_read_b64_tr_b16 a[122:123], v81 offset:0
  ds_read_b64_tr_b16 a[128:129], v80 offset:32
  ds_read_b64_tr_b16 a[130:131], v81 offset:32
  ds_read_b64_tr_b16 a[124:125], v80 offset:1288
  ds_read_b64_tr_b16 a[126:127], v81 offset:1288
  ds_read_b64_tr_b16 a[132:133], v80 offset:1320
  ds_read_b64_tr_b16 a[134:135], v81 offset:1320
  ds_read_b64_tr_b16 a[136:137], v80 offset:2576
  ds_read_b64_tr_b16 a[138:139], v81 offset:2576
  ds_read_b64_tr_b16 a[144:145], v80 offset:2608
  ds_read_b64_tr_b16 a[146:147], v81 offset:2608
  ds_read_b64_tr_b16 a[140:141], v80 offset:3864
  ds_read_b64_tr_b16 a[142:143], v81 offset:3864
  ds_read_b64_tr_b16 a[148:149], v80 offset:3896
  ds_read_b64_tr_b16 a[150:151], v81 offset:3896
  v_lshlrev_b32 v240, 16, v28
  v_and_b32 v241, 0xffff0000, v28
  v_lshlrev_b32 v242, 16, v29
  v_and_b32 v243, 0xffff0000, v29
  v_lshlrev_b32 v244, 16, v30
  v_and_b32 v245, 0xffff0000, v30
  v_lshlrev_b32 v246, 16, v31
  v_and_b32 v247, 0xffff0000, v31
  v_lshlrev_b32 v248, 16, v32
  v_and_b32 v249, 0xffff0000, v32
  v_lshlrev_b32 v250, 16, v33
  v_and_b32 v251, 0xffff0000, v33
  v_lshlrev_b32 v252, 16, v34
  v_and_b32 v253, 0xffff0000, v34
  v_lshlrev_b32 v254, 16, v35
  v_and_b32 v255, 0xffff0000, v35
  s_waitcnt lgkmcnt(14)
  v_mfma_f32_16x16x32_bf16 v[88:91], a[80:83], a[120:123], 0
  s_waitcnt lgkmcnt(12)
  v_mfma_f32_16x16x32_bf16 v[92:95], a[80:83], a[128:131], 0
  s_waitcnt lgkmcnt(10)
  v_mfma_f32_16x16x32_bf16 v[88:91], a[84:87], a[124:127], v[88:91]
  s_waitcnt lgkmcnt(8)
  v_mfma_f32_16x16x32_bf16 v[92:95], a[84:87], a[132:135], v[92:95]
  v_mfma_f32_16x16x32_bf16 v[96:99], a[88:91], a[120:123], 0
  v_mfma_f32_16x16x32_bf16 v[100:103], a[88:91], a[128:131], 0
  v_mfma_f32_16x16x32_bf16 v[96:99], a[92:95], a[124:127], v[96:99]
  v_mfma_f32_16x16x32_bf16 v[100:103], a[92:95], a[132:135], v[100:103]
  v_mfma_f32_16x16x32_bf16 v[104:107], a[96:99], a[120:123], 0
  v_mfma_f32_16x16x32_bf16 v[108:111], a[96:99], a[128:131], 0
  v_mfma_f32_16x16x32_bf16 v[104:107], a[100:103], a[124:127], v[104:107]
  v_mfma_f32_16x16x32_bf16 v[108:111], a[100:103], a[132:135], v[108:111]
  s_waitcnt lgkmcnt(6)
  v_mfma_f32_16x16x32_bf16 v[112:115], a[80:83], a[136:139], 0
  s_waitcnt lgkmcnt(4)
  v_mfma_f32_16x16x32_bf16 v[116:119], a[80:83], a[144:147], 0
  s_waitcnt lgkmcnt(2)
  v_mfma_f32_16x16x32_bf16 v[112:115], a[84:87], a[140:143], v[112:115]
  s_waitcnt lgkmcnt(0)
  v_mfma_f32_16x16x32_bf16 v[116:119], a[84:87], a[148:151], v[116:119]
  v_mfma_f32_16x16x32_bf16 v[120:123], a[88:91], a[136:139], 0
  v_mfma_f32_16x16x32_bf16 v[124:127], a[88:91], a[144:147], 0
  v_mfma_f32_16x16x32_bf16 v[120:123], a[92:95], a[140:143], v[120:123]
  v_mfma_f32_16x16x32_bf16 v[124:127], a[92:95], a[148:151], v[124:127]
  v_mfma_f32_16x16x32_bf16 v[128:131], a[96:99], a[136:139], 0
  v_mfma_f32_16x16x32_bf16 v[132:135], a[96:99], a[144:147], 0
  v_mfma_f32_16x16x32_bf16 v[128:131], a[100:103], a[140:143], v[128:131]
  v_mfma_f32_16x16x32_bf16 v[132:135], a[100:103], a[148:151], v[132:135]
  v_min_u32 v6, 19, v1
  v_lshlrev_b32 v6, 11, v6
  s_lshl_b32 s29, s23, 7
  s_add_u32 s29, s29, 3293184
  buffer_load_dword v7, v6, s[4:7], s29 offen sc0 sc1
  v_pk_mul_f32 v[52:53], v[88:89], v[168:169] op_sel_hi:[1,0]
  v_pk_mul_f32 v[54:55], v[90:91], v[170:171] op_sel_hi:[1,0]
  v_pk_mul_f32 v[56:57], v[92:93], v[172:173] op_sel_hi:[1,0]
  v_pk_mul_f32 v[58:59], v[94:95], v[174:175] op_sel_hi:[1,0]
  v_pk_fma_f32 v[52:53], v[88:89], v[168:169], v[52:53] op_sel:[1,1,0] op_sel_hi:[0,1,1] neg_hi:[1,0,0]
  v_pk_fma_f32 v[54:55], v[90:91], v[170:171], v[54:55] op_sel:[1,1,0] op_sel_hi:[0,1,1] neg_hi:[1,0,0]
  v_pk_fma_f32 v[56:57], v[92:93], v[172:173], v[56:57] op_sel:[1,1,0] op_sel_hi:[0,1,1] neg_hi:[1,0,0]
  v_pk_fma_f32 v[58:59], v[94:95], v[174:175], v[58:59] op_sel:[1,1,0] op_sel_hi:[0,1,1] neg_hi:[1,0,0]
  v_cvt_pk_bf16_f32 v88, v52, v53
  v_cvt_pk_bf16_f32 v90, v54, v55
  v_cvt_pk_bf16_f32 v89, v56, v57
  v_cvt_pk_bf16_f32 v91, v58, v59
  ds_write_b64 v82, v[88:89] offset:0
  ds_write_b64 v82, v[90:91] offset:144
  v_pk_mul_f32 v[60:61], v[96:97], v[176:177] op_sel_hi:[1,0]
  v_pk_mul_f32 v[62:63], v[98:99], v[178:179] op_sel_hi:[1,0]
  v_pk_mul_f32 v[64:65], v[100:101], v[180:181] op_sel_hi:[1,0]
  v_pk_mul_f32 v[66:67], v[102:103], v[182:183] op_sel_hi:[1,0]
  v_pk_fma_f32 v[60:61], v[96:97], v[176:177], v[60:61] op_sel:[1,1,0] op_sel_hi:[0,1,1] neg_hi:[1,0,0]
  v_pk_fma_f32 v[62:63], v[98:99], v[178:179], v[62:63] op_sel:[1,1,0] op_sel_hi:[0,1,1] neg_hi:[1,0,0]
  v_pk_fma_f32 v[64:65], v[100:101], v[180:181], v[64:65] op_sel:[1,1,0] op_sel_hi:[0,1,1] neg_hi:[1,0,0]
  v_pk_fma_f32 v[66:67], v[102:103], v[182:183], v[66:67] op_sel:[1,1,0] op_sel_hi:[0,1,1] neg_hi:[1,0,0]
  v_cvt_pk_bf16_f32 v96, v60, v61
  v_cvt_pk_bf16_f32 v98, v62, v63
  v_cvt_pk_bf16_f32 v97, v64, v65
  v_cvt_pk_bf16_f32 v99, v66, v67
  ds_write_b64 v82, v[96:97] offset:1152
  ds_write_b64 v82, v[98:99] offset:1296
  v_pk_mul_f32 v[52:53], v[104:105], v[184:185] op_sel_hi:[1,0]
  v_pk_mul_f32 v[54:55], v[106:107], v[186:187] op_sel_hi:[1,0]
  v_pk_mul_f32 v[56:57], v[108:109], v[188:189] op_sel_hi:[1,0]
  v_pk_mul_f32 v[58:59], v[110:111], v[190:191] op_sel_hi:[1,0]
  v_pk_fma_f32 v[52:53], v[104:105], v[184:185], v[52:53] op_sel:[1,1,0] op_sel_hi:[0,1,1] neg_hi:[1,0,0]
  v_pk_fma_f32 v[54:55], v[106:107], v[186:187], v[54:55] op_sel:[1,1,0] op_sel_hi:[0,1,1] neg_hi:[1,0,0]
  v_pk_fma_f32 v[56:57], v[108:109], v[188:189], v[56:57] op_sel:[1,1,0] op_sel_hi:[0,1,1] neg_hi:[1,0,0]
  v_pk_fma_f32 v[58:59], v[110:111], v[190:191], v[58:59] op_sel:[1,1,0] op_sel_hi:[0,1,1] neg_hi:[1,0,0]
  v_cvt_pk_bf16_f32 v104, v52, v53
  v_cvt_pk_bf16_f32 v106, v54, v55
  v_cvt_pk_bf16_f32 v105, v56, v57
  v_cvt_pk_bf16_f32 v107, v58, v59
  ds_write_b64 v82, v[104:105] offset:2304
  ds_write_b64 v82, v[106:107] offset:2448
  ds_read_b128 a[120:123], v83 offset:0
  ds_read_b128 a[128:131], v83 offset:2304
  ds_read_b128 a[124:127], v83 offset:64
  ds_read_b128 a[132:135], v83 offset:2368
  v_pk_mul_f32 v[52:53], v[112:113], v[168:169] op_sel_hi:[1,0]
  v_pk_mul_f32 v[54:55], v[114:115], v[170:171] op_sel_hi:[1,0]
  v_pk_mul_f32 v[56:57], v[116:117], v[172:173] op_sel_hi:[1,0]
  v_pk_mul_f32 v[58:59], v[118:119], v[174:175] op_sel_hi:[1,0]
  v_pk_fma_f32 v[52:53], v[112:113], v[168:169], v[52:53] op_sel:[1,1,0] op_sel_hi:[0,1,1] neg_hi:[1,0,0]
  v_pk_fma_f32 v[54:55], v[114:115], v[170:171], v[54:55] op_sel:[1,1,0] op_sel_hi:[0,1,1] neg_hi:[1,0,0]
  v_pk_fma_f32 v[56:57], v[116:117], v[172:173], v[56:57] op_sel:[1,1,0] op_sel_hi:[0,1,1] neg_hi:[1,0,0]
  v_pk_fma_f32 v[58:59], v[118:119], v[174:175], v[58:59] op_sel:[1,1,0] op_sel_hi:[0,1,1] neg_hi:[1,0,0]
  v_cvt_pk_bf16_f32 v112, v52, v53
  v_cvt_pk_bf16_f32 v114, v54, v55
  v_cvt_pk_bf16_f32 v113, v56, v57
  v_cvt_pk_bf16_f32 v115, v58, v59
  ds_write_b64 v82, v[112:113] offset:4608
  ds_write_b64 v82, v[114:115] offset:4752
  v_pk_mul_f32 v[60:61], v[120:121], v[176:177] op_sel_hi:[1,0]
  v_pk_mul_f32 v[62:63], v[122:123], v[178:179] op_sel_hi:[1,0]
  v_pk_mul_f32 v[64:65], v[124:125], v[180:181] op_sel_hi:[1,0]
  v_pk_mul_f32 v[66:67], v[126:127], v[182:183] op_sel_hi:[1,0]
  v_pk_fma_f32 v[60:61], v[120:121], v[176:177], v[60:61] op_sel:[1,1,0] op_sel_hi:[0,1,1] neg_hi:[1,0,0]
  v_pk_fma_f32 v[62:63], v[122:123], v[178:179], v[62:63] op_sel:[1,1,0] op_sel_hi:[0,1,1] neg_hi:[1,0,0]
  v_pk_fma_f32 v[64:65], v[124:125], v[180:181], v[64:65] op_sel:[1,1,0] op_sel_hi:[0,1,1] neg_hi:[1,0,0]
  v_pk_fma_f32 v[66:67], v[126:127], v[182:183], v[66:67] op_sel:[1,1,0] op_sel_hi:[0,1,1] neg_hi:[1,0,0]
  v_cvt_pk_bf16_f32 v120, v60, v61
  v_cvt_pk_bf16_f32 v122, v62, v63
  v_cvt_pk_bf16_f32 v121, v64, v65
  v_cvt_pk_bf16_f32 v123, v66, v67
  ds_write_b64 v82, v[120:121] offset:5760
  ds_write_b64 v82, v[122:123] offset:5904
  v_pk_mul_f32 v[52:53], v[128:129], v[184:185] op_sel_hi:[1,0]
  v_pk_mul_f32 v[54:55], v[130:131], v[186:187] op_sel_hi:[1,0]
  v_pk_mul_f32 v[56:57], v[132:133], v[188:189] op_sel_hi:[1,0]
  v_pk_mul_f32 v[58:59], v[134:135], v[190:191] op_sel_hi:[1,0]
  v_pk_fma_f32 v[52:53], v[128:129], v[184:185], v[52:53] op_sel:[1,1,0] op_sel_hi:[0,1,1] neg_hi:[1,0,0]
  v_pk_fma_f32 v[54:55], v[130:131], v[186:187], v[54:55] op_sel:[1,1,0] op_sel_hi:[0,1,1] neg_hi:[1,0,0]
  v_pk_fma_f32 v[56:57], v[132:133], v[188:189], v[56:57] op_sel:[1,1,0] op_sel_hi:[0,1,1] neg_hi:[1,0,0]
  v_pk_fma_f32 v[58:59], v[134:135], v[190:191], v[58:59] op_sel:[1,1,0] op_sel_hi:[0,1,1] neg_hi:[1,0,0]
  v_cvt_pk_bf16_f32 v128, v52, v53
  v_cvt_pk_bf16_f32 v130, v54, v55
  v_cvt_pk_bf16_f32 v129, v56, v57
  v_cvt_pk_bf16_f32 v131, v58, v59
  ds_write_b64 v82, v[128:129] offset:6912
  ds_write_b64 v82, v[130:131] offset:7056
  ds_read_b128 a[136:139], v83 offset:4608
  ds_read_b128 a[144:147], v83 offset:6912
  ds_read_b128 a[140:143], v83 offset:4672
  ds_read_b128 a[148:151], v83 offset:6976
  s_waitcnt lgkmcnt(13)
  v_mfma_f32_16x16x32_bf16 v[136:139], a[120:123], a[104:107], 0
  v_mfma_f32_16x16x32_bf16 v[140:143], a[120:123], a[112:115], 0
  s_waitcnt lgkmcnt(12)
  v_mfma_f32_16x16x32_bf16 v[144:147], a[128:131], a[104:107], 0
  v_mfma_f32_16x16x32_bf16 v[148:151], a[128:131], a[112:115], 0
  s_waitcnt lgkmcnt(11)
  v_mfma_f32_16x16x32_bf16 v[136:139], a[124:127], a[108:111], v[136:139]
  v_mfma_f32_16x16x32_bf16 v[140:143], a[124:127], a[116:119], v[140:143]
  s_waitcnt lgkmcnt(10)
  v_mfma_f32_16x16x32_bf16 v[144:147], a[132:135], a[108:111], v[144:147]
  v_mfma_f32_16x16x32_bf16 v[148:151], a[132:135], a[116:119], v[148:151]
  v_lshlrev_b32 v168, 16, v20
  v_and_b32 v169, 0xffff0000, v20
  v_lshlrev_b32 v170, 16, v21
  v_and_b32 v171, 0xffff0000, v21
  v_lshlrev_b32 v172, 16, v22
  v_and_b32 v173, 0xffff0000, v22
  v_lshlrev_b32 v174, 16, v23
  v_and_b32 v175, 0xffff0000, v23
  v_lshlrev_b32 v176, 16, v24
  v_and_b32 v177, 0xffff0000, v24
  v_lshlrev_b32 v178, 16, v25
  v_and_b32 v179, 0xffff0000, v25
  v_lshlrev_b32 v180, 16, v26
  v_and_b32 v181, 0xffff0000, v26
  s_mov_b32 s31, 0
  s_waitcnt vmcnt(0)
  v_xor_b32 v7, s3, v7
  v_cmp_ne_u32 vcc, 0, v7
  s_nop 0
  s_cmp_eq_u64 vcc, 0
  s_cbranch_scc1 kg_w_ok
kg_w_again:
  s_sleep 2
  buffer_load_dword v7, v6, s[4:7], s29 offen sc0 sc1
  s_add_u32 s31, s31, 1
  s_waitcnt vmcnt(0)
  v_xor_b32 v7, s3, v7
  v_cmp_ne_u32 vcc, 0, v7
  s_nop 0
  s_cmp_eq_u64 vcc, 0
  s_cbranch_scc1 kg_w_ok
  s_cmp_lt_u32 s31, 100000
  s_cbranch_scc1 kg_w_again
kg_w_ok:
  s_add_u32 m0, s21, 0
  s_add_u32 s42, s21, 61440
  buffer_load_dwordx4 v2, s[8:11], s42 offen sc1 lds
  v_lshlrev_b32 v182, 16, v27
  v_and_b32 v183, 0xffff0000, v27
  s_waitcnt lgkmcnt(3)
  v_mfma_f32_16x16x32_bf16 v[152:155], a[136:139], a[104:107], 0
  v_mfma_f32_16x16x32_bf16 v[156:159], a[136:139], a[112:115], 0
  s_waitcnt lgkmcnt(2)
  v_mfma_f32_16x16x32_bf16 v[160:163], a[144:147], a[104:107], 0
  v_mfma_f32_16x16x32_bf16 v[164:167], a[144:147], a[112:115], 0
  s_add_u32 m0, s21, 4096
  s_add_u32 s42, s21, 65536
  buffer_load_dwordx4 v2, s[8:11], s42 offen sc1 lds
  s_waitcnt lgkmcnt(1)
  v_mfma_f32_16x16x32_bf16 v[152:155], a[140:143], a[108:111], v[152:155]
  v_mfma_f32_16x16x32_bf16 v[156:159], a[140:143], a[116:119], v[156:159]
  s_waitcnt lgkmcnt(0)
  v_mfma_f32_16x16x32_bf16 v[160:163], a[148:151], a[108:111], v[160:163]
  v_mfma_f32_16x16x32_bf16 v[164:167], a[148:151], a[116:119], v[164:167]
  ds_write_b128 v84, v[136:139] offset:0
  ds_write_b128 v84, v[140:143] offset:1280
  s_add_u32 m0, s21, 8192
  s_add_u32 s42, s21, 69632
  buffer_load_dwordx4 v2, s[8:11], s42 offen sc1 lds
  s_mov_b64 exec, 0xffff
  ds_write_b128 v84, v[144:147] offset:64
  ds_write_b128 v84, v[148:151] offset:1344
  s_mov_b64 exec, -1
  ds_read_b128 v[88:91], v85 offset:0
  ds_read_b128 v[92:95], v85 offset:16
  ds_read_b128 v[96:99], v85 offset:1280
  ds_read_b128 v[100:103], v85 offset:1296
  ds_write_b128 v84, v[152:155] offset:4608
  s_add_u32 m0, s21, 12288
  s_add_u32 s42, s21, 73728
  buffer_load_dwordx4 v2, s[8:11], s42 offen sc1 lds
  ds_write_b128 v84, v[156:159] offset:5888
  s_mov_b64 exec, 0xffff
  ds_write_b128 v84, v[160:163] offset:4672
  ds_write_b128 v84, v[164:167] offset:5952
  s_mov_b64 exec, -1
  ds_read_b128 v[112:115], v85 offset:4608
  ds_read_b128 v[116:119], v85 offset:4624
  ds_read_b128 v[120:123], v85 offset:5888
  ds_read_b128 v[124:127], v85 offset:5904
  s_add_u32 m0, s21, 16384
  s_add_u32 s42, s21, 77824
  buffer_load_dwordx4 v2, s[8:11], s42 offen sc1 lds
  v_cmp_gt_u32 vcc, 40, v1
  s_add_u32 s38, s34, 9396224
  s_add_u32 s39, s38, 81920
  s_waitcnt lgkmcnt(11)
  v_pk_fma_f32 v[88:89], v[88:89], v[192:193], v[168:169]
  s_waitcnt lgkmcnt(3)
  v_pk_fma_f32 v[112:113], v[112:113], v[192:193], v[240:241]
  v_pk_fma_f32 v[90:91], v[90:91], v[194:195], v[170:171]
  s_add_u32 m0, s21, 20480
  s_add_u32 s42, s21, 81920
  buffer_load_dwordx4 v2, s[8:11], s42 offen sc1 lds
  v_pk_fma_f32 v[114:115], v[114:115], v[194:195], v[242:243]
  v_pk_fma_f32 v[92:93], v[92:93], v[196:197], v[172:173]
  s_waitcnt lgkmcnt(2)
  v_pk_fma_f32 v[116:117], v[116:117], v[196:197], v[244:245]
  v_pk_fma_f32 v[94:95], v[94:95], v[198:199], v[174:175]
  v_pk_fma_f32 v[118:119], v[118:119], v[198:199], v[246:247]
  v_pk_fma_f32 v[96:97], v[96:97], v[200:201], v[176:177]
  s_add_u32 m0, s21, 24576
  s_add_u32 s42, s21, 86016
  buffer_load_dwordx4 v2, s[8:11], s42 offen sc1 lds
  s_waitcnt lgkmcnt(1)
  v_pk_fma_f32 v[120:121], v[120:121], v[200:201], v[248:249]
  v_pk_fma_f32 v[98:99], v[98:99], v[202:203], v[178:179]
  v_pk_fma_f32 v[122:123], v[122:123], v[202:203], v[250:251]
  v_pk_fma_f32 v[100:101], v[100:101], v[204:205], v[180:181]
  s_waitcnt lgkmcnt(0)
  v_pk_fma_f32 v[124:125], v[124:125], v[204:205], v[252:253]
  v_pk_fma_f32 v[102:103], v[102:103], v[206:207], v[182:183]
  s_add_u32 m0, s21, 28672
  s_add_u32 s42, s21, 90112
  buffer_load_dwordx4 v2, s[8:11], s42 offen sc1 lds
  v_pk_fma_f32 v[126:127], v[126:127], v[206:207], v[254:255]
  v_pk_add_f32 v[56:57], v[88:89], v[90:91]
  v_pk_add_f32 v[64:65], v[112:113], v[114:115]
  v_pk_mul_f32 v[58:59], v[88:89], v[88:89]
  v_pk_mul_f32 v[66:67], v[112:113], v[112:113]
  v_pk_fma_f32 v[58:59], v[90:91], v[90:91], v[58:59]
  s_add_u32 m0, s21, 32768
  s_add_u32 s42, s21, 94208
  buffer_load_dwordx4 v2, s[8:11], s42 offen sc1 lds
  v_pk_fma_f32 v[66:67], v[114:115], v[114:115], v[66:67]
  v_pk_add_f32 v[56:57], v[56:57], v[92:93]
  v_pk_add_f32 v[64:65], v[64:65], v[116:117]
  v_pk_fma_f32 v[58:59], v[92:93], v[92:93], v[58:59]
  v_pk_fma_f32 v[66:67], v[116:117], v[116:117], v[66:67]
  v_pk_add_f32 v[56:57], v[56:57], v[94:95]
  s_add_u32 m0, s21, 36864
  s_add_u32 s42, s21, 98304
  buffer_load_dwordx4 v2, s[8:11], s42 offen sc1 lds
  v_pk_add_f32 v[64:65], v[64:65], v[118:119]
  v_pk_fma_f32 v[58:59], v[94:95], v[94:95], v[58:59]
  v_pk_fma_f32 v[66:67], v[118:119], v[118:119], v[66:67]
  v_pk_add_f32 v[56:57], v[56:57], v[96:97]
  v_pk_add_f32 v[64:65], v[64:65], v[120:121]
  v_pk_fma_f32 v[58:59], v[96:97], v[96:97], v[58:59]
  s_add_u32 m0, s21, 40960
  s_add_u32 s42, s21, 102400
  buffer_load_dwordx4 v2, s[8:11], s42 offen sc1 lds
  v_pk_fma_f32 v[66:67], v[120:121], v[120:121], v[66:67]
  v_pk_add_f32 v[56:57], v[56:57], v[98:99]
  v_pk_add_f32 v[64:65], v[64:65], v[122:123]
  v_pk_fma_f32 v[58:59], v[98:99], v[98:99], v[58:59]
  v_pk_fma_f32 v[66:67], v[122:123], v[122:123], v[66:67]
  v_pk_add_f32 v[56:57], v[56:57], v[100:101]
  s_add_u32 m0, s21, 45056
  s_add_u32 s42, s21, 106496
  buffer_load_dwordx4 v2, s[8:11], s42 offen sc1 lds
  v_pk_add_f32 v[64:65], v[64:65], v[124:125]
  v_pk_fma_f32 v[58:59], v[100:101], v[100:101], v[58:59]
  v_pk_fma_f32 v[66:67], v[124:125], v[124:125], v[66:67]
  v_pk_add_f32 v[56:57], v[56:57], v[102:103]
  v_pk_add_f32 v[64:65], v[64:65], v[126:127]
  v_pk_fma_f32 v[58:59], v[102:103], v[102:103], v[58:59]
  s_add_u32 m0, s21, 49152
  s_add_u32 s42, s21, 110592
  buffer_load_dwordx4 v2, s[8:11], s42 offen sc1 lds
  v_pk_fma_f32 v[66:67], v[126:127], v[126:127], v[66:67]
  v_add_f32 v56, v56, v57
  v_add_f32 v64, v64, v65
  v_add_f32 v58, v58, v59
  v_add_f32 v66, v66, v67
  v_cndmask_b32 v56, 0, v56, vcc
  s_add_u32 m0, s21, 53248
  s_add_u32 s42, s21, 114688
  buffer_load_dwordx4 v2, s[8:11], s42 offen sc1 lds
  v_cndmask_b32 v64, 0, v64, vcc
  v_cndmask_b32 v58, 0, v58, vcc
  v_cndmask_b32 v66, 0, v66, vcc
  v_add_f32_dpp v56, v56, v56 row_ror:8 row_mask:0xf bank_mask:0xf
  v_add_f32_dpp v64, v64, v64 row_ror:8 row_mask:0xf bank_mask:0xf
  v_add_f32_dpp v58, v58, v58 row_ror:8 row_mask:0xf bank_mask:0xf
  s_add_u32 m0, s21, 57344
  s_add_u32 s42, s21, 118784
  buffer_load_dwordx4 v2, s[8:11], s42 offen sc1 lds
  v_add_f32_dpp v66, v66, v66 row_ror:8 row_mask:0xf bank_mask:0xf
  v_add_f32_dpp v56, v56, v56 row_ror:4 row_mask:0xf bank_mask:0xf
  v_add_f32_dpp v64, v64, v64 row_ror:4 row_mask:0xf bank_mask:0xf
  v_add_f32_dpp v58, v58, v58 row_ror:4 row_mask:0xf bank_mask:0xf
  v_add_f32_dpp v66, v66, v66 row_ror:4 row_mask:0xf bank_mask:0xf
  v_add_f32_dpp v56, v56, v56 row_ror:2 row_mask:0xf bank_mask:0xf
  s_add_u32 m0, s21, 61440
  s_add_u32 s42, s21, 122880
  buffer_load_dwordx4 v2, s[8:11], s42 offen sc1 lds
  v_add_f32_dpp v64, v64, v64 row_ror:2 row_mask:0xf bank_mask:0xf
  v_add_f32_dpp v58, v58, v58 row_ror:2 row_mask:0xf bank_mask:0xf
  v_add_f32_dpp v66, v66, v66 row_ror:2 row_mask:0xf bank_mask:0xf
  v_add_f32_dpp v56, v56, v56 row_ror:1 row_mask:0xf bank_mask:0xf
  v_add_f32_dpp v64, v64, v64 row_ror:1 row_mask:0xf bank_mask:0xf
  v_add_f32_dpp v58, v58, v58 row_ror:1 row_mask:0xf bank_mask:0xf
  s_add_u32 m0, s21, 65536
  s_add_u32 s42, s21, 126976
  buffer_load_dwordx4 v2, s[8:11], s42 offen sc1 lds
  v_add_f32_dpp v66, v66, v66 row_ror:1 row_mask:0xf bank_mask:0xf
  v_add_f32_dpp v56, v56, v56 row_bcast:15 row_mask:0xa bank_mask:0xf
  v_add_f32_dpp v64, v64, v64 row_bcast:15 row_mask:0xa bank_mask:0xf
  v_add_f32_dpp v58, v58, v58 row_bcast:15 row_mask:0xa bank_mask:0xf
  v_add_f32_dpp v66, v66, v66 row_bcast:15 row_mask:0xa bank_mask:0xf
  v_add_f32_dpp v56, v56, v56 row_bcast:31 row_mask:0xc bank_mask:0xf
  s_add_u32 m0, s21, 69632
  s_add_u32 s42, s21, 131072
  buffer_load_dwordx4 v2, s[8:11], s42 offen sc1 lds
  v_add_f32_dpp v64, v64, v64 row_bcast:31 row_mask:0xc bank_mask:0xf
  v_add_f32_dpp v58, v58, v58 row_bcast:31 row_mask:0xc bank_mask:0xf
  v_add_f32_dpp v66, v66, v66 row_bcast:31 row_mask:0xc bank_mask:0xf
  v_readlane_b32 s27, v56, 63
  v_readlane_b32 s35, v64, 63
  v_readlane_b32 s28, v58, 63
  s_add_u32 m0, s21, 73728
  s_add_u32 s42, s21, 135168
  buffer_load_dwordx4 v2, s[8:11], s42 offen sc1 lds
  v_readlane_b32 s36, v66, 63
  v_cvt_pk_bf16_f32 v20, v88, v89
  v_cvt_pk_bf16_f32 v28, v112, v113
  v_cvt_pk_bf16_f32 v21, v90, v91
  v_cvt_pk_bf16_f32 v29, v114, v115
  v_cvt_pk_bf16_f32 v22, v92, v93
  s_add_u32 m0, s21, 77824
  s_add_u32 s42, s21, 139264
  buffer_load_dwordx4 v2, s[8:11], s42 offen sc1 lds
  v_cvt_pk_bf16_f32 v30, v116, v117
  v_cvt_pk_bf16_f32 v23, v94, v95
  v_cvt_pk_bf16_f32 v31, v118, v119
  v_cvt_pk_bf16_f32 v24, v96, v97
  v_cvt_pk_bf16_f32 v32, v120, v121
  v_cvt_pk_bf16_f32 v25, v98, v99
  v_cvt_pk_bf16_f32 v33, v122, v123
  v_cvt_pk_bf16_f32 v26, v100, v101
  v_cvt_pk_bf16_f32 v34, v124, v125
  v_cvt_pk_bf16_f32 v27, v102, v103
  v_cvt_pk_bf16_f32 v35, v126, v127
  v_mov_b32 v56, s27
  v_mov_b32 v64, s35
  v_mov_b32 v58, s28
  v_mov_b32 v66, s36
  v_mul_f32 v56, 0xbacccccd, v56
  v_mul_f32 v64, 0xbacccccd, v64
  v_mul_f32 v58, 0x3acccccd, v58
  v_mul_f32 v66, 0x3acccccd, v66
  v_fma_f32 v58, -v56, v56, v58
  v_fma_f32 v66, -v64, v64, v66
  v_max_f32 v58, 0, v58
  v_max_f32 v66, 0, v66
  v_add_f32 v58, 0x3727c5ac, v58
  v_add_f32 v66, 0x3727c5ac, v66
  v_rsq_f32 v58, v58
  v_rsq_f32 v66, v66
  v_mul_f32 v56, v56, v58
  v_mul_f32 v64, v64, v66
  v_pk_fma_f32 v[88:89], v[88:89], v[58:59], v[56:57] op_sel_hi:[1,0,0]
  v_pk_fma_f32 v[112:113], v[112:113], v[66:67], v[64:65] op_sel_hi:[1,0,0]
  v_pk_fma_f32 v[90:91], v[90:91], v[58:59], v[56:57] op_sel_hi:[1,0,0]
  v_pk_fma_f32 v[114:115], v[114:115], v[66:67], v[64:65] op_sel_hi:[1,0,0]
  v_pk_fma_f32 v[92:93], v[92:93], v[58:59], v[56:57] op_sel_hi:[1,0,0]
  v_pk_fma_f32 v[116:117], v[116:117], v[66:67], v[64:65] op_sel_hi:[1,0,0]
  v_pk_fma_f32 v[94:95], v[94:95], v[58:59], v[56:57] op_sel_hi:[1,0,0]
  v_pk_fma_f32 v[118:119], v[118:119], v[66:67], v[64:65] op_sel_hi:[1,0,0]
  v_pk_fma_f32 v[96:97], v[96:97], v[58:59], v[56:57] op_sel_hi:[1,0,0]
  v_pk_fma_f32 v[120:121], v[120:121], v[66:67], v[64:65] op_sel_hi:[1,0,0]
  v_pk_fma_f32 v[98:99], v[98:99], v[58:59], v[56:57] op_sel_hi:[1,0,0]
  v_pk_fma_f32 v[122:123], v[122:123], v[66:67], v[64:65] op_sel_hi:[1,0,0]
  v_pk_fma_f32 v[100:101], v[100:101], v[58:59], v[56:57] op_sel_hi:[1,0,0]
  v_pk_fma_f32 v[124:125], v[124:125], v[66:67], v[64:65] op_sel_hi:[1,0,0]
  v_pk_fma_f32 v[102:103], v[102:103], v[58:59], v[56:57] op_sel_hi:[1,0,0]
  v_pk_fma_f32 v[126:127], v[126:127], v[66:67], v[64:65] op_sel_hi:[1,0,0]
  v_pk_fma_f32 v[88:89], v[88:89], v[208:209], v[224:225]
  v_pk_fma_f32 v[112:113], v[112:113], v[208:209], v[224:225]
  v_pk_fma_f32 v[90:91], v[90:91], v[210:211], v[226:227]
  v_pk_fma_f32 v[114:115], v[114:115], v[210:211], v[226:227]
  v_pk_fma_f32 v[92:93], v[92:93], v[212:213], v[228:229]
  v_pk_fma_f32 v[116:117], v[116:117], v[212:213], v[228:229]
  v_pk_fma_f32 v[94:95], v[94:95], v[214:215], v[230:231]
  v_pk_fma_f32 v[118:119], v[118:119], v[214:215], v[230:231]
  v_pk_fma_f32 v[96:97], v[96:97], v[216:217], v[232:233]
  v_pk_fma_f32 v[120:121], v[120:121], v[216:217], v[232:233]
  v_pk_fma_f32 v[98:99], v[98:99], v[218:219], v[234:235]
  v_pk_fma_f32 v[122:123], v[122:123], v[218:219], v[234:235]
  v_pk_fma_f32 v[100:101], v[100:101], v[220:221], v[236:237]
  v_pk_fma_f32 v[124:125], v[124:125], v[220:221], v[236:237]
  v_pk_fma_f32 v[102:103], v[102:103], v[222:223], v[238:239]
  v_pk_fma_f32 v[126:127], v[126:127], v[222:223], v[238:239]
  v_cvt_pk_bf16_f32 v168, v88, v89
  v_cvt_pk_bf16_f32 v240, v112, v113
  v_cvt_pk_bf16_f32 v169, v90, v91
  v_cvt_pk_bf16_f32 v241, v114, v115
  v_cvt_pk_bf16_f32 v170, v92, v93
  v_cvt_pk_bf16_f32 v242, v116, v117
  v_cvt_pk_bf16_f32 v171, v94, v95
  v_cvt_pk_bf16_f32 v243, v118, v119
  v_cvt_pk_bf16_f32 v172, v96, v97
  v_cvt_pk_bf16_f32 v244, v120, v121
  v_cvt_pk_bf16_f32 v173, v98, v99
  v_cvt_pk_bf16_f32 v245, v122, v123
  v_cvt_pk_bf16_f32 v174, v100, v101
  v_cvt_pk_bf16_f32 v246, v124, v125
  v_cvt_pk_bf16_f32 v175, v102, v103
  v_cvt_pk_bf16_f32 v247, v126, v127
  s_sub_u32 s27, s38, 2621440
  s_sub_u32 s35, s39, 2621440
  buffer_store_dwordx4 v[168:171], v36, s[4:7], s27 offen offset:0 sc1
  buffer_store_dwordx4 v[240:243], v36, s[4:7], s35 offen offset:0 sc1
  buffer_store_dwordx4 v[172:175], v36, s[4:7], s27 offen offset:640 sc1
  buffer_store_dwordx4 v[244:247], v36, s[4:7], s35 offen offset:640 sc1
  buffer_store_dwordx4 v[20:23], v36, s[4:7], s38 offen offset:0 sc1
  buffer_store_dwordx4 v[28:31], v36, s[4:7], s39 offen offset:0 sc1
  buffer_store_dwordx4 v[24:27], v36, s[4:7], s38 offen offset:640 sc1
  buffer_store_dwordx4 v[32:35], v36, s[4:7], s39 offen offset:640 sc1
  s_lshl_b32 s29, s32, 6
  s_add_u32 s29, s29, s30
  s_and_b32 s35, s2, 3
  s_lshl_b32 s35, s35, 6
  s_lshl_b32 s27, s26, 8
  s_add_u32 s35, s35, s27
  s_load_dwordx2 s[12:13], s[0:1], 56
  s_mov_b32 s14, 8388608
  s_mov_b32 s15, 0x20000
  v_mov_b32 v164, 0
  v_lshlrev_b32 v165, 15, v1
  s_and_b32 s32, s29, 0
  s_lshr_b32 s29, s29, 0
  s_lshl_b32 s29, s29, 5
  s_add_u32 s29, s29, s32
  s_lshl2_add_u32 s29, s29, 2965504
  s_lshl_b32 s35, s35, 7
  s_add_u32 s35, s35, 2965504
  s_waitcnt vmcnt(0)
  s_barrier
  s_cmp_lg_u32 s20, 0
  s_cbranch_scc1 kg_h_sent
  s_mov_b64 exec, 3
  buffer_store_dword v164, v165, s[4:7], s29 offen sc0 sc1
  s_mov_b64 exec, -1
kg_h_sent:
  v_lshrrev_b32 v4, 3, v1
  v_and_b32 v5, 7, v0
  v_bfe_u32 v9, v0, 4, 2
  v_xor_b32 v5, v5, v9
  v_mul_u32_u24 v4, 1280, v4
  v_lshl_add_u32 v20, v5, 4, v4
  v_xor_b32 v5, 4, v5
  v_lshl_add_u32 v4, v5, 4, v4
  v_add_u32 v21, 9216, v4
  v_add_u32 v22, 18432, v20
  v_add_u32 v23, 27648, v4
  s_mul_i32 s30, s22, 40960
  s_add_u32 s30, s30, 6774784
  s_lshl_b32 s37, s20, 14
  s_add_u32 s37, s37, 94208
  s_and_b32 s24, s23, 1
  s_mov_b32 s38, 0xbdd2d3e8
  s_mov_b32 s39, 0xbdd2d3e8
  v_mov_b32 v26, 0xc0135761
  v_mov_b32 v27, 0xc0135761
  v_add_u32 v6, 65536, v2
  v_add_u32 v7, 131072, v2
  v_lshlrev_b32 v3, 3, v1
  v_and_b32 v19, 255, v3
  s_lshl_b32 s27, s24, 3
  s_lshl_b32 s42, 0x00ff00ff, s27
  s_mov_b32 s43, s42
  s_mov_b32 s40, 0xaaaaaaaa
  s_mov_b32 s41, 0xaaaaaaaa
  v_and_b32 v8, 15, v0
  v_bfe_u32 v4, v0, 1, 3
  v_xor_b32 v4, v4, v9
  v_lshlrev_b32 v4, 4, v4
  v_lshl_add_u32 v4, v8, 7, v4
  v_add_u32 v24, s37, v4
  v_xor_b32 v25, 64, v24
  v_lshrrev_b32 v4, 2, v1
  v_and_b32 v5, 1, v0
  v_lshl_add_u32 v4, v4, 1, v5
  v_lshlrev_b32 v18, 3, v4
  v_lshrrev_b32 v4, 5, v1
  v_lshl_add_u32 v86, v4, 11, v19
  v_bfe_u32 v4, v0, 2, 1
  v_bfe_u32 v5, v0, 3, 2
  v_lshl_add_u32 v4, v4, 2, v5
  v_and_b32 v5, 3, v0
  v_lshl_add_u32 v4, v4, 2, v5
  s_lshl_b32 s27, s20, 8
  s_add_u32 s27, s27, 65536
  v_lshl_add_u32 v87, v4, 2, s27
  v_lshl_add_u32 v88, v9, 4, s27
  s_add_u32 s27, s21, 66560
  v_lshlrev_b32 v84, 6, v8
  v_lshl_add_u32 v84, v9, 3, v84
  v_add_u32 v84, s27, v84
  s_lshl_b32 s28, s24, 9
  s_sub_u32 s27, s27, s28
  s_add_u32 s27, s27, 512
  v_bfe_u32 v4, v0, 2, 3
  v_lshlrev_b32 v4, 6, v4
  v_lshl_add_u32 v4, v5, 3, v4
  v_add_u32 v85, s27, v4
  s_lshl_b32 s31, s22, 12
  s_add_u32 s31, s31, 2637824
  v_lshrrev_b32 v4, 3, v1
  v_and_b32 v5, 7, v0
  v_xor_b32 v5, v5, v9
  v_lshlrev_b32 v4, 12, v4
  v_lshl_add_u32 v10, v5, 4, v4
  v_xor_b32 v4, 64, v10
  v_add_u32 v11, 31744, v4
  v_add_u32 v12, 63488, v10
  v_add_u32 v13, 95232, v4
  s_lshl_b32 s34, s22, 17
  s_lshl_b32 s28, s26, 11
  s_add_u32 s34, s34, s28
  s_add_u32 s34, s34, 512
  s_lshl_b32 s33, s20, 14
  s_add_u32 s33, s33, 86016
  v_bfe_u32 v4, v0, 1, 3
  v_lshrrev_b32 v5, 1, v9
  v_xor_b32 v4, v4, v5
  v_lshlrev_b32 v4, 4, v4
  v_lshl_add_u32 v4, v8, 7, v4
  v_and_b32 v5, 1, v9
  v_lshl_add_u32 v4, v5, 3, v4
  v_add_u32 v14, s33, v4
  v_xor_b32 v15, 32, v14
  v_xor_b32 v16, 64, v14
  v_xor_b32 v17, 96, v14
  s_waitcnt lgkmcnt(0)
  s_add_u32 m0, s33, 0
  s_nop 0
  buffer_load_dwordx4 v10, s[12:15], s34 offen offset:0 lds
  buffer_load_dwordx4 v11, s[12:15], s34 offen offset:1024 lds
  buffer_load_dwordx4 v12, s[12:15], s34 offen offset:2048 lds
  buffer_load_dwordx4 v13, s[12:15], s34 offen offset:3072 lds
  s_add_u32 s34, s34, 128
  s_add_u32 m0, s33, 4096
  s_nop 0
  buffer_load_dwordx4 v10, s[12:15], s34 offen offset:0 lds
  buffer_load_dwordx4 v11, s[12:15], s34 offen offset:1024 lds
  buffer_load_dwordx4 v12, s[12:15], s34 offen offset:2048 lds
  buffer_load_dwordx4 v13, s[12:15], s34 offen offset:3072 lds
  s_add_u32 s34, s34, 128
  s_waitcnt vmcnt(4)
  ds_read_b64 a[224:225], v14 offset:0
  ds_read_b64 a[226:227], v15 offset:0
  ds_read_b64 a[228:229], v14 offset:2048
  ds_read_b64 a[230:231], v15 offset:2048
  ds_read_b64 a[232:233], v16 offset:0
  ds_read_b64 a[234:235], v17 offset:0
  ds_read_b64 a[236:237], v16 offset:2048
  ds_read_b64 a[238:239], v17 offset:2048
  s_waitcnt vmcnt(0)
  ds_read_b64 a[240:241], v14 offset:4096
  ds_read_b64 a[242:243], v15 offset:4096
  ds_read_b64 a[244:245], v14 offset:6144
  ds_read_b64 a[246:247], v15 offset:6144
  ds_read_b64 a[248:249], v16 offset:4096
  ds_read_b64 a[250:251], v17 offset:4096
  ds_read_b64 a[252:253], v16 offset:6144
  ds_read_b64 a[254:255], v17 offset:6144
  s_waitcnt lgkmcnt(0)
  s_cmp_lg_u32 s20, 0
  s_cbranch_scc1 kg_h_ok
  v_and_b32 v5, 63, v0
  v_lshlrev_b32 v5, 7, v5
  s_nop 1
  buffer_load_dword v164, v5, s[4:7], s35 offen sc0 sc1
  s_mov_b32 s32, 0
  s_waitcnt vmcnt(0)
  v_cmp_eq_u32 vcc, -1, v164
  s_nop 0
  s_cmp_eq_u64 vcc, 0
  s_cbranch_scc1 kg_h_ok
kg_h_again:
  s_sleep 2
  buffer_load_dword v164, v5, s[4:7], s35 offen sc0 sc1
  s_add_u32 s32, s32, 1
  s_waitcnt vmcnt(0)
  v_cmp_eq_u32 vcc, -1, v164
  s_nop 0
  s_cmp_eq_u64 vcc, 0
  s_cbranch_scc1 kg_h_ok
  s_cmp_lt_u32 s32, 100000
  s_cbranch_scc1 kg_h_again
kg_h_ok:
  s_mov_b64 exec, -1
  s_barrier
  s_add_u32 m0, s37, 0
  s_nop 0
  buffer_load_dwordx4 v20, s[4:7], s30 offen offset:0 sc1 lds
  buffer_load_dwordx4 v21, s[4:7], s30 offen offset:1024 sc1 lds
  buffer_load_dwordx4 v22, s[4:7], s30 offen offset:2048 sc1 lds
  buffer_load_dwordx4 v23, s[4:7], s30 offen offset:3072 sc1 lds
  s_add_u32 s30, s30, 128
  s_add_u32 m0, s37, 4096
  s_nop 0
  buffer_load_dwordx4 v20, s[4:7], s30 offen offset:0 sc1 lds
  buffer_load_dwordx4 v21, s[4:7], s30 offen offset:1024 sc1 lds
  buffer_load_dwordx4 v22, s[4:7], s30 offen offset:2048 sc1 lds
  buffer_load_dwordx4 v23, s[4:7], s30 offen offset:3072 sc1 lds
  s_add_u32 s30, s30, 128
  s_add_u32 m0, s37, 8192
  s_nop 0
  buffer_load_dwordx4 v20, s[4:7], s30 offen offset:0 sc1 lds
  buffer_load_dwordx4 v21, s[4:7], s30 offen offset:1024 sc1 lds
  buffer_load_dwordx4 v22, s[4:7], s30 offen offset:2048 sc1 lds
  buffer_load_dwordx4 v23, s[4:7], s30 offen offset:3072 sc1 lds
  s_add_u32 s30, s30, 128
  s_add_u32 m0, s37, 12288
  s_nop 0
  buffer_load_dwordx4 v20, s[4:7], s30 offen offset:0 sc1 lds
  buffer_load_dwordx4 v21, s[4:7], s30 offen offset:1024 sc1 lds
  buffer_load_dwordx4 v22, s[4:7], s30 offen offset:2048 sc1 lds
  buffer_load_dwordx4 v23, s[4:7], s30 offen offset:3072 sc1 lds
  s_add_u32 s30, s30, 128
  s_barrier
  s_waitcnt vmcnt(12)
  ds_read_b128 a[0:3], v24 offset:0
  ds_read_b128 a[4:7], v24 offset:2048
  ds_read_b128 a[8:11], v25 offset:0
  ds_read_b128 a[12:15], v25 offset:2048
  ds_read_b128 v[92:95], v2 offset:0
  ds_read_b128 v[96:99], v2 offset:1024
  ds_read_b128 v[100:103], v2 offset:2048
  ds_read_b128 v[104:107], v2 offset:3072
  s_waitcnt lgkmcnt(0)
  v_mfma_f32_16x16x32_bf16 v[28:31], a[0:3], v[92:95], 0
  ds_read_b128 v[108:111], v2 offset:4096
  ds_read_b128 v[112:115], v2 offset:5120
  v_mfma_f32_16x16x32_bf16 v[44:47], a[4:7], v[92:95], 0
  ds_read_b128 v[116:119], v2 offset:6144
  ds_read_b128 v[120:123], v2 offset:7168
  s_add_u32 m0, s37, 0
  s_nop 0
  buffer_load_dwordx4 v20, s[4:7], s30 offen offset:0 sc1 lds
  v_mfma_f32_16x16x32_bf16 v[32:35], a[0:3], v[96:99], 0
  v_mfma_f32_16x16x32_bf16 v[48:51], a[4:7], v[96:99], 0
  buffer_load_dwordx4 v21, s[4:7], s30 offen offset:1024 sc1 lds
  v_mfma_f32_16x16x32_bf16 v[36:39], a[0:3], v[100:103], 0
  v_mfma_f32_16x16x32_bf16 v[52:55], a[4:7], v[100:103], 0
  buffer_load_dwordx4 v22, s[4:7], s30 offen offset:2048 sc1 lds
  v_mfma_f32_16x16x32_bf16 v[40:43], a[0:3], v[104:107], 0
  v_mfma_f32_16x16x32_bf16 v[56:59], a[4:7], v[104:107], 0
  buffer_load_dwordx4 v23, s[4:7], s30 offen offset:3072 sc1 lds
  s_add_u32 s30, s30, 128
  s_waitcnt lgkmcnt(0)
  v_mfma_f32_16x16x32_bf16 v[28:31], a[8:11], v[108:111], v[28:31]
  ds_read_b128 v[92:95], v2 offset:8192
  ds_read_b128 v[96:99], v2 offset:9216
  s_waitcnt vmcnt(12)
  v_mfma_f32_16x16x32_bf16 v[44:47], a[12:15], v[108:111], v[44:47]
  ds_read_b128 v[100:103], v2 offset:10240
  ds_read_b128 v[104:107], v2 offset:11264
  v_mfma_f32_16x16x32_bf16 v[32:35], a[8:11], v[112:115], v[32:35]
  ds_read_b128 a[16:19], v24 offset:4096
  v_mfma_f32_16x16x32_bf16 v[48:51], a[12:15], v[112:115], v[48:51]
  v_mfma_f32_16x16x32_bf16 v[36:39], a[8:11], v[116:119], v[36:39]
  ds_read_b128 a[20:23], v24 offset:6144
  v_mfma_f32_16x16x32_bf16 v[52:55], a[12:15], v[116:119], v[52:55]
  ds_read_b128 a[24:27], v25 offset:4096
  v_mfma_f32_16x16x32_bf16 v[40:43], a[8:11], v[120:123], v[40:43]
  v_mfma_f32_16x16x32_bf16 v[56:59], a[12:15], v[120:123], v[56:59]
  ds_read_b128 a[28:31], v25 offset:6144
  s_waitcnt lgkmcnt(0)
  v_mfma_f32_16x16x32_bf16 v[28:31], a[16:19], v[92:95], v[28:31]
  ds_read_b128 v[108:111], v2 offset:12288
  ds_read_b128 v[112:115], v2 offset:13312
  v_mfma_f32_16x16x32_bf16 v[44:47], a[20:23], v[92:95], v[44:47]
  ds_read_b128 v[116:119], v2 offset:14336
  ds_read_b128 v[120:123], v2 offset:15360
  s_add_u32 m0, s37, 4096
  s_nop 0
  buffer_load_dwordx4 v20, s[4:7], s30 offen offset:0 sc1 lds
  v_mfma_f32_16x16x32_bf16 v[32:35], a[16:19], v[96:99], v[32:35]
  v_mfma_f32_16x16x32_bf16 v[48:51], a[20:23], v[96:99], v[48:51]
  buffer_load_dwordx4 v21, s[4:7], s30 offen offset:1024 sc1 lds
  v_mfma_f32_16x16x32_bf16 v[36:39], a[16:19], v[100:103], v[36:39]
  v_mfma_f32_16x16x32_bf16 v[52:55], a[20:23], v[100:103], v[52:55]
  buffer_load_dwordx4 v22, s[4:7], s30 offen offset:2048 sc1 lds
  v_mfma_f32_16x16x32_bf16 v[40:43], a[16:19], v[104:107], v[40:43]
  v_mfma_f32_16x16x32_bf16 v[56:59], a[20:23], v[104:107], v[56:59]
  buffer_load_dwordx4 v23, s[4:7], s30 offen offset:3072 sc1 lds
  s_add_u32 s30, s30, 128
  s_waitcnt lgkmcnt(0)
  v_mfma_f32_16x16x32_bf16 v[28:31], a[24:27], v[108:111], v[28:31]
  ds_read_b128 v[92:95], v2 offset:16384
  ds_read_b128 v[96:99], v2 offset:17408
  s_waitcnt vmcnt(12)
  v_mfma_f32_16x16x32_bf16 v[44:47], a[28:31], v[108:111], v[44:47]
  ds_read_b128 v[100:103], v2 offset:18432
  ds_read_b128 v[104:107], v2 offset:19456
  v_mfma_f32_16x16x32_bf16 v[32:35], a[24:27], v[112:115], v[32:35]
  ds_read_b128 a[32:35], v24 offset:8192
  v_mfma_f32_16x16x32_bf16 v[48:51], a[28:31], v[112:115], v[48:51]
  v_mfma_f32_16x16x32_bf16 v[36:39], a[24:27], v[116:119], v[36:39]
  ds_read_b128 a[36:39], v24 offset:10240
  v_mfma_f32_16x16x32_bf16 v[52:55], a[28:31], v[116:119], v[52:55]
  ds_read_b128 a[40:43], v25 offset:8192
  v_mfma_f32_16x16x32_bf16 v[40:43], a[24:27], v[120:123], v[40:43]
  v_mfma_f32_16x16x32_bf16 v[56:59], a[28:31], v[120:123], v[56:59]
  ds_read_b128 a[44:47], v25 offset:10240
  s_waitcnt lgkmcnt(0)
  v_mfma_f32_16x16x32_bf16 v[28:31], a[32:35], v[92:95], v[28:31]
  ds_read_b128 v[108:111], v2 offset:20480
  ds_read_b128 v[112:115], v2 offset:21504
  v_mfma_f32_16x16x32_bf16 v[44:47], a[36:39], v[92:95], v[44:47]
  ds_read_b128 v[116:119], v2 offset:22528
  ds_read_b128 v[120:123], v2 offset:23552
  s_add_u32 m0, s37, 8192
  s_nop 0
  buffer_load_dwordx4 v20, s[4:7], s30 offen offset:0 sc1 lds
  v_mfma_f32_16x16x32_bf16 v[32:35], a[32:35], v[96:99], v[32:35]
  v_mfma_f32_16x16x32_bf16 v[48:51], a[36:39], v[96:99], v[48:51]
  buffer_load_dwordx4 v21, s[4:7], s30 offen offset:1024 sc1 lds
  v_mfma_f32_16x16x32_bf16 v[36:39], a[32:35], v[100:103], v[36:39]
  v_mfma_f32_16x16x32_bf16 v[52:55], a[36:39], v[100:103], v[52:55]
  buffer_load_dwordx4 v22, s[4:7], s30 offen offset:2048 sc1 lds
  v_mfma_f32_16x16x32_bf16 v[40:43], a[32:35], v[104:107], v[40:43]
  v_mfma_f32_16x16x32_bf16 v[56:59], a[36:39], v[104:107], v[56:59]
  buffer_load_dwordx4 v23, s[4:7], s30 offen offset:3072 sc1 lds
  s_add_u32 s30, s30, 128
  s_waitcnt lgkmcnt(0)
  v_mfma_f32_16x16x32_bf16 v[28:31], a[40:43], v[108:111], v[28:31]
  ds_read_b128 v[92:95], v2 offset:24576
  ds_read_b128 v[96:99], v2 offset:25600
  s_waitcnt vmcnt(12)
  v_mfma_f32_16x16x32_bf16 v[44:47], a[44:47], v[108:111], v[44:47]
  ds_read_b128 v[100:103], v2 offset:26624
  ds_read_b128 v[104:107], v2 offset:27648
  v_mfma_f32_16x16x32_bf16 v[32:35], a[40:43], v[112:115], v[32:35]
  ds_read_b128 a[48:51], v24 offset:12288
  v_mfma_f32_16x16x32_bf16 v[48:51], a[44:47], v[112:115], v[48:51]
  v_mfma_f32_16x16x32_bf16 v[36:39], a[40:43], v[116:119], v[36:39]
  ds_read_b128 a[52:55], v24 offset:14336
  v_mfma_f32_16x16x32_bf16 v[52:55], a[44:47], v[116:119], v[52:55]
  ds_read_b128 a[56:59], v25 offset:12288
  v_mfma_f32_16x16x32_bf16 v[40:43], a[40:43], v[120:123], v[40:43]
  v_mfma_f32_16x16x32_bf16 v[56:59], a[44:47], v[120:123], v[56:59]
  ds_read_b128 a[60:63], v25 offset:14336
  s_waitcnt lgkmcnt(0)
  v_mfma_f32_16x16x32_bf16 v[28:31], a[48:51], v[92:95], v[28:31]
  ds_read_b128 v[108:111], v2 offset:28672
  ds_read_b128 v[112:115], v2 offset:29696
  v_mfma_f32_16x16x32_bf16 v[44:47], a[52:55], v[92:95], v[44:47]
  ds_read_b128 v[116:119], v2 offset:30720
  ds_read_b128 v[120:123], v2 offset:31744
  s_add_u32 m0, s37, 12288
  s_nop 0
  buffer_load_dwordx4 v20, s[4:7], s30 offen offset:0 sc1 lds
  v_mfma_f32_16x16x32_bf16 v[32:35], a[48:51], v[96:99], v[32:35]
  v_mfma_f32_16x16x32_bf16 v[48:51], a[52:55], v[96:99], v[48:51]
  buffer_load_dwordx4 v21, s[4:7], s30 offen offset:1024 sc1 lds
  v_mfma_f32_16x16x32_bf16 v[36:39], a[48:51], v[100:103], v[36:39]
  v_mfma_f32_16x16x32_bf16 v[52:55], a[52:55], v[100:103], v[52:55]
  buffer_load_dwordx4 v22, s[4:7], s30 offen offset:2048 sc1 lds
  v_mfma_f32_16x16x32_bf16 v[40:43], a[48:51], v[104:107], v[40:43]
  v_mfma_f32_16x16x32_bf16 v[56:59], a[52:55], v[104:107], v[56:59]
  buffer_load_dwordx4 v23, s[4:7], s30 offen offset:3072 sc1 lds
  s_add_u32 s30, s30, 128
  s_waitcnt lgkmcnt(0)
  v_mfma_f32_16x16x32_bf16 v[28:31], a[56:59], v[108:111], v[28:31]
  ds_read_b128 v[92:95], v2 offset:32768
  ds_read_b128 v[96:99], v2 offset:33792
  s_waitcnt vmcnt(12)
  v_mfma_f32_16x16x32_bf16 v[44:47], a[60:63], v[108:111], v[44:47]
  ds_read_b128 v[100:103], v2 offset:34816
  ds_read_b128 v[104:107], v2 offset:35840
  v_mfma_f32_16x16x32_bf16 v[32:35], a[56:59], v[112:115], v[32:35]
  ds_read_b128 a[64:67], v24 offset:0
  v_mfma_f32_16x16x32_bf16 v[48:51], a[60:63], v[112:115], v[48:51]
  v_mfma_f32_16x16x32_bf16 v[36:39], a[56:59], v[116:119], v[36:39]
  ds_read_b128 a[68:71], v24 offset:2048
  v_mfma_f32_16x16x32_bf16 v[52:55], a[60:63], v[116:119], v[52:55]
  ds_read_b128 a[72:75], v25 offset:0
  v_mfma_f32_16x16x32_bf16 v[40:43], a[56:59], v[120:123], v[40:43]
  v_mfma_f32_16x16x32_bf16 v[56:59], a[60:63], v[120:123], v[56:59]
  ds_read_b128 a[76:79], v25 offset:2048
  s_waitcnt lgkmcnt(0)
  v_mfma_f32_16x16x32_bf16 v[28:31], a[64:67], v[92:95], v[28:31]
  ds_read_b128 v[108:111], v2 offset:36864
  ds_read_b128 v[112:115], v2 offset:37888
  v_mfma_f32_16x16x32_bf16 v[44:47], a[68:71], v[92:95], v[44:47]
  ds_read_b128 v[116:119], v2 offset:38912
  ds_read_b128 v[120:123], v2 offset:39936
  s_add_u32 m0, s37, 0
  s_nop 0
  buffer_load_dwordx4 v20, s[4:7], s30 offen offset:0 sc1 lds
  v_mfma_f32_16x16x32_bf16 v[32:35], a[64:67], v[96:99], v[32:35]
  v_mfma_f32_16x16x32_bf16 v[48:51], a[68:71], v[96:99], v[48:51]
  buffer_load_dwordx4 v21, s[4:7], s30 offen offset:1024 sc1 lds
  v_mfma_f32_16x16x32_bf16 v[36:39], a[64:67], v[100:103], v[36:39]
  v_mfma_f32_16x16x32_bf16 v[52:55], a[68:71], v[100:103], v[52:55]
  buffer_load_dwordx4 v22, s[4:7], s30 offen offset:2048 sc1 lds
  v_mfma_f32_16x16x32_bf16 v[40:43], a[64:67], v[104:107], v[40:43]
  v_mfma_f32_16x16x32_bf16 v[56:59], a[68:71], v[104:107], v[56:59]
  buffer_load_dwordx4 v23, s[4:7], s30 offen offset:3072 sc1 lds
  s_add_u32 s30, s30, 128
  s_waitcnt lgkmcnt(0)
  v_mfma_f32_16x16x32_bf16 v[28:31], a[72:75], v[108:111], v[28:31]
  ds_read_b128 v[92:95], v2 offset:40960
  ds_read_b128 v[96:99], v2 offset:41984
  s_waitcnt vmcnt(12)
  v_mfma_f32_16x16x32_bf16 v[44:47], a[76:79], v[108:111], v[44:47]
  ds_read_b128 v[100:103], v2 offset:43008
  ds_read_b128 v[104:107], v2 offset:44032
  v_mfma_f32_16x16x32_bf16 v[32:35], a[72:75], v[112:115], v[32:35]
  ds_read_b128 a[80:83], v24 offset:4096
  v_mfma_f32_16x16x32_bf16 v[48:51], a[76:79], v[112:115], v[48:51]
  v_mfma_f32_16x16x32_bf16 v[36:39], a[72:75], v[116:119], v[36:39]
  ds_read_b128 a[84:87], v24 offset:6144
  v_mfma_f32_16x16x32_bf16 v[52:55], a[76:79], v[116:119], v[52:55]
  ds_read_b128 a[88:91], v25 offset:4096
  v_mfma_f32_16x16x32_bf16 v[40:43], a[72:75], v[120:123], v[40:43]
  v_mfma_f32_16x16x32_bf16 v[56:59], a[76:79], v[120:123], v[56:59]
  ds_read_b128 a[92:95], v25 offset:6144
  s_waitcnt lgkmcnt(0)
  v_mfma_f32_16x16x32_bf16 v[28:31], a[80:83], v[92:95], v[28:31]
  ds_read_b128 v[108:111], v2 offset:45056
  ds_read_b128 v[112:115], v2 offset:46080
  v_mfma_f32_16x16x32_bf16 v[44:47], a[84:87], v[92:95], v[44:47]
  ds_read_b128 v[116:119], v2 offset:47104
  ds_read_b128 v[120:123], v2 offset:48128
  s_add_u32 m0, s37, 4096
  s_nop 0
  buffer_load_dwordx4 v20, s[4:7], s30 offen offset:0 sc1 lds
  v_mfma_f32_16x16x32_bf16 v[32:35], a[80:83], v[96:99], v[32:35]
  v_mfma_f32_16x16x32_bf16 v[48:51], a[84:87], v[96:99], v[48:51]
  buffer_load_dwordx4 v21, s[4:7], s30 offen offset:1024 sc1 lds
  v_mfma_f32_16x16x32_bf16 v[36:39], a[80:83], v[100:103], v[36:39]
  v_mfma_f32_16x16x32_bf16 v[52:55], a[84:87], v[100:103], v[52:55]
  buffer_load_dwordx4 v22, s[4:7], s30 offen offset:2048 sc1 lds
  v_mfma_f32_16x16x32_bf16 v[40:43], a[80:83], v[104:107], v[40:43]
  v_mfma_f32_16x16x32_bf16 v[56:59], a[84:87], v[104:107], v[56:59]
  buffer_load_dwordx4 v23, s[4:7], s30 offen offset:3072 sc1 lds
  s_add_u32 s30, s30, 128
  s_waitcnt lgkmcnt(0)
  v_mfma_f32_16x16x32_bf16 v[28:31], a[88:91], v[108:111], v[28:31]
  ds_read_b128 v[92:95], v2 offset:49152
  ds_read_b128 v[96:99], v2 offset:50176
  s_waitcnt vmcnt(12)
  v_mfma_f32_16x16x32_bf16 v[44:47], a[92:95], v[108:111], v[44:47]
  ds_read_b128 v[100:103], v2 offset:51200
  ds_read_b128 v[104:107], v2 offset:52224
  v_mfma_f32_16x16x32_bf16 v[32:35], a[88:91], v[112:115], v[32:35]
  ds_read_b128 a[96:99], v24 offset:8192
  v_mfma_f32_16x16x32_bf16 v[48:51], a[92:95], v[112:115], v[48:51]
  v_mfma_f32_16x16x32_bf16 v[36:39], a[88:91], v[116:119], v[36:39]
  ds_read_b128 a[100:103], v24 offset:10240
  v_mfma_f32_16x16x32_bf16 v[52:55], a[92:95], v[116:119], v[52:55]
  ds_read_b128 a[104:107], v25 offset:8192
  v_mfma_f32_16x16x32_bf16 v[40:43], a[88:91], v[120:123], v[40:43]
  v_mfma_f32_16x16x32_bf16 v[56:59], a[92:95], v[120:123], v[56:59]
  ds_read_b128 a[108:111], v25 offset:10240
  s_waitcnt lgkmcnt(0)
  v_mfma_f32_16x16x32_bf16 v[28:31], a[96:99], v[92:95], v[28:31]
  ds_read_b128 v[108:111], v2 offset:53248
  ds_read_b128 v[112:115], v2 offset:54272
  v_mfma_f32_16x16x32_bf16 v[44:47], a[100:103], v[92:95], v[44:47]
  ds_read_b128 v[116:119], v2 offset:55296
  ds_read_b128 v[120:123], v2 offset:56320
  v_mfma_f32_16x16x32_bf16 v[32:35], a[96:99], v[96:99], v[32:35]
  v_mfma_f32_16x16x32_bf16 v[48:51], a[100:103], v[96:99], v[48:51]
  v_mfma_f32_16x16x32_bf16 v[36:39], a[96:99], v[100:103], v[36:39]
  v_mfma_f32_16x16x32_bf16 v[52:55], a[100:103], v[100:103], v[52:55]
  v_mfma_f32_16x16x32_bf16 v[40:43], a[96:99], v[104:107], v[40:43]
  v_mfma_f32_16x16x32_bf16 v[56:59], a[100:103], v[104:107], v[56:59]
  s_waitcnt lgkmcnt(0)
  v_mfma_f32_16x16x32_bf16 v[28:31], a[104:107], v[108:111], v[28:31]
  ds_read_b128 v[92:95], v2 offset:57344
  ds_read_b128 v[96:99], v2 offset:58368
  s_waitcnt vmcnt(8)
  v_mfma_f32_16x16x32_bf16 v[44:47], a[108:111], v[108:111], v[44:47]
  ds_read_b128 v[100:103], v2 offset:59392
  ds_read_b128 v[104:107], v2 offset:60416
  v_mfma_f32_16x16x32_bf16 v[32:35], a[104:107], v[112:115], v[32:35]
  ds_read_b128 a[112:115], v24 offset:12288
  v_mfma_f32_16x16x32_bf16 v[48:51], a[108:111], v[112:115], v[48:51]
  v_mfma_f32_16x16x32_bf16 v[36:39], a[104:107], v[116:119], v[36:39]
  ds_read_b128 a[116:119], v24 offset:14336
  v_mfma_f32_16x16x32_bf16 v[52:55], a[108:111], v[116:119], v[52:55]
  ds_read_b128 a[120:123], v25 offset:12288
  v_mfma_f32_16x16x32_bf16 v[40:43], a[104:107], v[120:123], v[40:43]
  v_mfma_f32_16x16x32_bf16 v[56:59], a[108:111], v[120:123], v[56:59]
  ds_read_b128 a[124:127], v25 offset:14336
  s_waitcnt lgkmcnt(0)
  v_mfma_f32_16x16x32_bf16 v[28:31], a[112:115], v[92:95], v[28:31]
  ds_read_b128 v[108:111], v2 offset:61440
  ds_read_b128 v[112:115], v2 offset:62464
  v_mfma_f32_16x16x32_bf16 v[44:47], a[116:119], v[92:95], v[44:47]
  ds_read_b128 v[116:119], v2 offset:63488
  ds_read_b128 v[120:123], v2 offset:64512
  v_mfma_f32_16x16x32_bf16 v[32:35], a[112:115], v[96:99], v[32:35]
  v_mfma_f32_16x16x32_bf16 v[48:51], a[116:119], v[96:99], v[48:51]
  v_mfma_f32_16x16x32_bf16 v[36:39], a[112:115], v[100:103], v[36:39]
  v_mfma_f32_16x16x32_bf16 v[52:55], a[116:119], v[100:103], v[52:55]
  v_mfma_f32_16x16x32_bf16 v[40:43], a[112:115], v[104:107], v[40:43]
  v_mfma_f32_16x16x32_bf16 v[56:59], a[116:119], v[104:107], v[56:59]
  s_waitcnt lgkmcnt(0)
  v_mfma_f32_16x16x32_bf16 v[28:31], a[120:123], v[108:111], v[28:31]
  ds_read_b128 v[92:95], v6 offset:0
  ds_read_b128 v[96:99], v6 offset:1024
  s_waitcnt vmcnt(4)
  v_mfma_f32_16x16x32_bf16 v[44:47], a[124:127], v[108:111], v[44:47]
  ds_read_b128 v[100:103], v6 offset:2048
  ds_read_b128 v[104:107], v6 offset:3072
  v_mfma_f32_16x16x32_bf16 v[32:35], a[120:123], v[112:115], v[32:35]
  ds_read_b128 a[128:131], v24 offset:0
  v_mfma_f32_16x16x32_bf16 v[48:51], a[124:127], v[112:115], v[48:51]
  v_mfma_f32_16x16x32_bf16 v[36:39], a[120:123], v[116:119], v[36:39]
  ds_read_b128 a[132:135], v24 offset:2048
  v_mfma_f32_16x16x32_bf16 v[52:55], a[124:127], v[116:119], v[52:55]
  ds_read_b128 a[136:139], v25 offset:0
  v_mfma_f32_16x16x32_bf16 v[40:43], a[120:123], v[120:123], v[40:43]
  v_mfma_f32_16x16x32_bf16 v[56:59], a[124:127], v[120:123], v[56:59]
  ds_read_b128 a[140:143], v25 offset:2048
  s_barrier
  s_waitcnt lgkmcnt(0)
  v_mfma_f32_16x16x32_bf16 v[28:31], a[128:131], v[92:95], v[28:31]
  ds_read_b128 v[108:111], v6 offset:4096
  ds_read_b128 v[112:115], v6 offset:5120
  s_add_u32 m0, s21, 0
  v_mfma_f32_16x16x32_bf16 v[44:47], a[132:135], v[92:95], v[44:47]
  ds_read_b128 v[116:119], v6 offset:6144
  ds_read_b128 v[120:123], v6 offset:7168
  buffer_load_dwordx4 v2, s[8:11], m0 offen sc1 lds
  v_mfma_f32_16x16x32_bf16 v[32:35], a[128:131], v[96:99], v[32:35]
  s_add_u32 m0, s21, 4096
  v_mfma_f32_16x16x32_bf16 v[48:51], a[132:135], v[96:99], v[48:51]
  buffer_load_dwordx4 v2, s[8:11], m0 offen sc1 lds
  v_mfma_f32_16x16x32_bf16 v[36:39], a[128:131], v[100:103], v[36:39]
  s_add_u32 m0, s21, 8192
  v_mfma_f32_16x16x32_bf16 v[52:55], a[132:135], v[100:103], v[52:55]
  buffer_load_dwordx4 v2, s[8:11], m0 offen sc1 lds
  v_mfma_f32_16x16x32_bf16 v[40:43], a[128:131], v[104:107], v[40:43]
  s_add_u32 m0, s21, 12288
  v_mfma_f32_16x16x32_bf16 v[56:59], a[132:135], v[104:107], v[56:59]
  buffer_load_dwordx4 v2, s[8:11], m0 offen sc1 lds
  s_waitcnt lgkmcnt(0)
  v_mfma_f32_16x16x32_bf16 v[28:31], a[136:139], v[108:111], v[28:31]
  ds_read_b128 v[92:95], v6 offset:8192
  ds_read_b128 v[96:99], v6 offset:9216
  s_waitcnt vmcnt(4)
  ds_read_b128 a[144:147], v24 offset:4096
  v_mfma_f32_16x16x32_bf16 v[44:47], a[140:143], v[108:111], v[44:47]
  ds_read_b128 v[100:103], v6 offset:10240
  ds_read_b128 v[104:107], v6 offset:11264
  ds_read_b128 a[148:151], v24 offset:6144
  v_mfma_f32_16x16x32_bf16 v[32:35], a[136:139], v[112:115], v[32:35]
  ds_read_b128 a[152:155], v25 offset:4096
  ds_read_b128 a[156:159], v25 offset:6144
  v_mfma_f32_16x16x32_bf16 v[48:51], a[140:143], v[112:115], v[48:51]
  s_add_u32 m0, s21, 16384
  v_mfma_f32_16x16x32_bf16 v[36:39], a[136:139], v[116:119], v[36:39]
  buffer_load_dwordx4 v2, s[8:11], m0 offen sc1 lds
  s_add_u32 m0, s21, 20480
  v_mfma_f32_16x16x32_bf16 v[52:55], a[140:143], v[116:119], v[52:55]
  buffer_load_dwordx4 v2, s[8:11], m0 offen sc1 lds
  s_add_u32 m0, s21, 24576
  v_mfma_f32_16x16x32_bf16 v[40:43], a[136:139], v[120:123], v[40:43]
  buffer_load_dwordx4 v2, s[8:11], m0 offen sc1 lds
  v_mfma_f32_16x16x32_bf16 v[56:59], a[140:143], v[120:123], v[56:59]
  s_add_u32 m0, s21, 28672
  s_nop 0
  buffer_load_dwordx4 v2, s[8:11], m0 offen sc1 lds
  s_waitcnt lgkmcnt(0)
  v_mfma_f32_16x16x32_bf16 v[28:31], a[144:147], v[92:95], v[28:31]
  ds_read_b128 v[108:111], v6 offset:12288
  ds_read_b128 v[112:115], v6 offset:13312
  s_add_u32 m0, s21, 32768
  v_mfma_f32_16x16x32_bf16 v[44:47], a[148:151], v[92:95], v[44:47]
  ds_read_b128 v[116:119], v6 offset:14336
  ds_read_b128 v[120:123], v6 offset:15360
  buffer_load_dwordx4 v2, s[8:11], m0 offen sc1 lds
  v_mfma_f32_16x16x32_bf16 v[32:35], a[144:147], v[96:99], v[32:35]
  s_add_u32 m0, s21, 36864
  v_mfma_f32_16x16x32_bf16 v[48:51], a[148:151], v[96:99], v[48:51]
  buffer_load_dwordx4 v2, s[8:11], m0 offen sc1 lds
  v_mfma_f32_16x16x32_bf16 v[36:39], a[144:147], v[100:103], v[36:39]
  s_add_u32 m0, s21, 40960
  v_mfma_f32_16x16x32_bf16 v[52:55], a[148:151], v[100:103], v[52:55]
  buffer_load_dwordx4 v2, s[8:11], m0 offen sc1 lds
  v_mfma_f32_16x16x32_bf16 v[40:43], a[144:147], v[104:107], v[40:43]
  s_add_u32 m0, s21, 45056
  v_mfma_f32_16x16x32_bf16 v[56:59], a[148:151], v[104:107], v[56:59]
  buffer_load_dwordx4 v2, s[8:11], m0 offen sc1 lds
  s_waitcnt lgkmcnt(3)
  v_mfma_f32_16x16x32_bf16 v[28:31], a[152:155], v[108:111], v[28:31]
  s_add_u32 m0, s21, 49152
  s_nop 0
  buffer_load_dwordx4 v2, s[8:11], m0 offen sc1 lds
  s_add_u32 m0, s21, 53248
  v_mfma_f32_16x16x32_bf16 v[44:47], a[156:159], v[108:111], v[44:47]
  buffer_load_dwordx4 v2, s[8:11], m0 offen sc1 lds
  s_add_u32 m0, s21, 57344
  s_waitcnt lgkmcnt(2)
  v_mfma_f32_16x16x32_bf16 v[32:35], a[152:155], v[112:115], v[32:35]
  buffer_load_dwordx4 v2, s[8:11], m0 offen sc1 lds
  s_lshl_b32 s29, s20, 9
  s_and_b32 s27, s2, 3
  v_mfma_f32_16x16x32_bf16 v[48:51], a[156:159], v[112:115], v[48:51]
  s_lshr_b32 s28, s2, 3
  s_lshl_b32 s27, s27, 5
  s_waitcnt lgkmcnt(1)
  v_mfma_f32_16x16x32_bf16 v[36:39], a[152:155], v[116:119], v[36:39]
  s_add_u32 s27, s27, s28
  s_lshl_b32 s27, s27, 16
  s_bfe_u32 s28, s2, 0x10002
  v_mfma_f32_16x16x32_bf16 v[52:55], a[156:159], v[116:119], v[52:55]
  s_lshl_b32 s28, s28, 11
  s_add_u32 s27, s27, s28
  s_add_u32 s27, s27, s29
  s_waitcnt lgkmcnt(0)
  v_mfma_f32_16x16x32_bf16 v[40:43], a[152:155], v[120:123], v[40:43]
  v_lshrrev_b32 v4, 2, v1
  v_and_b32 v5, 3, v1
  v_mfma_f32_16x16x32_bf16 v[56:59], a[156:159], v[120:123], v[56:59]
  v_lshlrev_b32 v4, 12, v4
  v_lshl_add_u32 v4, v5, 7, v4
  buffer_load_dword v172, v4, s[12:15], s27 offen
  s_barrier
  v_pk_mul_f32 v[124:125], v[28:29], v[28:29]
  v_pk_mul_f32 v[126:127], v[30:31], v[30:31]
  v_pk_mul_f32 v[128:129], v[44:45], v[44:45]
  v_pk_mul_f32 v[130:131], v[46:47], v[46:47]
  v_pk_fma_f32 v[124:125], v[124:125], s[38:39], v[26:27]
  v_pk_fma_f32 v[126:127], v[126:127], s[38:39], v[26:27]
  v_pk_fma_f32 v[128:129], v[128:129], s[38:39], v[26:27]
  v_pk_fma_f32 v[130:131], v[130:131], s[38:39], v[26:27]
  v_pk_mul_f32 v[124:125], v[124:125], v[28:29]
  v_pk_mul_f32 v[126:127], v[126:127], v[30:31]
  v_pk_mul_f32 v[128:129], v[128:129], v[44:45]
  v_pk_mul_f32 v[130:131], v[130:131], v[46:47]
  v_exp_f32 v124, v124
  v_exp_f32 v125, v125
  v_exp_f32 v126, v126
  v_exp_f32 v127, v127
  v_exp_f32 v128, v128
  v_exp_f32 v129, v129
  v_exp_f32 v130, v130
  v_exp_f32 v131, v131
  v_pk_add_f32 v[124:125], v[124:125], 1.0 op_sel_hi:[1,0]
  v_pk_add_f32 v[126:127], v[126:127], 1.0 op_sel_hi:[1,0]
  v_pk_add_f32 v[128:129], v[128:129], 1.0 op_sel_hi:[1,0]
  v_pk_add_f32 v[130:131], v[130:131], 1.0 op_sel_hi:[1,0]
  v_rcp_f32 v124, v124
  v_rcp_f32 v125, v125
  v_rcp_f32 v126, v126
  v_rcp_f32 v127, v127
  v_rcp_f32 v128, v128
  v_rcp_f32 v129, v129
  v_rcp_f32 v130, v130
  v_rcp_f32 v131, v131
  v_pk_mul_f32 v[28:29], v[28:29], v[124:125]
  v_pk_mul_f32 v[30:31], v[30:31], v[126:127]
  v_pk_mul_f32 v[44:45], v[44:45], v[128:129]
  v_pk_mul_f32 v[46:47], v[46:47], v[130:131]
  v_pk_mul_f32 v[156:157], v[28:29], v[28:29]
  v_pk_mul_f32 v[158:159], v[30:31], v[30:31]
  v_pk_mul_f32 v[160:161], v[44:45], v[44:45]
  v_pk_mul_f32 v[162:163], v[46:47], v[46:47]
  v_pk_mul_f32 v[124:125], v[32:33], v[32:33]
  v_pk_mul_f32 v[126:127], v[34:35], v[34:35]
  v_pk_mul_f32 v[128:129], v[48:49], v[48:49]
  v_pk_mul_f32 v[130:131], v[50:51], v[50:51]
  v_pk_fma_f32 v[124:125], v[124:125], s[38:39], v[26:27]
  v_pk_fma_f32 v[126:127], v[126:127], s[38:39], v[26:27]
  v_pk_fma_f32 v[128:129], v[128:129], s[38:39], v[26:27]
  v_pk_fma_f32 v[130:131], v[130:131], s[38:39], v[26:27]
  v_pk_mul_f32 v[124:125], v[124:125], v[32:33]
  v_pk_mul_f32 v[126:127], v[126:127], v[34:35]
  v_pk_mul_f32 v[128:129], v[128:129], v[48:49]
  v_pk_mul_f32 v[130:131], v[130:131], v[50:51]
  v_exp_f32 v124, v124
  v_exp_f32 v125, v125
  v_exp_f32 v126, v126
  v_exp_f32 v127, v127
  v_exp_f32 v128, v128
  v_exp_f32 v129, v129
  v_exp_f32 v130, v130
  v_exp_f32 v131, v131
  v_pk_add_f32 v[124:125], v[124:125], 1.0 op_sel_hi:[1,0]
  v_pk_add_f32 v[126:127], v[126:127], 1.0 op_sel_hi:[1,0]
  v_pk_add_f32 v[128:129], v[128:129], 1.0 op_sel_hi:[1,0]
  v_pk_add_f32 v[130:131], v[130:131], 1.0 op_sel_hi:[1,0]
  v_rcp_f32 v124, v124
  v_rcp_f32 v125, v125
  v_rcp_f32 v126, v126
  v_rcp_f32 v127, v127
  v_rcp_f32 v128, v128
  v_rcp_f32 v129, v129
  v_rcp_f32 v130, v130
  v_rcp_f32 v131, v131
  v_pk_mul_f32 v[32:33], v[32:33], v[124:125]
  v_pk_mul_f32 v[34:35], v[34:35], v[126:127]
  v_pk_mul_f32 v[48:49], v[48:49], v[128:129]
  v_pk_mul_f32 v[50:51], v[50:51], v[130:131]
  v_pk_add_f32 v[148:149], v[32:33], v[28:29]
  v_pk_fma_f32 v[156:157], v[32:33], v[32:33], v[156:157]
  v_pk_add_f32 v[150:151], v[34:35], v[30:31]
  v_pk_fma_f32 v[158:159], v[34:35], v[34:35], v[158:159]
  v_pk_add_f32 v[152:153], v[48:49], v[44:45]
  v_pk_fma_f32 v[160:161], v[48:49], v[48:49], v[160:161]
  v_pk_add_f32 v[154:155], v[50:51], v[46:47]
  v_pk_fma_f32 v[162:163], v[50:51], v[50:51], v[162:163]
  v_pk_mul_f32 v[124:125], v[36:37], v[36:37]
  v_pk_mul_f32 v[126:127], v[38:39], v[38:39]
  v_pk_mul_f32 v[128:129], v[52:53], v[52:53]
  v_pk_mul_f32 v[130:131], v[54:55], v[54:55]
  v_pk_fma_f32 v[124:125], v[124:125], s[38:39], v[26:27]
  v_pk_fma_f32 v[126:127], v[126:127], s[38:39], v[26:27]
  v_pk_fma_f32 v[128:129], v[128:129], s[38:39], v[26:27]
  v_pk_fma_f32 v[130:131], v[130:131], s[38:39], v[26:27]
  v_pk_mul_f32 v[124:125], v[124:125], v[36:37]
  v_pk_mul_f32 v[126:127], v[126:127], v[38:39]
  v_pk_mul_f32 v[128:129], v[128:129], v[52:53]
  v_pk_mul_f32 v[130:131], v[130:131], v[54:55]
  v_exp_f32 v124, v124
  v_exp_f32 v125, v125
  v_exp_f32 v126, v126
  v_exp_f32 v127, v127
  v_exp_f32 v128, v128
  v_exp_f32 v129, v129
  v_exp_f32 v130, v130
  v_exp_f32 v131, v131
  v_pk_add_f32 v[124:125], v[124:125], 1.0 op_sel_hi:[1,0]
  v_pk_add_f32 v[126:127], v[126:127], 1.0 op_sel_hi:[1,0]
  v_pk_add_f32 v[128:129], v[128:129], 1.0 op_sel_hi:[1,0]
  v_pk_add_f32 v[130:131], v[130:131], 1.0 op_sel_hi:[1,0]
  v_rcp_f32 v124, v124
  v_rcp_f32 v125, v125
  v_rcp_f32 v126, v126
  v_rcp_f32 v127, v127
  v_rcp_f32 v128, v128
  v_rcp_f32 v129, v129
  v_rcp_f32 v130, v130
  v_rcp_f32 v131, v131
  v_pk_mul_f32 v[36:37], v[36:37], v[124:125]
  v_pk_mul_f32 v[38:39], v[38:39], v[126:127]
  v_pk_mul_f32 v[52:53], v[52:53], v[128:129]
  v_pk_mul_f32 v[54:55], v[54:55], v[130:131]
  v_pk_add_f32 v[148:149], v[36:37], v[148:149]
  v_pk_fma_f32 v[156:157], v[36:37], v[36:37], v[156:157]
  v_pk_add_f32 v[150:151], v[38:39], v[150:151]
  v_pk_fma_f32 v[158:159], v[38:39], v[38:39], v[158:159]
  v_pk_add_f32 v[152:153], v[52:53], v[152:153]
  v_pk_fma_f32 v[160:161], v[52:53], v[52:53], v[160:161]
  v_pk_add_f32 v[154:155], v[54:55], v[154:155]
  v_pk_fma_f32 v[162:163], v[54:55], v[54:55], v[162:163]
  v_pk_mul_f32 v[124:125], v[40:41], v[40:41]
  v_pk_mul_f32 v[126:127], v[42:43], v[42:43]
  v_pk_mul_f32 v[128:129], v[56:57], v[56:57]
  v_pk_mul_f32 v[130:131], v[58:59], v[58:59]
  v_pk_fma_f32 v[124:125], v[124:125], s[38:39], v[26:27]
  v_pk_fma_f32 v[126:127], v[126:127], s[38:39], v[26:27]
  v_pk_fma_f32 v[128:129], v[128:129], s[38:39], v[26:27]
  v_pk_fma_f32 v[130:131], v[130:131], s[38:39], v[26:27]
  v_pk_mul_f32 v[124:125], v[124:125], v[40:41]
  v_pk_mul_f32 v[126:127], v[126:127], v[42:43]
  v_pk_mul_f32 v[128:129], v[128:129], v[56:57]
  v_pk_mul_f32 v[130:131], v[130:131], v[58:59]
  v_exp_f32 v124, v124
  v_exp_f32 v125, v125
  v_exp_f32 v126, v126
  v_exp_f32 v127, v127
  v_exp_f32 v128, v128
  v_exp_f32 v129, v129
  v_exp_f32 v130, v130
  v_exp_f32 v131, v131
  v_pk_add_f32 v[124:125], v[124:125], 1.0 op_sel_hi:[1,0]
  v_pk_add_f32 v[126:127], v[126:127], 1.0 op_sel_hi:[1,0]
  v_pk_add_f32 v[128:129], v[128:129], 1.0 op_sel_hi:[1,0]
  v_pk_add_f32 v[130:131], v[130:131], 1.0 op_sel_hi:[1,0]
  v_rcp_f32 v124, v124
  v_rcp_f32 v125, v125
  v_rcp_f32 v126, v126
  v_rcp_f32 v127, v127
  v_rcp_f32 v128, v128
  v_rcp_f32 v129, v129
  v_rcp_f32 v130, v130
  v_rcp_f32 v131, v131
  v_pk_mul_f32 v[40:41], v[40:41], v[124:125]
  v_pk_mul_f32 v[42:43], v[42:43], v[126:127]
  v_pk_mul_f32 v[56:57], v[56:57], v[128:129]
  v_pk_mul_f32 v[58:59], v[58:59], v[130:131]
  v_cvt_pk_bf16_f32 v252, v40, v41
  v_cvt_pk_bf16_f32 v253, v42, v43
  v_cvt_pk_bf16_f32 v254, v56, v57
  v_cvt_pk_bf16_f32 v255, v58, v59
  ds_write_b64 v84, v[252:253] offset:0
  ds_write_b64 v84, v[254:255] offset:32
  v_cndmask_b32 v40, 0, v40, s[42:43]
  v_cndmask_b32 v41, 0, v41, s[42:43]
  v_cndmask_b32 v42, 0, v42, s[42:43]
  v_cndmask_b32 v43, 0, v43, s[42:43]
  v_cndmask_b32 v56, 0, v56, s[42:43]
  v_cndmask_b32 v57, 0, v57, s[42:43]
  v_cndmask_b32 v58, 0, v58, s[42:43]
  v_cndmask_b32 v59, 0, v59, s[42:43]
  ds_read_b64_tr_b16 v[252:253], v85 offset:0
  ds_read_b64_tr_b16 v[254:255], v85 offset:32
  v_pk_add_f32 v[148:149], v[40:41], v[148:149]
  v_pk_fma_f32 v[156:157], v[40:41], v[40:41], v[156:157]
  v_pk_add_f32 v[150:151], v[42:43], v[150:151]
  v_pk_fma_f32 v[158:159], v[42:43], v[42:43], v[158:159]
  v_pk_add_f32 v[152:153], v[56:57], v[152:153]
  v_pk_fma_f32 v[160:161], v[56:57], v[56:57], v[160:161]
  v_pk_add_f32 v[154:155], v[58:59], v[154:155]
  v_pk_fma_f32 v[162:163], v[58:59], v[58:59], v[162:163]
  v_add_f32_dpp v148, v148, v148 row_ror:8 row_mask:0xf bank_mask:0x3
  v_add_f32_dpp v149, v149, v149 row_ror:8 row_mask:0xf bank_mask:0x3
  v_add_f32_dpp v150, v150, v150 row_ror:8 row_mask:0xf bank_mask:0x3
  v_add_f32_dpp v151, v151, v151 row_ror:8 row_mask:0xf bank_mask:0x3
  v_add_f32_dpp v156, v156, v156 row_ror:8 row_mask:0xf bank_mask:0x3
  v_add_f32_dpp v157, v157, v157 row_ror:8 row_mask:0xf bank_mask:0x3
  v_add_f32_dpp v158, v158, v158 row_ror:8 row_mask:0xf bank_mask:0x3
  v_add_f32_dpp v159, v159, v159 row_ror:8 row_mask:0xf bank_mask:0x3
  v_add_f32_dpp v148, v152, v152 row_ror:8 row_mask:0xf bank_mask:0xc
  v_add_f32_dpp v149, v153, v153 row_ror:8 row_mask:0xf bank_mask:0xc
  v_add_f32_dpp v150, v154, v154 row_ror:8 row_mask:0xf bank_mask:0xc
  v_add_f32_dpp v151, v155, v155 row_ror:8 row_mask:0xf bank_mask:0xc
  v_add_f32_dpp v156, v160, v160 row_ror:8 row_mask:0xf bank_mask:0xc
  v_add_f32_dpp v157, v161, v161 row_ror:8 row_mask:0xf bank_mask:0xc
  v_add_f32_dpp v158, v162, v162 row_ror:8 row_mask:0xf bank_mask:0xc
  v_add_f32_dpp v159, v163, v163 row_ror:8 row_mask:0xf bank_mask:0xc
  v_add_f32_dpp v148, v148, v148 row_half_mirror row_mask:0xf bank_mask:0x5
  v_add_f32_dpp v149, v149, v149 row_half_mirror row_mask:0xf bank_mask:0x5
  v_add_f32_dpp v156, v156, v156 row_half_mirror row_mask:0xf bank_mask:0x5
  v_add_f32_dpp v157, v157, v157 row_half_mirror row_mask:0xf bank_mask:0x5
  v_add_f32_dpp v148, v150, v150 row_half_mirror row_mask:0xf bank_mask:0xa
  v_add_f32_dpp v149, v151, v151 row_half_mirror row_mask:0xf bank_mask:0xa
  v_add_f32_dpp v156, v158, v158 row_half_mirror row_mask:0xf bank_mask:0xa
  v_add_f32_dpp v157, v159, v159 row_half_mirror row_mask:0xf bank_mask:0xa
  v_add_f32_dpp v148, v148, v148 quad_perm:[2,3,0,1] row_mask:0xf bank_mask:0xf
  v_add_f32_dpp v149, v149, v149 quad_perm:[2,3,0,1] row_mask:0xf bank_mask:0xf
  v_add_f32_dpp v156, v156, v156 quad_perm:[2,3,0,1] row_mask:0xf bank_mask:0xf
  v_add_f32_dpp v157, v157, v157 quad_perm:[2,3,0,1] row_mask:0xf bank_mask:0xf
  v_add_f32_dpp v148, v148, v148 quad_perm:[1,0,3,2] row_mask:0xf bank_mask:0xf
  v_add_f32_dpp v149, v149, v149 quad_perm:[1,0,3,2] row_mask:0xf bank_mask:0xf
  v_add_f32_dpp v156, v156, v156 quad_perm:[1,0,3,2] row_mask:0xf bank_mask:0xf
  v_add_f32_dpp v157, v157, v157 quad_perm:[1,0,3,2] row_mask:0xf bank_mask:0xf
  v_cndmask_b32 v148, v148, v149, s[40:41]
  v_cndmask_b32 v149, v156, v157, s[40:41]
  v_and_b32 v148, -2, v148
  v_and_b32 v149, -2, v149
  s_lshl_b32 s27, s23, 8
  s_add_u32 s27, s27, s31
  s_mov_b32 exec_lo, 0x33333333
  s_mov_b32 exec_hi, 0x33333333
  buffer_store_dwordx2 v[148:149], v18, s[4:7], s27 offen sc0 sc1
  s_mov_b64 exec, -1
  s_waitcnt vmcnt(2)
  s_barrier
  ds_read_b128 v[92:95], v2 offset:0
  ds_read_b128 v[96:99], v2 offset:1024
  ds_read_b128 v[100:103], v2 offset:2048
  s_waitcnt lgkmcnt(0)
  v_mfma_f32_16x16x32_bf16 v[60:63], v[92:95], a[0:3], 0
  ds_read_b128 v[108:111], v2 offset:3072
  ds_read_b128 v[112:115], v2 offset:4096
  s_add_u32 m0, s33, 8192
  s_nop 0
  buffer_load_dwordx4 v10, s[12:15], s34 offen offset:0 lds
  v_mfma_f32_16x16x32_bf16 v[72:75], v[92:95], a[4:7], 0
  ds_read_b128 v[116:119], v2 offset:5120
  v_mfma_f32_16x16x32_bf16 v[64:67], v[96:99], a[0:3], 0
  buffer_load_dwordx4 v11, s[12:15], s34 offen offset:1024 lds
  v_mfma_f32_16x16x32_bf16 v[76:79], v[96:99], a[4:7], 0
  buffer_load_dwordx4 v12, s[12:15], s34 offen offset:2048 lds
  v_mfma_f32_16x16x32_bf16 v[68:71], v[100:103], a[0:3], 0
  v_mfma_f32_16x16x32_bf16 v[80:83], v[100:103], a[4:7], 0
  buffer_load_dwordx4 v13, s[12:15], s34 offen offset:3072 lds
  s_add_u32 s34, s34, 128
  s_waitcnt lgkmcnt(0)
  v_mfma_f32_16x16x32_bf16 v[60:63], v[108:111], a[8:11], v[60:63]
  ds_read_b128 v[92:95], v2 offset:6144
  ds_read_b128 v[96:99], v2 offset:7168
  s_add_u32 m0, s33, 12288
  s_nop 0
  buffer_load_dwordx4 v10, s[12:15], s34 offen offset:0 lds
  v_mfma_f32_16x16x32_bf16 v[72:75], v[108:111], a[12:15], v[72:75]
  ds_read_b128 v[100:103], v2 offset:8192
  v_mfma_f32_16x16x32_bf16 v[64:67], v[112:115], a[8:11], v[64:67]
  buffer_load_dwordx4 v11, s[12:15], s34 offen offset:1024 lds
  v_mfma_f32_16x16x32_bf16 v[76:79], v[112:115], a[12:15], v[76:79]
  buffer_load_dwordx4 v12, s[12:15], s34 offen offset:2048 lds
  v_mfma_f32_16x16x32_bf16 v[68:71], v[116:119], a[8:11], v[68:71]
  v_mfma_f32_16x16x32_bf16 v[80:83], v[116:119], a[12:15], v[80:83]
  buffer_load_dwordx4 v13, s[12:15], s34 offen offset:3072 lds
  s_add_u32 s34, s34, 128
  s_waitcnt lgkmcnt(0)
  v_mfma_f32_16x16x32_bf16 v[60:63], v[92:95], a[16:19], v[60:63]
  ds_read_b128 v[108:111], v2 offset:9216
  ds_read_b128 v[112:115], v2 offset:10240
  s_add_u32 m0, s33, 0
  s_nop 0
  buffer_load_dwordx4 v10, s[12:15], s34 offen offset:0 lds
  v_mfma_f32_16x16x32_bf16 v[72:75], v[92:95], a[20:23], v[72:75]
  ds_read_b128 v[116:119], v2 offset:11264
  v_mfma_f32_16x16x32_bf16 v[64:67], v[96:99], a[16:19], v[64:67]
  buffer_load_dwordx4 v11, s[12:15], s34 offen offset:1024 lds
  v_mfma_f32_16x16x32_bf16 v[76:79], v[96:99], a[20:23], v[76:79]
  buffer_load_dwordx4 v12, s[12:15], s34 offen offset:2048 lds
  v_mfma_f32_16x16x32_bf16 v[68:71], v[100:103], a[16:19], v[68:71]
  v_mfma_f32_16x16x32_bf16 v[80:83], v[100:103], a[20:23], v[80:83]
  buffer_load_dwordx4 v13, s[12:15], s34 offen offset:3072 lds
  s_add_u32 s34, s34, 128
  s_waitcnt lgkmcnt(0)
  v_mfma_f32_16x16x32_bf16 v[60:63], v[108:111], a[24:27], v[60:63]
  ds_read_b128 v[92:95], v2 offset:12288
  ds_read_b128 v[96:99], v2 offset:13312
  s_add_u32 m0, s33, 4096
  s_nop 0
  buffer_load_dwordx4 v10, s[12:15], s34 offen offset:0 lds
  v_mfma_f32_16x16x32_bf16 v[72:75], v[108:111], a[28:31], v[72:75]
  ds_read_b128 v[100:103], v2 offset:14336
  v_mfma_f32_16x16x32_bf16 v[64:67], v[112:115], a[24:27], v[64:67]
  buffer_load_dwordx4 v11, s[12:15], s34 offen offset:1024 lds
  v_mfma_f32_16x16x32_bf16 v[76:79], v[112:115], a[28:31], v[76:79]
  buffer_load_dwordx4 v12, s[12:15], s34 offen offset:2048 lds
  v_mfma_f32_16x16x32_bf16 v[68:71], v[116:119], a[24:27], v[68:71]
  v_mfma_f32_16x16x32_bf16 v[80:83], v[116:119], a[28:31], v[80:83]
  buffer_load_dwordx4 v13, s[12:15], s34 offen offset:3072 lds
  s_add_u32 s34, s34, 128
  s_waitcnt lgkmcnt(0)
  v_mfma_f32_16x16x32_bf16 v[60:63], v[92:95], a[32:35], v[60:63]
  ds_read_b128 v[108:111], v2 offset:15360
  ds_read_b128 v[112:115], v2 offset:16384
  v_mfma_f32_16x16x32_bf16 v[72:75], v[92:95], a[36:39], v[72:75]
  ds_read_b128 v[116:119], v2 offset:17408
  v_mfma_f32_16x16x32_bf16 v[64:67], v[96:99], a[32:35], v[64:67]
  v_mfma_f32_16x16x32_bf16 v[76:79], v[96:99], a[36:39], v[76:79]
  v_mfma_f32_16x16x32_bf16 v[68:71], v[100:103], a[32:35], v[68:71]
  v_mfma_f32_16x16x32_bf16 v[80:83], v[100:103], a[36:39], v[80:83]
  s_waitcnt lgkmcnt(0)
  v_mfma_f32_16x16x32_bf16 v[60:63], v[108:111], a[40:43], v[60:63]
  ds_read_b128 v[92:95], v2 offset:18432
  ds_read_b128 v[96:99], v2 offset:19456
  v_mfma_f32_16x16x32_bf16 v[72:75], v[108:111], a[44:47], v[72:75]
  ds_read_b128 v[100:103], v2 offset:20480
  v_mfma_f32_16x16x32_bf16 v[64:67], v[112:115], a[40:43], v[64:67]
  v_mfma_f32_16x16x32_bf16 v[76:79], v[112:115], a[44:47], v[76:79]
  v_mfma_f32_16x16x32_bf16 v[68:71], v[116:119], a[40:43], v[68:71]
  v_mfma_f32_16x16x32_bf16 v[80:83], v[116:119], a[44:47], v[80:83]
  s_waitcnt lgkmcnt(0)
  buffer_load_dwordx2 v[164:165], v86, s[4:7], s31 offen offset:0 sc0 sc1
  buffer_load_dwordx2 v[166:167], v86, s[4:7], s31 offen offset:256 sc0 sc1
  buffer_load_dwordx2 v[168:169], v86, s[4:7], s31 offen offset:512 sc0 sc1
  buffer_load_dwordx2 v[170:171], v86, s[4:7], s31 offen offset:768 sc0 sc1
  s_waitcnt vmcnt(21)
  buffer_load_dwordx2 v[172:173], v86, s[4:7], s31 offen offset:1024 sc0 sc1
  buffer_load_dwordx2 v[174:175], v86, s[4:7], s31 offen offset:1280 sc0 sc1
  buffer_load_dwordx2 v[176:177], v86, s[4:7], s31 offen offset:1536 sc0 sc1
  buffer_load_dwordx2 v[178:179], v86, s[4:7], s31 offen offset:1792 sc0 sc1
  v_mfma_f32_16x16x32_bf16 v[60:63], v[92:95], a[48:51], v[60:63]
  ds_read_b128 v[108:111], v2 offset:21504
  ds_read_b128 v[112:115], v2 offset:22528
  v_mfma_f32_16x16x32_bf16 v[72:75], v[92:95], a[52:55], v[72:75]
  ds_read_b128 v[116:119], v2 offset:23552
  v_mfma_f32_16x16x32_bf16 v[64:67], v[96:99], a[48:51], v[64:67]
  v_mfma_f32_16x16x32_bf16 v[76:79], v[96:99], a[52:55], v[76:79]
  v_mfma_f32_16x16x32_bf16 v[68:71], v[100:103], a[48:51], v[68:71]
  v_mfma_f32_16x16x32_bf16 v[80:83], v[100:103], a[52:55], v[80:83]
  s_waitcnt lgkmcnt(0)
  v_mfma_f32_16x16x32_bf16 v[60:63], v[108:111], a[56:59], v[60:63]
  ds_read_b128 v[92:95], v2 offset:24576
  ds_read_b128 v[96:99], v2 offset:25600
  v_mfma_f32_16x16x32_bf16 v[72:75], v[108:111], a[60:63], v[72:75]
  ds_read_b128 v[100:103], v2 offset:26624
  v_mfma_f32_16x16x32_bf16 v[64:67], v[112:115], a[56:59], v[64:67]
  v_mfma_f32_16x16x32_bf16 v[76:79], v[112:115], a[60:63], v[76:79]
  v_mfma_f32_16x16x32_bf16 v[68:71], v[116:119], a[56:59], v[68:71]
  v_mfma_f32_16x16x32_bf16 v[80:83], v[116:119], a[60:63], v[80:83]
  s_waitcnt lgkmcnt(0)
  v_mfma_f32_16x16x32_bf16 v[60:63], v[92:95], a[64:67], v[60:63]
  ds_read_b128 v[108:111], v2 offset:27648
  ds_read_b128 v[112:115], v2 offset:28672
  s_waitcnt vmcnt(20)
  v_mfma_f32_16x16x32_bf16 v[72:75], v[92:95], a[68:71], v[72:75]
  ds_read_b128 v[116:119], v2 offset:29696
  ds_read_b64 a[0:1], v14 offset:8192
  ds_read_b64 a[2:3], v15 offset:8192
  v_mfma_f32_16x16x32_bf16 v[64:67], v[96:99], a[64:67], v[64:67]
  ds_read_b64 a[4:5], v14 offset:10240
  v_mfma_f32_16x16x32_bf16 v[76:79], v[96:99], a[68:71], v[76:79]
  ds_read_b64 a[6:7], v15 offset:10240
  ds_read_b64 a[8:9], v16 offset:8192
  v_mfma_f32_16x16x32_bf16 v[68:71], v[100:103], a[64:67], v[68:71]
  ds_read_b64 a[10:11], v17 offset:8192
  v_mfma_f32_16x16x32_bf16 v[80:83], v[100:103], a[68:71], v[80:83]
  ds_read_b64 a[12:13], v16 offset:10240
  ds_read_b64 a[14:15], v17 offset:10240
  s_waitcnt lgkmcnt(0)
  v_mfma_f32_16x16x32_bf16 v[60:63], v[108:111], a[72:75], v[60:63]
  ds_read_b128 v[92:95], v2 offset:30720
  ds_read_b128 v[96:99], v2 offset:31744
  s_add_u32 m0, s33, 8192
  s_nop 0
  buffer_load_dwordx4 v10, s[12:15], s34 offen offset:0 lds
  v_mfma_f32_16x16x32_bf16 v[72:75], v[108:111], a[76:79], v[72:75]
  ds_read_b128 v[100:103], v2 offset:32768
  v_mfma_f32_16x16x32_bf16 v[64:67], v[112:115], a[72:75], v[64:67]
  buffer_load_dwordx4 v11, s[12:15], s34 offen offset:1024 lds
  v_mfma_f32_16x16x32_bf16 v[76:79], v[112:115], a[76:79], v[76:79]
  buffer_load_dwordx4 v12, s[12:15], s34 offen offset:2048 lds
  v_mfma_f32_16x16x32_bf16 v[68:71], v[116:119], a[72:75], v[68:71]
  v_mfma_f32_16x16x32_bf16 v[80:83], v[116:119], a[76:79], v[80:83]
  buffer_load_dwordx4 v13, s[12:15], s34 offen offset:3072 lds
  s_add_u32 s34, s34, 128
  s_waitcnt lgkmcnt(0)
  v_mfma_f32_16x16x32_bf16 v[60:63], v[92:95], a[80:83], v[60:63]
  ds_read_b128 v[108:111], v2 offset:33792
  ds_read_b128 v[112:115], v2 offset:34816
  s_waitcnt vmcnt(20)
  v_mfma_f32_16x16x32_bf16 v[72:75], v[92:95], a[84:87], v[72:75]
  ds_read_b128 v[116:119], v2 offset:35840
  ds_read_b64 a[16:17], v14 offset:12288
  ds_read_b64 a[18:19], v15 offset:12288
  v_mfma_f32_16x16x32_bf16 v[64:67], v[96:99], a[80:83], v[64:67]
  ds_read_b64 a[20:21], v14 offset:14336
  v_mfma_f32_16x16x32_bf16 v[76:79], v[96:99], a[84:87], v[76:79]
  ds_read_b64 a[22:23], v15 offset:14336
  ds_read_b64 a[24:25], v16 offset:12288
  v_mfma_f32_16x16x32_bf16 v[68:71], v[100:103], a[80:83], v[68:71]
  ds_read_b64 a[26:27], v17 offset:12288
  v_mfma_f32_16x16x32_bf16 v[80:83], v[100:103], a[84:87], v[80:83]
  ds_read_b64 a[28:29], v16 offset:14336
  ds_read_b64 a[30:31], v17 offset:14336
  s_waitcnt lgkmcnt(0)
  v_mfma_f32_16x16x32_bf16 v[60:63], v[108:111], a[88:91], v[60:63]
  ds_read_b128 v[92:95], v2 offset:36864
  ds_read_b128 v[96:99], v2 offset:37888
  s_add_u32 m0, s33, 12288
  s_nop 0
  buffer_load_dwordx4 v10, s[12:15], s34 offen offset:0 lds
  v_mfma_f32_16x16x32_bf16 v[72:75], v[108:111], a[92:95], v[72:75]
  ds_read_b128 v[100:103], v2 offset:38912
  v_mfma_f32_16x16x32_bf16 v[64:67], v[112:115], a[88:91], v[64:67]
  buffer_load_dwordx4 v11, s[12:15], s34 offen offset:1024 lds
  v_mfma_f32_16x16x32_bf16 v[76:79], v[112:115], a[92:95], v[76:79]
  buffer_load_dwordx4 v12, s[12:15], s34 offen offset:2048 lds
  v_mfma_f32_16x16x32_bf16 v[68:71], v[116:119], a[88:91], v[68:71]
  v_mfma_f32_16x16x32_bf16 v[80:83], v[116:119], a[92:95], v[80:83]
  buffer_load_dwordx4 v13, s[12:15], s34 offen offset:3072 lds
  s_add_u32 s34, s34, 128
  s_mov_b32 s32, 0
  s_waitcnt vmcnt(14)
  v_max3_u32 v4, v164, v165, v166
  s_waitcnt vmcnt(13)
  v_max3_u32 v4, v4, v167, v168
  s_waitcnt vmcnt(12)
  v_max3_u32 v4, v4, v169, v170
  s_waitcnt vmcnt(11)
  v_max3_u32 v4, v4, v171, v172
  s_waitcnt vmcnt(10)
  v_max3_u32 v4, v4, v173, v174
  s_waitcnt vmcnt(9)
  v_max3_u32 v4, v4, v175, v176
  s_waitcnt vmcnt(8)
  v_max3_u32 v4, v4, v177, v178
  v_max_u32 v4, v4, v179
  v_cmp_eq_u32 vcc, -1, v4
  s_nop 0
  s_cmp_eq_u64 vcc, 0
  s_cbranch_scc1 kg_g_ok
kg_g_again:
  s_sleep 2
  buffer_load_dwordx2 v[164:165], v86, s[4:7], s31 offen offset:0 sc0 sc1
  buffer_load_dwordx2 v[166:167], v86, s[4:7], s31 offen offset:256 sc0 sc1
  buffer_load_dwordx2 v[168:169], v86, s[4:7], s31 offen offset:512 sc0 sc1
  buffer_load_dwordx2 v[170:171], v86, s[4:7], s31 offen offset:768 sc0 sc1
  buffer_load_dwordx2 v[172:173], v86, s[4:7], s31 offen offset:1024 sc0 sc1
  buffer_load_dwordx2 v[174:175], v86, s[4:7], s31 offen offset:1280 sc0 sc1
  buffer_load_dwordx2 v[176:177], v86, s[4:7], s31 offen offset:1536 sc0 sc1
  buffer_load_dwordx2 v[178:179], v86, s[4:7], s31 offen offset:1792 sc0 sc1
  s_add_u32 s32, s32, 1
  s_waitcnt vmcnt(6)
  v_max3_u32 v4, v164, v165, v166
  s_waitcnt vmcnt(5)
  v_max3_u32 v4, v4, v167, v168
  s_waitcnt vmcnt(4)
  v_max3_u32 v4, v4, v169, v170
  s_waitcnt vmcnt(3)
  v_max3_u32 v4, v4, v171, v172
  s_waitcnt vmcnt(2)
  v_max3_u32 v4, v4, v173, v174
  s_waitcnt vmcnt(1)
  v_max3_u32 v4, v4, v175, v176
  s_waitcnt vmcnt(0)
  v_max3_u32 v4, v4, v177, v178
  v_max_u32 v4, v4, v179
  v_cmp_eq_u32 vcc, -1, v4
  s_nop 0
  s_cmp_eq_u64 vcc, 0
  s_cbranch_scc1 kg_g_ok
  s_cmp_lt_u32 s32, 100000
  s_cbranch_scc1 kg_g_again
kg_g_ok:
  v_pk_add_f32 v[164:165], v[164:165], v[172:173]
  v_pk_add_f32 v[166:167], v[166:167], v[174:175]
  v_pk_add_f32 v[168:169], v[168:169], v[176:177]
  v_pk_add_f32 v[170:171], v[170:171], v[178:179]
  v_pk_add_f32 v[164:165], v[164:165], v[168:169]
  v_pk_add_f32 v[166:167], v[166:167], v[170:171]
  v_pk_add_f32 v[164:165], v[164:165], v[166:167]
  v_mov_b32 v166, v164
  v_mov_b32 v167, v165
  s_nop 0
  v_permlane32_swap_b32 v164, v166
  v_permlane32_swap_b32 v165, v167
  v_pk_add_f32 v[164:165], v[164:165], v[166:167]
  v_mul_f32 v164, 0xba97b426, v164
  v_mul_f32 v165, 0x3a97b426, v165
  v_fma_f32 v165, -v164, v164, v165
  v_max_f32 v165, 0, v165
  v_add_f32 v165, 0x3727c5ac, v165
  v_rsq_f32 v165, v165
  s_nop 0
  v_mul_f32 v164, v164, v165
  ds_write_b32 v87, v164
  ds_write_b32 v87, v165 offset:128
  ds_read_b128 v[148:151], v88 offset:0
  ds_read_b128 v[156:159], v88 offset:128
  ds_read_b128 v[152:155], v88 offset:64
  ds_read_b128 v[160:163], v88 offset:192
  s_and_b32 s27, s23, 14
  s_lshr_b32 s28, s22, 5
  s_add_u32 s27, s27, s28
  s_mul_i32 s27, s27, 229376
  s_add_u32 s27, s27, 20414464
  s_and_b32 s29, s22, 31
  s_mul_i32 s30, s29, 3072
  s_add_u32 s30, s30, 131072
  s_lshl_b32 s29, s29, 12
  s_cmp_eq_u32 s28, s24
  s_cselect_b32 s30, s30, s29
  s_add_u32 s30, s30, s27
  s_add_u32 s27, s27, s29
  s_waitcnt lgkmcnt(2)
  v_pk_fma_f32 v[28:29], v[28:29], v[156:157], v[148:149]
  v_pk_fma_f32 v[30:31], v[30:31], v[158:159], v[150:151]
  s_waitcnt lgkmcnt(0)
  v_pk_fma_f32 v[44:45], v[44:45], v[160:161], v[152:153]
  v_pk_fma_f32 v[46:47], v[46:47], v[162:163], v[154:155]
  v_cvt_pk_bf16_f32 v132, v28, v29
  v_cvt_pk_bf16_f32 v133, v30, v31
  v_cvt_pk_bf16_f32 v134, v44, v45
  v_cvt_pk_bf16_f32 v135, v46, v47
  buffer_store_dwordx4 v[132:135], v2, s[4:7], s30 offen offset:0 sc1
  v_pk_fma_f32 v[32:33], v[32:33], v[156:157], v[148:149]
  v_pk_fma_f32 v[34:35], v[34:35], v[158:159], v[150:151]
  v_pk_fma_f32 v[48:49], v[48:49], v[160:161], v[152:153]
  v_pk_fma_f32 v[50:51], v[50:51], v[162:163], v[154:155]
  v_cvt_pk_bf16_f32 v136, v32, v33
  v_cvt_pk_bf16_f32 v137, v34, v35
  v_cvt_pk_bf16_f32 v138, v48, v49
  v_cvt_pk_bf16_f32 v139, v50, v51
  buffer_store_dwordx4 v[136:139], v2, s[4:7], s30 offen offset:1024 sc1
  v_pk_fma_f32 v[36:37], v[36:37], v[156:157], v[148:149]
  v_pk_fma_f32 v[38:39], v[38:39], v[158:159], v[150:151]
  v_pk_fma_f32 v[52:53], v[52:53], v[160:161], v[152:153]
  v_pk_fma_f32 v[54:55], v[54:55], v[162:163], v[154:155]
  v_cvt_pk_bf16_f32 v140, v36, v37
  v_cvt_pk_bf16_f32 v141, v38, v39
  v_cvt_pk_bf16_f32 v142, v52, v53
  v_cvt_pk_bf16_f32 v143, v54, v55
  buffer_store_dwordx4 v[140:143], v2, s[4:7], s30 offen offset:2048 sc1
  v_pk_fma_f32 v[40:41], v[40:41], v[156:157], v[148:149]
  v_pk_fma_f32 v[42:43], v[42:43], v[158:159], v[150:151]
  v_pk_fma_f32 v[56:57], v[56:57], v[160:161], v[152:153]
  v_pk_fma_f32 v[58:59], v[58:59], v[162:163], v[154:155]
  v_cvt_pk_bf16_f32 v144, v40, v41
  v_cvt_pk_bf16_f32 v145, v42, v43
  v_cvt_pk_bf16_f32 v146, v56, v57
  v_cvt_pk_bf16_f32 v147, v58, v59
  s_mov_b64 exec, s[42:43]
  buffer_store_dwordx4 v[144:147], v2, s[4:7], s27 offen offset:3072 sc1
  s_mov_b64 exec, -1
  s_waitcnt lgkmcnt(0)
  v_mfma_f32_16x16x32_bf16 v[60:63], v[92:95], a[96:99], v[60:63]
  ds_read_b128 v[108:111], v2 offset:39936
  ds_read_b128 v[112:115], v2 offset:40960
  v_mfma_f32_16x16x32_bf16 v[72:75], v[92:95], a[100:103], v[72:75]
  ds_read_b128 v[116:119], v2 offset:41984
  ds_read_b64 a[32:33], v14 offset:0
  ds_read_b64 a[34:35], v15 offset:0
  v_mfma_f32_16x16x32_bf16 v[64:67], v[96:99], a[96:99], v[64:67]
  ds_read_b64 a[36:37], v14 offset:2048
  v_mfma_f32_16x16x32_bf16 v[76:79], v[96:99], a[100:103], v[76:79]
  ds_read_b64 a[38:39], v15 offset:2048
  ds_read_b64 a[40:41], v16 offset:0
  v_mfma_f32_16x16x32_bf16 v[68:71], v[100:103], a[96:99], v[68:71]
  ds_read_b64 a[42:43], v17 offset:0
  v_mfma_f32_16x16x32_bf16 v[80:83], v[100:103], a[100:103], v[80:83]
  ds_read_b64 a[44:45], v16 offset:2048
  ds_read_b64 a[46:47], v17 offset:2048
  s_waitcnt lgkmcnt(0)
  v_mfma_f32_16x16x32_bf16 v[60:63], v[108:111], a[104:107], v[60:63]
  ds_read_b128 v[92:95], v2 offset:43008
  ds_read_b128 v[96:99], v2 offset:44032
  s_add_u32 m0, s33, 0
  s_nop 0
  buffer_load_dwordx4 v10, s[12:15], s34 offen offset:0 lds
  v_mfma_f32_16x16x32_bf16 v[72:75], v[108:111], a[108:111], v[72:75]
  ds_read_b128 v[100:103], v2 offset:45056
  v_mfma_f32_16x16x32_bf16 v[64:67], v[112:115], a[104:107], v[64:67]
  buffer_load_dwordx4 v11, s[12:15], s34 offen offset:1024 lds
  v_mfma_f32_16x16x32_bf16 v[76:79], v[112:115], a[108:111], v[76:79]
  buffer_load_dwordx4 v12, s[12:15], s34 offen offset:2048 lds
  v_mfma_f32_16x16x32_bf16 v[68:71], v[116:119], a[104:107], v[68:71]
  v_mfma_f32_16x16x32_bf16 v[80:83], v[116:119], a[108:111], v[80:83]
  buffer_load_dwordx4 v13, s[12:15], s34 offen offset:3072 lds
  s_add_u32 s34, s34, 128
  s_waitcnt lgkmcnt(0)
  v_mfma_f32_16x16x32_bf16 v[60:63], v[92:95], a[112:115], v[60:63]
  ds_read_b128 v[108:111], v2 offset:46080
  ds_read_b128 v[112:115], v2 offset:47104
  v_mfma_f32_16x16x32_bf16 v[72:75], v[92:95], a[116:119], v[72:75]
  ds_read_b128 v[116:119], v2 offset:48128
  ds_read_b64 a[48:49], v14 offset:4096
  ds_read_b64 a[50:51], v15 offset:4096
  v_mfma_f32_16x16x32_bf16 v[64:67], v[96:99], a[112:115], v[64:67]
  ds_read_b64 a[52:53], v14 offset:6144
  v_mfma_f32_16x16x32_bf16 v[76:79], v[96:99], a[116:119], v[76:79]
  ds_read_b64 a[54:55], v15 offset:6144
  ds_read_b64 a[56:57], v16 offset:4096
  v_mfma_f32_16x16x32_bf16 v[68:71], v[100:103], a[112:115], v[68:71]
  ds_read_b64 a[58:59], v17 offset:4096
  v_mfma_f32_16x16x32_bf16 v[80:83], v[100:103], a[116:119], v[80:83]
  ds_read_b64 a[60:61], v16 offset:6144
  ds_read_b64 a[62:63], v17 offset:6144
  s_waitcnt lgkmcnt(0)
  v_mfma_f32_16x16x32_bf16 v[60:63], v[108:111], a[120:123], v[60:63]
  ds_read_b128 v[92:95], v2 offset:49152
  ds_read_b128 v[96:99], v2 offset:50176
  s_add_u32 m0, s33, 4096
  s_nop 0
  buffer_load_dwordx4 v10, s[12:15], s34 offen offset:0 lds
  v_mfma_f32_16x16x32_bf16 v[72:75], v[108:111], a[124:127], v[72:75]
  ds_read_b128 v[100:103], v2 offset:51200
  v_mfma_f32_16x16x32_bf16 v[64:67], v[112:115], a[120:123], v[64:67]
  buffer_load_dwordx4 v11, s[12:15], s34 offen offset:1024 lds
  v_mfma_f32_16x16x32_bf16 v[76:79], v[112:115], a[124:127], v[76:79]
  buffer_load_dwordx4 v12, s[12:15], s34 offen offset:2048 lds
  v_mfma_f32_16x16x32_bf16 v[68:71], v[116:119], a[120:123], v[68:71]
  v_mfma_f32_16x16x32_bf16 v[80:83], v[116:119], a[124:127], v[80:83]
  buffer_load_dwordx4 v13, s[12:15], s34 offen offset:3072 lds
  s_add_u32 s34, s34, 128
  s_waitcnt lgkmcnt(0)
  v_mfma_f32_16x16x32_bf16 v[60:63], v[92:95], a[128:131], v[60:63]
  ds_read_b128 v[108:111], v2 offset:52224
  ds_read_b128 v[112:115], v2 offset:53248
  s_waitcnt vmcnt(16)
  v_mfma_f32_16x16x32_bf16 v[72:75], v[92:95], a[132:135], v[72:75]
  ds_read_b128 v[116:119], v2 offset:54272
  ds_read_b64 a[64:65], v14 offset:8192
  ds_read_b64 a[66:67], v15 offset:8192
  v_mfma_f32_16x16x32_bf16 v[64:67], v[96:99], a[128:131], v[64:67]
  ds_read_b64 a[68:69], v14 offset:10240
  v_mfma_f32_16x16x32_bf16 v[76:79], v[96:99], a[132:135], v[76:79]
  ds_read_b64 a[70:71], v15 offset:10240
  ds_read_b64 a[72:73], v16 offset:8192
  v_mfma_f32_16x16x32_bf16 v[68:71], v[100:103], a[128:131], v[68:71]
  ds_read_b64 a[74:75], v17 offset:8192
  v_mfma_f32_16x16x32_bf16 v[80:83], v[100:103], a[132:135], v[80:83]
  ds_read_b64 a[76:77], v16 offset:10240
  ds_read_b64 a[78:79], v17 offset:10240
  s_waitcnt lgkmcnt(0)
  v_mfma_f32_16x16x32_bf16 v[60:63], v[108:111], a[136:139], v[60:63]
  ds_read_b128 v[92:95], v2 offset:55296
  ds_read_b128 v[96:99], v2 offset:56320
  s_add_u32 m0, s33, 8192
  s_nop 0
  buffer_load_dwordx4 v10, s[12:15], s34 offen offset:0 lds
  v_mfma_f32_16x16x32_bf16 v[72:75], v[108:111], a[140:143], v[72:75]
  ds_read_b128 v[100:103], v2 offset:57344
  v_mfma_f32_16x16x32_bf16 v[64:67], v[112:115], a[136:139], v[64:67]
  buffer_load_dwordx4 v11, s[12:15], s34 offen offset:1024 lds
  v_mfma_f32_16x16x32_bf16 v[76:79], v[112:115], a[140:143], v[76:79]
  buffer_load_dwordx4 v12, s[12:15], s34 offen offset:2048 lds
  v_mfma_f32_16x16x32_bf16 v[68:71], v[116:119], a[136:139], v[68:71]
  v_mfma_f32_16x16x32_bf16 v[80:83], v[116:119], a[140:143], v[80:83]
  buffer_load_dwordx4 v13, s[12:15], s34 offen offset:3072 lds
  s_add_u32 s34, s34, 128
  s_waitcnt lgkmcnt(0)
  v_mfma_f32_16x16x32_bf16 v[60:63], v[92:95], a[144:147], v[60:63]
  ds_read_b128 v[108:111], v2 offset:58368
  ds_read_b128 v[112:115], v2 offset:59392
  s_waitcnt vmcnt(16)
  v_mfma_f32_16x16x32_bf16 v[72:75], v[92:95], a[148:151], v[72:75]
  ds_read_b128 v[116:119], v2 offset:60416
  ds_read_b64 a[80:81], v14 offset:12288
  ds_read_b64 a[82:83], v15 offset:12288
  v_mfma_f32_16x16x32_bf16 v[64:67], v[96:99], a[144:147], v[64:67]
  ds_read_b64 a[84:85], v14 offset:14336
  v_mfma_f32_16x16x32_bf16 v[76:79], v[96:99], a[148:151], v[76:79]
  ds_read_b64 a[86:87], v15 offset:14336
  ds_read_b64 a[88:89], v16 offset:12288
  v_mfma_f32_16x16x32_bf16 v[68:71], v[100:103], a[144:147], v[68:71]
  ds_read_b64 a[90:91], v17 offset:12288
  v_mfma_f32_16x16x32_bf16 v[80:83], v[100:103], a[148:151], v[80:83]
  ds_read_b64 a[92:93], v16 offset:14336
  ds_read_b64 a[94:95], v17 offset:14336
  s_waitcnt lgkmcnt(0)
  v_mfma_f32_16x16x32_bf16 v[60:63], v[108:111], a[152:155], v[60:63]
  s_add_u32 m0, s33, 12288
  s_nop 0
  buffer_load_dwordx4 v10, s[12:15], s34 offen offset:0 lds
  v_mfma_f32_16x16x32_bf16 v[72:75], v[108:111], a[156:159], v[72:75]
  v_mfma_f32_16x16x32_bf16 v[64:67], v[112:115], a[152:155], v[64:67]
  buffer_load_dwordx4 v11, s[12:15], s34 offen offset:1024 lds
  v_mfma_f32_16x16x32_bf16 v[76:79], v[112:115], a[156:159], v[76:79]
  buffer_load_dwordx4 v12, s[12:15], s34 offen offset:2048 lds
  v_mfma_f32_16x16x32_bf16 v[68:71], v[116:119], a[152:155], v[68:71]
  v_mfma_f32_16x16x32_bf16 v[80:83], v[116:119], a[156:159], v[80:83]
  buffer_load_dwordx4 v13, s[12:15], s34 offen offset:3072 lds
  s_add_u32 s34, s34, 128
  s_lshr_b32 s27, s23, 1
  s_lshr_b32 s28, s22, 2
  s_lshl4_add_u32 s29, s27, s28
  s_lshl1_add_u32 s29, s29, s24
  s_lshl_b32 s31, s25, 5
  s_load_dwordx2 s[16:17], s[0:1], 64
  s_mov_b32 s18, 4096
  s_mov_b32 s19, 0x20000
  s_lshl1_add_u32 s27, s25, s26
  s_mul_i32 s27, s27, 229376
  s_add_u32 s27, s27, 20414464
  s_add_u32 s8, s4, s27
  s_addc_u32 s9, s5, 0
  s_mov_b32 s10, 86016
  s_mul_i32 s35, s22, 57344
  s_mul_i32 s28, s23, 1792
  s_add_u32 s35, s35, s28
  s_add_u32 s35, s35, 24084480
  s_waitcnt lgkmcnt(0)
  v_mov_b32 v164, 0
  v_lshlrev_b32 v165, 15, v1
  s_and_b32 s32, s29, 0
  s_lshr_b32 s29, s29, 0
  s_lshl_b32 s29, s29, 5
  s_add_u32 s29, s29, s32
  s_lshl2_add_u32 s29, s29, 2899968
  s_lshl_b32 s31, s31, 7
  s_add_u32 s31, s31, 2899968
  s_waitcnt vmcnt(16)
  s_barrier
  s_cmp_lg_u32 s20, 0
  s_cbranch_scc1 kg_f_sent
  s_mov_b64 exec, 1
  buffer_store_dword v164, v165, s[4:7], s29 offen sc0 sc1
  s_mov_b64 exec, -1
kg_f_sent:
  s_lshl_b32 s28, s22, 6
  v_lshlrev_b32 v4, 1, v8
  buffer_load_ushort v148, v4, s[16:19], s28 offen offset:0
  buffer_load_ushort v149, v4, s[16:19], s28 offen offset:32
  s_waitcnt vmcnt(14)
  ds_read_b64 a[96:97], v14 offset:0
  ds_read_b64 a[98:99], v15 offset:0
  ds_read_b64 a[100:101], v14 offset:2048
  ds_read_b64 a[102:103], v15 offset:2048
  ds_read_b64 a[104:105], v16 offset:0
  ds_read_b64 a[106:107], v17 offset:0
  ds_read_b64 a[108:109], v16 offset:2048
  ds_read_b64 a[110:111], v17 offset:2048
  s_waitcnt vmcnt(10)
  ds_read_b64 a[112:113], v14 offset:4096
  ds_read_b64 a[114:115], v15 offset:4096
  ds_read_b64 a[116:117], v14 offset:6144
  ds_read_b64 a[118:119], v15 offset:6144
  ds_read_b64 a[120:121], v16 offset:4096
  ds_read_b64 a[122:123], v17 offset:4096
  ds_read_b64 a[124:125], v16 offset:6144
  ds_read_b64 a[126:127], v17 offset:6144
  v_pk_mul_f32 v[224:225], v[60:61], v[60:61]
  v_pk_mul_f32 v[226:227], v[62:63], v[62:63]
  v_pk_mul_f32 v[228:229], v[64:65], v[64:65]
  v_pk_mul_f32 v[230:231], v[66:67], v[66:67]
  v_pk_fma_f32 v[224:225], v[224:225], s[38:39], v[26:27]
  v_pk_fma_f32 v[226:227], v[226:227], s[38:39], v[26:27]
  v_pk_fma_f32 v[228:229], v[228:229], s[38:39], v[26:27]
  v_pk_fma_f32 v[230:231], v[230:231], s[38:39], v[26:27]
  v_pk_mul_f32 v[224:225], v[224:225], v[60:61]
  v_pk_mul_f32 v[226:227], v[226:227], v[62:63]
  v_pk_mul_f32 v[228:229], v[228:229], v[64:65]
  v_pk_mul_f32 v[230:231], v[230:231], v[66:67]
  v_exp_f32 v224, v224
  v_exp_f32 v225, v225
  v_exp_f32 v226, v226
  v_exp_f32 v227, v227
  v_exp_f32 v228, v228
  v_exp_f32 v229, v229
  v_exp_f32 v230, v230
  v_exp_f32 v231, v231
  v_pk_add_f32 v[224:225], v[224:225], 1.0 op_sel_hi:[1,0]
  v_pk_add_f32 v[226:227], v[226:227], 1.0 op_sel_hi:[1,0]
  v_pk_add_f32 v[228:229], v[228:229], 1.0 op_sel_hi:[1,0]
  v_pk_add_f32 v[230:231], v[230:231], 1.0 op_sel_hi:[1,0]
  v_rcp_f32 v224, v224
  v_rcp_f32 v225, v225
  v_rcp_f32 v226, v226
  v_rcp_f32 v227, v227
  v_rcp_f32 v228, v228
  v_rcp_f32 v229, v229
  v_rcp_f32 v230, v230
  v_rcp_f32 v231, v231
  v_pk_mul_f32 v[60:61], v[60:61], v[224:225]
  v_pk_mul_f32 v[62:63], v[62:63], v[226:227]
  v_pk_mul_f32 v[64:65], v[64:65], v[228:229]
  v_pk_mul_f32 v[66:67], v[66:67], v[230:231]
  v_cvt_pk_bf16_f32 v240, v60, v61
  v_cvt_pk_bf16_f32 v241, v62, v63
  v_cvt_pk_bf16_f32 v242, v64, v65
  v_cvt_pk_bf16_f32 v243, v66, v67
  s_waitcnt lgkmcnt(0)
  s_waitcnt vmcnt(6)
  ds_read_b64 a[128:129], v14 offset:8192
  ds_read_b64 a[130:131], v15 offset:8192
  ds_read_b64 a[132:133], v14 offset:10240
  ds_read_b64 a[134:135], v15 offset:10240
  ds_read_b64 a[136:137], v16 offset:8192
  ds_read_b64 a[138:139], v17 offset:8192
  ds_read_b64 a[140:141], v16 offset:10240
  ds_read_b64 a[142:143], v17 offset:10240
  s_waitcnt vmcnt(2)
  ds_read_b64 a[144:145], v14 offset:12288
  ds_read_b64 a[146:147], v15 offset:12288
  ds_read_b64 a[148:149], v14 offset:14336
  ds_read_b64 a[150:151], v15 offset:14336
  ds_read_b64 a[152:153], v16 offset:12288
  ds_read_b64 a[154:155], v17 offset:12288
  ds_read_b64 a[156:157], v16 offset:14336
  ds_read_b64 a[158:159], v17 offset:14336
  v_pk_mul_f32 v[224:225], v[72:73], v[72:73]
  v_pk_mul_f32 v[226:227], v[74:75], v[74:75]
  v_pk_mul_f32 v[228:229], v[76:77], v[76:77]
  v_pk_mul_f32 v[230:231], v[78:79], v[78:79]
  v_pk_fma_f32 v[224:225], v[224:225], s[38:39], v[26:27]
  v_pk_fma_f32 v[226:227], v[226:227], s[38:39], v[26:27]
  v_pk_fma_f32 v[228:229], v[228:229], s[38:39], v[26:27]
  v_pk_fma_f32 v[230:231], v[230:231], s[38:39], v[26:27]
  v_pk_mul_f32 v[224:225], v[224:225], v[72:73]
  v_pk_mul_f32 v[226:227], v[226:227], v[74:75]
  v_pk_mul_f32 v[228:229], v[228:229], v[76:77]
  v_pk_mul_f32 v[230:231], v[230:231], v[78:79]
  v_exp_f32 v224, v224
  v_exp_f32 v225, v225
  v_exp_f32 v226, v226
  v_exp_f32 v227, v227
  v_exp_f32 v228, v228
  v_exp_f32 v229, v229
  v_exp_f32 v230, v230
  v_exp_f32 v231, v231
  v_pk_add_f32 v[224:225], v[224:225], 1.0 op_sel_hi:[1,0]
  v_pk_add_f32 v[226:227], v[226:227], 1.0 op_sel_hi:[1,0]
  v_pk_add_f32 v[228:229], v[228:229], 1.0 op_sel_hi:[1,0]
  v_pk_add_f32 v[230:231], v[230:231], 1.0 op_sel_hi:[1,0]
  v_rcp_f32 v224, v224
  v_rcp_f32 v225, v225
  v_rcp_f32 v226, v226
  v_rcp_f32 v227, v227
  v_rcp_f32 v228, v228
  v_rcp_f32 v229, v229
  v_rcp_f32 v230, v230
  v_rcp_f32 v231, v231
  v_pk_mul_f32 v[72:73], v[72:73], v[224:225]
  v_pk_mul_f32 v[74:75], v[74:75], v[226:227]
  v_pk_mul_f32 v[76:77], v[76:77], v[228:229]
  v_pk_mul_f32 v[78:79], v[78:79], v[230:231]
  v_cvt_pk_bf16_f32 v244, v72, v73
  v_cvt_pk_bf16_f32 v245, v74, v75
  v_cvt_pk_bf16_f32 v246, v76, v77
  v_cvt_pk_bf16_f32 v247, v78, v79
  s_waitcnt lgkmcnt(0)
  v_pk_mul_f32 v[224:225], v[68:69], v[68:69]
  v_pk_mul_f32 v[226:227], v[70:71], v[70:71]
  v_pk_mul_f32 v[228:229], v[80:81], v[80:81]
  v_pk_mul_f32 v[230:231], v[82:83], v[82:83]
  v_pk_fma_f32 v[224:225], v[224:225], s[38:39], v[26:27]
  v_pk_fma_f32 v[226:227], v[226:227], s[38:39], v[26:27]
  v_pk_fma_f32 v[228:229], v[228:229], s[38:39], v[26:27]
  v_pk_fma_f32 v[230:231], v[230:231], s[38:39], v[26:27]
  v_pk_mul_f32 v[224:225], v[224:225], v[68:69]
  v_pk_mul_f32 v[226:227], v[226:227], v[70:71]
  v_pk_mul_f32 v[228:229], v[228:229], v[80:81]
  v_pk_mul_f32 v[230:231], v[230:231], v[82:83]
  v_exp_f32 v224, v224
  v_exp_f32 v225, v225
  v_exp_f32 v226, v226
  v_exp_f32 v227, v227
  v_exp_f32 v228, v228
  v_exp_f32 v229, v229
  v_exp_f32 v230, v230
  v_exp_f32 v231, v231
  v_pk_add_f32 v[224:225], v[224:225], 1.0 op_sel_hi:[1,0]
  v_pk_add_f32 v[226:227], v[226:227], 1.0 op_sel_hi:[1,0]
  v_pk_add_f32 v[228:229], v[228:229], 1.0 op_sel_hi:[1,0]
  v_pk_add_f32 v[230:231], v[230:231], 1.0 op_sel_hi:[1,0]
  v_rcp_f32 v224, v224
  v_rcp_f32 v225, v225
  v_rcp_f32 v226, v226
  v_rcp_f32 v227, v227
  v_rcp_f32 v228, v228
  v_rcp_f32 v229, v229
  v_rcp_f32 v230, v230
  v_rcp_f32 v231, v231
  v_pk_mul_f32 v[68:69], v[68:69], v[224:225]
  v_pk_mul_f32 v[70:71], v[70:71], v[226:227]
  v_pk_mul_f32 v[80:81], v[80:81], v[228:229]
  v_pk_mul_f32 v[82:83], v[82:83], v[230:231]
  v_cvt_pk_bf16_f32 v248, v68, v69
  v_cvt_pk_bf16_f32 v249, v70, v71
  v_cvt_pk_bf16_f32 v250, v80, v81
  v_cvt_pk_bf16_f32 v251, v82, v83
  s_waitcnt lgkmcnt(0)
  s_waitcnt vmcnt(1)
  v_lshlrev_b32 v148, 16, v148
  s_waitcnt vmcnt(0)
  v_lshlrev_b32 v149, 16, v149
  s_cmp_lg_u32 s20, 0
  s_cbranch_scc1 kg_f_ok
  v_and_b32 v5, 31, v0
  v_lshlrev_b32 v5, 7, v5
  s_mov_b32 exec_lo, -1
  s_mov_b32 exec_hi, 0
  s_nop 1
  buffer_load_dword v164, v5, s[4:7], s31 offen sc0 sc1
  s_mov_b32 s32, 0
  s_waitcnt vmcnt(0)
  v_cmp_eq_u32 vcc, -1, v164
  s_nop 0
  s_cmp_eq_u64 vcc, 0
  s_cbranch_scc1 kg_f_ok
kg_f_again:
  s_sleep 2
  buffer_load_dword v164, v5, s[4:7], s31 offen sc0 sc1
  s_add_u32 s32, s32, 1
  s_waitcnt vmcnt(0)
  v_cmp_eq_u32 vcc, -1, v164
  s_nop 0
  s_cmp_eq_u64 vcc, 0
  s_cbranch_scc1 kg_f_ok
  s_cmp_lt_u32 s32, 100000
  s_cbranch_scc1 kg_f_again
kg_f_ok:
  s_mov_b64 exec, -1
  s_barrier
  s_add_u32 m0, s21, 0
  s_nop 0
  buffer_load_dwordx4 v2, s[8:11], m0 offen sc1 lds
  s_add_u32 m0, s21, 4096
  s_nop 0
  buffer_load_dwordx4 v2, s[8:11], m0 offen sc1 lds
  s_add_u32 m0, s21, 8192
  s_nop 0
  buffer_load_dwordx4 v2, s[8:11], m0 offen sc1 lds
  s_add_u32 m0, s21, 12288
  s_nop 0
  buffer_load_dwordx4 v2, s[8:11], m0 offen sc1 lds
  s_add_u32 m0, s21, 16384
  s_nop 0
  buffer_load_dwordx4 v2, s[8:11], m0 offen sc1 lds
  s_add_u32 m0, s21, 20480
  s_nop 0
  buffer_load_dwordx4 v2, s[8:11], m0 offen sc1 lds
  s_add_u32 m0, s21, 24576
  s_nop 0
  buffer_load_dwordx4 v2, s[8:11], m0 offen sc1 lds
  s_add_u32 m0, s21, 28672
  s_nop 0
  buffer_load_dwordx4 v2, s[8:11], m0 offen sc1 lds
  s_add_u32 m0, s21, 32768
  s_nop 0
  buffer_load_dwordx4 v2, s[8:11], m0 offen sc1 lds
  s_add_u32 m0, s21, 36864
  s_nop 0
  buffer_load_dwordx4 v2, s[8:11], m0 offen sc1 lds
  s_add_u32 m0, s21, 40960
  s_nop 0
  buffer_load_dwordx4 v2, s[8:11], m0 offen sc1 lds
  s_add_u32 m0, s21, 45056
  s_nop 0
  buffer_load_dwordx4 v2, s[8:11], m0 offen sc1 lds
  s_add_u32 m0, s21, 49152
  s_nop 0
  buffer_load_dwordx4 v2, s[8:11], m0 offen sc1 lds
  s_add_u32 m0, s21, 53248
  s_nop 0
  buffer_load_dwordx4 v2, s[8:11], m0 offen sc1 lds
  s_add_u32 m0, s21, 57344
  s_nop 0
  buffer_load_dwordx4 v2, s[8:11], m0 offen sc1 lds
  s_lshl4_add_u32 s29, s22, s23
  s_lshl_b32 s38, s29, 13
  s_add_u32 s38, s38, 12025856
  s_xor_b32 s30, s38, 8192
  s_mov_b32 s29, 0xffffff00
  v_bfe_u32 v20, s3, 0, 8
  v_bfe_u32 v21, s3, 8, 8
  v_bfe_u32 v22, s3, 16, 8
  v_bfe_u32 v23, s3, 24, 8
  v_add_u32 v186, 4096, v2
  s_lshr_b32 s23, s2, 5
  s_mul_i32 s37, s23, 143360
  s_add_u32 s37, s37, 5627904
  s_add_u32 s40, s4, s37
  s_addc_u32 s41, s5, 0
  s_mov_b32 s42, 143360
  s_mov_b32 s43, 0x20000
  v_mov_b32 v216, v148
  v_mov_b32 v220, v149
  v_mov_b32 v217, v148
  v_mov_b32 v221, v149
  v_mov_b32 v218, v148
  v_mov_b32 v222, v149
  v_mov_b32 v219, v148
  v_mov_b32 v223, v149
  s_and_b32 s18, s2, 7
  s_bfe_u32 s19, s2, 0x20003
  s_lshl2_add_u32 s18, s18, s19
  s_lshl2_add_u32 s36, s18, s20
  s_lshr_b32 s17, s18, 1
  s_lshl_b32 s17, s17, 4
  s_lshl1_add_u32 s16, s25, s26
  s_lshr_b32 s18, s22, 2
  s_lshl4_add_u32 s16, s18, s16
  s_and_b32 s39, s36, -1
  s_mul_i32 s39, s39, 28672
  s_and_b32 s19, s20, 0
  s_mul_i32 s18, s19, 14336
  s_add_u32 s39, s39, s18
  s_add_u32 s39, s39, 24084480
  v_add_u32 v184, 28672, v2
  v_mul_u32_u24 v4, 6554, v1
  v_lshrrev_b32 v4, 16, v4
  v_mul_u32_u24 v213, 10, v4
  v_sub_u32 v213, v1, v213
  s_mul_i32 s24, s20, 5376
  s_add_u32 s24, s24, 86016
  s_mul_i32 s18, s19, 5376
  s_add_u32 s18, s18, s24
  v_mul_u32_u24 v210, 336, v4
  v_lshl_add_u32 v210, v213, 5, v210
  v_add_u32 v210, s18, v210
  s_mul_i32 s18, s19, 10752
  s_add_u32 s18, s18, s24
  v_mul_u32_u24 v211, 1280, v4
  v_lshl_add_u32 v211, v213, 4, v211
  v_lshlrev_b32 v213, 5, v213
  v_mov_b32 v4, 0x80000000
  v_cmp_gt_u32 vcc, 40, v1
  s_nop 1
  v_cndmask_b32 v212, v4, v211, vcc
  v_cmp_gt_u32 vcc, 60, v1
  s_nop 1
  v_cndmask_b32 v211, v4, v211, vcc
  v_mul_u32_u24 v209, 336, v8
  v_lshl_add_u32 v209, v9, 4, v209
  v_add_u32 v209, s18, v209
  s_mul_i32 s37, s36, 20480
  s_mul_i32 s18, s23, 160
  s_add_u32 s37, s37, s18
  s_lshl_b32 s18, s18, 1
  s_add_u32 s18, s18, 2634240
  s_add_u32 s19, s37, 9396224
  v_lshrrev_b32 v4, 1, v9
  v_lshl_add_u32 v4, v4, 4, v8
  v_and_b32 v5, 1, v9
  v_mul_u32_u24 v5, 28672, v5
  v_lshl_add_u32 v208, v4, 4, v5
  s_waitcnt vmcnt(14)
  s_barrier
  ds_read_b128 v[88:91], v2 offset:0
  ds_read_b128 v[92:95], v2 offset:1024
  ds_read_b128 v[96:99], v2 offset:2048
  ds_read_b128 v[100:103], v2 offset:3072
  s_waitcnt vmcnt(12)
  s_barrier
  s_waitcnt lgkmcnt(0)
  v_mfma_f32_16x16x32_bf16 v[24:27], v[88:91], a[160:163], 0
  ds_read_b128 v[108:111], v2 offset:4096
  ds_read_b128 v[112:115], v2 offset:5120
  v_mfma_f32_16x16x32_bf16 v[52:55], v[88:91], a[164:167], 0
  ds_read_b128 v[116:119], v2 offset:6144
  ds_read_b128 v[120:123], v2 offset:7168
  v_mfma_f32_16x16x32_bf16 v[28:31], v[92:95], a[160:163], 0
  v_mfma_f32_16x16x32_bf16 v[56:59], v[92:95], a[164:167], 0
  v_mfma_f32_16x16x32_bf16 v[32:35], v[96:99], a[160:163], 0
  s_add_u32 m0, s21, 61440
  s_nop 0
  buffer_load_dwordx4 v2, s[8:11], m0 offen sc1 lds
  v_mfma_f32_16x16x32_bf16 v[60:63], v[96:99], a[164:167], 0
  v_mfma_f32_16x16x32_bf16 v[36:39], v[100:103], a[160:163], 0
  v_mfma_f32_16x16x32_bf16 v[64:67], v[100:103], a[164:167], 0
  s_waitcnt lgkmcnt(0)
  v_mfma_f32_16x16x32_bf16 v[24:27], v[108:111], a[168:171], v[24:27]
  ds_read_b128 v[88:91], v2 offset:8192
  ds_read_b128 v[92:95], v2 offset:9216
  v_mfma_f32_16x16x32_bf16 v[52:55], v[108:111], a[172:175], v[52:55]
  ds_read_b128 v[96:99], v2 offset:10240
  ds_read_b128 v[100:103], v2 offset:11264
  v_mfma_f32_16x16x32_bf16 v[28:31], v[112:115], a[168:171], v[28:31]
  v_mfma_f32_16x16x32_bf16 v[56:59], v[112:115], a[172:175], v[56:59]
  v_mfma_f32_16x16x32_bf16 v[32:35], v[116:119], a[168:171], v[32:35]
  s_add_u32 m0, s21, 65536
  s_nop 0
  buffer_load_dwordx4 v2, s[8:11], m0 offen sc1 lds
  v_mfma_f32_16x16x32_bf16 v[60:63], v[116:119], a[172:175], v[60:63]
  v_mfma_f32_16x16x32_bf16 v[36:39], v[120:123], a[168:171], v[36:39]
  v_mfma_f32_16x16x32_bf16 v[64:67], v[120:123], a[172:175], v[64:67]
  s_waitcnt vmcnt(12)
  s_barrier
  s_waitcnt lgkmcnt(0)
  v_mfma_f32_16x16x32_bf16 v[24:27], v[88:91], a[176:179], v[24:27]
  ds_read_b128 v[108:111], v2 offset:12288
  ds_read_b128 v[112:115], v2 offset:13312
  v_mfma_f32_16x16x32_bf16 v[52:55], v[88:91], a[180:183], v[52:55]
  ds_read_b128 v[116:119], v2 offset:14336
  ds_read_b128 v[120:123], v2 offset:15360
  v_mfma_f32_16x16x32_bf16 v[28:31], v[92:95], a[176:179], v[28:31]
  s_add_u32 m0, s21, 69632
  s_nop 0
  buffer_load_dwordx4 v2, s[8:11], m0 offen sc1 lds
  v_mfma_f32_16x16x32_bf16 v[56:59], v[92:95], a[180:183], v[56:59]
  v_mfma_f32_16x16x32_bf16 v[32:35], v[96:99], a[176:179], v[32:35]
  v_mfma_f32_16x16x32_bf16 v[60:63], v[96:99], a[180:183], v[60:63]
  v_mfma_f32_16x16x32_bf16 v[36:39], v[100:103], a[176:179], v[36:39]
  s_add_u32 m0, s21, 86016
  s_add_u32 s24, s21, 0
  buffer_load_dwordx4 v2, s[40:43], s24 offen sc1 lds
  v_mfma_f32_16x16x32_bf16 v[64:67], v[100:103], a[180:183], v[64:67]
  s_waitcnt lgkmcnt(0)
  v_mfma_f32_16x16x32_bf16 v[24:27], v[108:111], a[184:187], v[24:27]
  ds_read_b128 v[88:91], v2 offset:16384
  ds_read_b128 v[92:95], v2 offset:17408
  v_mfma_f32_16x16x32_bf16 v[52:55], v[108:111], a[188:191], v[52:55]
  ds_read_b128 v[96:99], v2 offset:18432
  ds_read_b128 v[100:103], v2 offset:19456
  v_mfma_f32_16x16x32_bf16 v[28:31], v[112:115], a[184:187], v[28:31]
  s_add_u32 m0, s21, 73728
  s_nop 0
  buffer_load_dwordx4 v2, s[8:11], m0 offen sc1 lds
  v_mfma_f32_16x16x32_bf16 v[56:59], v[112:115], a[188:191], v[56:59]
  v_mfma_f32_16x16x32_bf16 v[32:35], v[116:119], a[184:187], v[32:35]
  v_mfma_f32_16x16x32_bf16 v[60:63], v[116:119], a[188:191], v[60:63]
  v_mfma_f32_16x16x32_bf16 v[36:39], v[120:123], a[184:187], v[36:39]
  s_add_u32 m0, s21, 90112
  s_add_u32 s24, s21, 4096
  buffer_load_dwordx4 v2, s[40:43], s24 offen sc1 lds
  v_mfma_f32_16x16x32_bf16 v[64:67], v[120:123], a[188:191], v[64:67]
  s_waitcnt vmcnt(14)
  s_barrier
  s_waitcnt lgkmcnt(0)
  v_mfma_f32_16x16x32_bf16 v[24:27], v[88:91], a[192:195], v[24:27]
  ds_read_b128 v[108:111], v2 offset:20480
  ds_read_b128 v[112:115], v2 offset:21504
  v_mfma_f32_16x16x32_bf16 v[52:55], v[88:91], a[196:199], v[52:55]
  ds_read_b128 v[116:119], v2 offset:22528
  ds_read_b128 v[120:123], v2 offset:23552
  v_mfma_f32_16x16x32_bf16 v[28:31], v[92:95], a[192:195], v[28:31]
  s_add_u32 m0, s21, 77824
  s_nop 0
  buffer_load_dwordx4 v2, s[8:11], m0 offen sc1 lds
  v_mfma_f32_16x16x32_bf16 v[56:59], v[92:95], a[196:199], v[56:59]
  v_mfma_f32_16x16x32_bf16 v[32:35], v[96:99], a[192:195], v[32:35]
  v_mfma_f32_16x16x32_bf16 v[60:63], v[96:99], a[196:199], v[60:63]
  v_mfma_f32_16x16x32_bf16 v[36:39], v[100:103], a[192:195], v[36:39]
  s_add_u32 m0, s21, 94208
  s_add_u32 s24, s21, 8192
  buffer_load_dwordx4 v2, s[40:43], s24 offen sc1 lds
  v_mfma_f32_16x16x32_bf16 v[64:67], v[100:103], a[196:199], v[64:67]
  s_waitcnt lgkmcnt(0)
  v_mfma_f32_16x16x32_bf16 v[24:27], v[108:111], a[200:203], v[24:27]
  ds_read_b128 v[88:91], v2 offset:24576
  ds_read_b128 v[92:95], v2 offset:25600
  v_mfma_f32_16x16x32_bf16 v[52:55], v[108:111], a[204:207], v[52:55]
  ds_read_b128 v[96:99], v2 offset:26624
  ds_read_b128 v[100:103], v2 offset:27648
  v_mfma_f32_16x16x32_bf16 v[28:31], v[112:115], a[200:203], v[28:31]
  s_add_u32 m0, s21, 81920
  s_nop 0
  buffer_load_dwordx4 v2, s[8:11], m0 offen sc1 lds
  v_mfma_f32_16x16x32_bf16 v[56:59], v[112:115], a[204:207], v[56:59]
  v_mfma_f32_16x16x32_bf16 v[32:35], v[116:119], a[200:203], v[32:35]
  v_mfma_f32_16x16x32_bf16 v[60:63], v[116:119], a[204:207], v[60:63]
  v_mfma_f32_16x16x32_bf16 v[36:39], v[120:123], a[200:203], v[36:39]
  s_add_u32 m0, s21, 98304
  s_add_u32 s24, s21, 12288
  buffer_load_dwordx4 v2, s[40:43], s24 offen sc1 lds
  v_mfma_f32_16x16x32_bf16 v[64:67], v[120:123], a[204:207], v[64:67]
  s_waitcnt vmcnt(16)
  s_barrier
  s_waitcnt lgkmcnt(0)
  v_mfma_f32_16x16x32_bf16 v[24:27], v[88:91], a[208:211], v[24:27]
  ds_read_b128 v[108:111], v2 offset:28672
  ds_read_b128 v[112:115], v2 offset:29696
  v_mfma_f32_16x16x32_bf16 v[52:55], v[88:91], a[212:215], v[52:55]
  ds_read_b128 v[116:119], v2 offset:30720
  ds_read_b128 v[120:123], v2 offset:31744
  s_add_u32 s8, s8, 86016
  s_addc_u32 s9, s9, 0
  v_mfma_f32_16x16x32_bf16 v[28:31], v[92:95], a[208:211], v[28:31]
  v_mfma_f32_16x16x32_bf16 v[56:59], v[92:95], a[212:215], v[56:59]
  v_mfma_f32_16x16x32_bf16 v[32:35], v[96:99], a[208:211], v[32:35]
  s_add_u32 m0, s21, 0
  s_nop 0
  buffer_load_dwordx4 v2, s[8:11], m0 offen sc1 lds
  v_mfma_f32_16x16x32_bf16 v[60:63], v[96:99], a[212:215], v[60:63]
  v_mfma_f32_16x16x32_bf16 v[36:39], v[100:103], a[208:211], v[36:39]
  s_add_u32 m0, s21, 102400
  s_add_u32 s24, s21, 16384
  buffer_load_dwordx4 v2, s[40:43], s24 offen sc1 lds
  v_mfma_f32_16x16x32_bf16 v[64:67], v[100:103], a[212:215], v[64:67]
  s_waitcnt lgkmcnt(0)
  v_mfma_f32_16x16x32_bf16 v[24:27], v[108:111], a[216:219], v[24:27]
  ds_read_b128 v[88:91], v2 offset:32768
  ds_read_b128 v[92:95], v2 offset:33792
  v_mfma_f32_16x16x32_bf16 v[52:55], v[108:111], a[220:223], v[52:55]
  ds_read_b128 v[96:99], v2 offset:34816
  ds_read_b128 v[100:103], v2 offset:35840
  v_mfma_f32_16x16x32_bf16 v[28:31], v[112:115], a[216:219], v[28:31]
  s_add_u32 m0, s21, 4096
  s_nop 0
  buffer_load_dwordx4 v2, s[8:11], m0 offen sc1 lds
  v_mfma_f32_16x16x32_bf16 v[56:59], v[112:115], a[220:223], v[56:59]
  v_mfma_f32_16x16x32_bf16 v[32:35], v[116:119], a[216:219], v[32:35]
  v_mfma_f32_16x16x32_bf16 v[60:63], v[116:119], a[220:223], v[60:63]
  v_mfma_f32_16x16x32_bf16 v[36:39], v[120:123], a[216:219], v[36:39]
  s_add_u32 m0, s21, 106496
  s_add_u32 s24, s21, 20480
  buffer_load_dwordx4 v2, s[40:43], s24 offen sc1 lds
  v_mfma_f32_16x16x32_bf16 v[64:67], v[120:123], a[220:223], v[64:67]
  s_waitcnt vmcnt(18)
  s_barrier
  s_waitcnt lgkmcnt(0)
  v_mfma_f32_16x16x32_bf16 v[24:27], v[88:91], a[224:227], v[24:27]
  ds_read_b128 v[108:111], v2 offset:36864
  ds_read_b128 v[112:115], v2 offset:37888
  v_mfma_f32_16x16x32_bf16 v[52:55], v[88:91], a[228:231], v[52:55]
  ds_read_b128 v[116:119], v2 offset:38912
  ds_read_b128 v[120:123], v2 offset:39936
  v_mfma_f32_16x16x32_bf16 v[28:31], v[92:95], a[224:227], v[28:31]
  s_add_u32 m0, s21, 8192
  s_nop 0
  buffer_load_dwordx4 v2, s[8:11], m0 offen sc1 lds
  v_mfma_f32_16x16x32_bf16 v[56:59], v[92:95], a[228:231], v[56:59]
  v_mfma_f32_16x16x32_bf16 v[32:35], v[96:99], a[224:227], v[32:35]
  v_mfma_f32_16x16x32_bf16 v[60:63], v[96:99], a[228:231], v[60:63]
  v_mfma_f32_16x16x32_bf16 v[36:39], v[100:103], a[224:227], v[36:39]
  s_add_u32 m0, s21, 110592
  s_add_u32 s24, s21, 24576
  buffer_load_dwordx4 v2, s[40:43], s24 offen sc1 lds
  v_mfma_f32_16x16x32_bf16 v[64:67], v[100:103], a[228:231], v[64:67]
  s_waitcnt lgkmcnt(0)
  v_mfma_f32_16x16x32_bf16 v[24:27], v[108:111], a[232:235], v[24:27]
  ds_read_b128 v[88:91], v2 offset:40960
  ds_read_b128 v[92:95], v2 offset:41984
  v_mfma_f32_16x16x32_bf16 v[52:55], v[108:111], a[236:239], v[52:55]
  ds_read_b128 v[96:99], v2 offset:43008
  ds_read_b128 v[100:103], v2 offset:44032
  v_mfma_f32_16x16x32_bf16 v[28:31], v[112:115], a[232:235], v[28:31]
  s_add_u32 m0, s21, 12288
  s_nop 0
  buffer_load_dwordx4 v2, s[8:11], m0 offen sc1 lds
  v_mfma_f32_16x16x32_bf16 v[56:59], v[112:115], a[236:239], v[56:59]
  v_mfma_f32_16x16x32_bf16 v[32:35], v[116:119], a[232:235], v[32:35]
  v_mfma_f32_16x16x32_bf16 v[60:63], v[116:119], a[236:239], v[60:63]
  v_mfma_f32_16x16x32_bf16 v[36:39], v[120:123], a[232:235], v[36:39]
  s_add_u32 m0, s21, 114688
  s_add_u32 s24, s21, 28672
  buffer_load_dwordx4 v2, s[40:43], s24 offen sc1 lds
  v_mfma_f32_16x16x32_bf16 v[64:67], v[120:123], a[236:239], v[64:67]
  s_waitcnt vmcnt(20)
  s_barrier
  s_waitcnt lgkmcnt(0)
  v_mfma_f32_16x16x32_bf16 v[24:27], v[88:91], a[240:243], v[24:27]
  ds_read_b128 v[108:111], v2 offset:45056
  ds_read_b128 v[112:115], v2 offset:46080
  v_mfma_f32_16x16x32_bf16 v[52:55], v[88:91], a[244:247], v[52:55]
  ds_read_b128 v[116:119], v2 offset:47104
  ds_read_b128 v[120:123], v2 offset:48128
  v_mfma_f32_16x16x32_bf16 v[28:31], v[92:95], a[240:243], v[28:31]
  s_add_u32 m0, s21, 16384
  s_nop 0
  buffer_load_dwordx4 v2, s[8:11], m0 offen sc1 lds
  v_mfma_f32_16x16x32_bf16 v[56:59], v[92:95], a[244:247], v[56:59]
  v_mfma_f32_16x16x32_bf16 v[32:35], v[96:99], a[240:243], v[32:35]
  v_mfma_f32_16x16x32_bf16 v[60:63], v[96:99], a[244:247], v[60:63]
  v_mfma_f32_16x16x32_bf16 v[36:39], v[100:103], a[240:243], v[36:39]
  s_add_u32 m0, s21, 118784
  s_add_u32 s24, s21, 32768
  buffer_load_dwordx4 v2, s[40:43], s24 offen sc1 lds
  v_mfma_f32_16x16x32_bf16 v[64:67], v[100:103], a[244:247], v[64:67]
  s_waitcnt lgkmcnt(0)
  v_mfma_f32_16x16x32_bf16 v[24:27], v[108:111], a[248:251], v[24:27]
  ds_read_b128 v[88:91], v2 offset:49152
  ds_read_b128 v[92:95], v2 offset:50176
  v_mfma_f32_16x16x32_bf16 v[52:55], v[108:111], a[252:255], v[52:55]
  ds_read_b128 v[96:99], v2 offset:51200
  ds_read_b128 v[100:103], v2 offset:52224
  v_mfma_f32_16x16x32_bf16 v[28:31], v[112:115], a[248:251], v[28:31]
  s_add_u32 m0, s21, 20480
  s_nop 0
  buffer_load_dwordx4 v2, s[8:11], m0 offen sc1 lds
  v_mfma_f32_16x16x32_bf16 v[56:59], v[112:115], a[252:255], v[56:59]
  v_mfma_f32_16x16x32_bf16 v[32:35], v[116:119], a[248:251], v[32:35]
  v_mfma_f32_16x16x32_bf16 v[60:63], v[116:119], a[252:255], v[60:63]
  v_mfma_f32_16x16x32_bf16 v[36:39], v[120:123], a[248:251], v[36:39]
  s_add_u32 m0, s21, 122880
  s_add_u32 s24, s21, 36864
  buffer_load_dwordx4 v2, s[40:43], s24 offen sc1 lds
  v_mfma_f32_16x16x32_bf16 v[64:67], v[120:123], a[252:255], v[64:67]
  s_waitcnt vmcnt(22)
  s_barrier
  s_waitcnt lgkmcnt(0)
  v_mfma_f32_16x16x32_bf16 v[24:27], v[88:91], a[0:3], v[24:27]
  ds_read_b128 v[108:111], v2 offset:53248
  ds_read_b128 v[112:115], v2 offset:54272
  v_mfma_f32_16x16x32_bf16 v[52:55], v[88:91], a[4:7], v[52:55]
  ds_read_b128 v[116:119], v2 offset:55296
  ds_read_b128 v[120:123], v2 offset:56320
  v_mfma_f32_16x16x32_bf16 v[28:31], v[92:95], a[0:3], v[28:31]
  s_add_u32 m0, s21, 24576
  s_nop 0
  buffer_load_dwordx4 v2, s[8:11], m0 offen sc1 lds
  v_mfma_f32_16x16x32_bf16 v[56:59], v[92:95], a[4:7], v[56:59]
  v_mfma_f32_16x16x32_bf16 v[32:35], v[96:99], a[0:3], v[32:35]
  v_mfma_f32_16x16x32_bf16 v[60:63], v[96:99], a[4:7], v[60:63]
  v_mfma_f32_16x16x32_bf16 v[36:39], v[100:103], a[0:3], v[36:39]
  s_add_u32 m0, s21, 126976
  s_add_u32 s24, s21, 40960
  buffer_load_dwordx4 v2, s[40:43], s24 offen sc1 lds
  v_mfma_f32_16x16x32_bf16 v[64:67], v[100:103], a[4:7], v[64:67]
  s_waitcnt lgkmcnt(0)
  v_mfma_f32_16x16x32_bf16 v[24:27], v[108:111], a[8:11], v[24:27]
  ds_read_b128 v[88:91], v2 offset:57344
  ds_read_b128 v[92:95], v2 offset:58368
  v_mfma_f32_16x16x32_bf16 v[52:55], v[108:111], a[12:15], v[52:55]
  ds_read_b128 v[96:99], v2 offset:59392
  ds_read_b128 v[100:103], v2 offset:60416
  v_mfma_f32_16x16x32_bf16 v[28:31], v[112:115], a[8:11], v[28:31]
  s_add_u32 m0, s21, 28672
  s_nop 0
  buffer_load_dwordx4 v2, s[8:11], m0 offen sc1 lds
  v_mfma_f32_16x16x32_bf16 v[56:59], v[112:115], a[12:15], v[56:59]
  v_mfma_f32_16x16x32_bf16 v[32:35], v[116:119], a[8:11], v[32:35]
  v_mfma_f32_16x16x32_bf16 v[60:63], v[116:119], a[12:15], v[60:63]
  v_mfma_f32_16x16x32_bf16 v[36:39], v[120:123], a[8:11], v[36:39]
  s_add_u32 m0, s21, 131072
  s_add_u32 s24, s21, 45056
  buffer_load_dwordx4 v2, s[40:43], s24 offen sc1 lds
  v_mfma_f32_16x16x32_bf16 v[64:67], v[120:123], a[12:15], v[64:67]
  s_waitcnt vmcnt(24)
  s_barrier
  s_waitcnt lgkmcnt(0)
  v_mfma_f32_16x16x32_bf16 v[24:27], v[88:91], a[16:19], v[24:27]
  ds_read_b128 v[108:111], v2 offset:61440
  ds_read_b128 v[112:115], v2 offset:62464
  v_mfma_f32_16x16x32_bf16 v[52:55], v[88:91], a[20:23], v[52:55]
  ds_read_b128 v[116:119], v2 offset:63488
  ds_read_b128 v[120:123], v2 offset:64512
  v_mfma_f32_16x16x32_bf16 v[28:31], v[92:95], a[16:19], v[28:31]
  s_add_u32 m0, s21, 32768
  s_nop 0
  buffer_load_dwordx4 v2, s[8:11], m0 offen sc1 lds
  v_mfma_f32_16x16x32_bf16 v[56:59], v[92:95], a[20:23], v[56:59]
  v_mfma_f32_16x16x32_bf16 v[32:35], v[96:99], a[16:19], v[32:35]
  v_mfma_f32_16x16x32_bf16 v[60:63], v[96:99], a[20:23], v[60:63]
  v_mfma_f32_16x16x32_bf16 v[36:39], v[100:103], a[16:19], v[36:39]
  s_add_u32 m0, s21, 135168
  s_add_u32 s24, s21, 49152
  buffer_load_dwordx4 v2, s[40:43], s24 offen sc1 lds
  v_mfma_f32_16x16x32_bf16 v[64:67], v[100:103], a[20:23], v[64:67]
  s_waitcnt lgkmcnt(0)
  v_mfma_f32_16x16x32_bf16 v[24:27], v[108:111], a[24:27], v[24:27]
  ds_read_b128 v[88:91], v6 offset:0
  ds_read_b128 v[92:95], v6 offset:1024
  v_mfma_f32_16x16x32_bf16 v[52:55], v[108:111], a[28:31], v[52:55]
  ds_read_b128 v[96:99], v6 offset:2048
  ds_read_b128 v[100:103], v6 offset:3072
  v_mfma_f32_16x16x32_bf16 v[28:31], v[112:115], a[24:27], v[28:31]
  s_add_u32 m0, s21, 36864
  s_nop 0
  buffer_load_dwordx4 v2, s[8:11], m0 offen sc1 lds
  v_mfma_f32_16x16x32_bf16 v[56:59], v[112:115], a[28:31], v[56:59]
  v_mfma_f32_16x16x32_bf16 v[32:35], v[116:119], a[24:27], v[32:35]
  v_mfma_f32_16x16x32_bf16 v[60:63], v[116:119], a[28:31], v[60:63]
  v_mfma_f32_16x16x32_bf16 v[36:39], v[120:123], a[24:27], v[36:39]
  s_add_u32 m0, s21, 139264
  s_add_u32 s24, s21, 53248
  buffer_load_dwordx4 v2, s[40:43], s24 offen sc1 lds
  v_mfma_f32_16x16x32_bf16 v[64:67], v[120:123], a[28:31], v[64:67]
  s_waitcnt vmcnt(25)
  s_barrier
  s_waitcnt lgkmcnt(0)
  v_mfma_f32_16x16x32_bf16 v[24:27], v[88:91], a[32:35], v[24:27]
  ds_read_b128 v[108:111], v6 offset:4096
  ds_read_b128 v[112:115], v6 offset:5120
  v_mfma_f32_16x16x32_bf16 v[52:55], v[88:91], a[36:39], v[52:55]
  ds_read_b128 v[116:119], v6 offset:6144
  ds_read_b128 v[120:123], v6 offset:7168
  v_mfma_f32_16x16x32_bf16 v[28:31], v[92:95], a[32:35], v[28:31]
  v_mfma_f32_16x16x32_bf16 v[56:59], v[92:95], a[36:39], v[56:59]
  v_mfma_f32_16x16x32_bf16 v[32:35], v[96:99], a[32:35], v[32:35]
  s_add_u32 m0, s21, 40960
  s_nop 0
  buffer_load_dwordx4 v2, s[8:11], m0 offen sc1 lds
  v_mfma_f32_16x16x32_bf16 v[60:63], v[96:99], a[36:39], v[60:63]
  v_mfma_f32_16x16x32_bf16 v[36:39], v[100:103], a[32:35], v[36:39]
  v_mfma_f32_16x16x32_bf16 v[64:67], v[100:103], a[36:39], v[64:67]
  s_waitcnt lgkmcnt(0)
  v_mfma_f32_16x16x32_bf16 v[24:27], v[108:111], a[40:43], v[24:27]
  ds_read_b128 v[88:91], v6 offset:8192
  ds_read_b128 v[92:95], v6 offset:9216
  v_mfma_f32_16x16x32_bf16 v[52:55], v[108:111], a[44:47], v[52:55]
  ds_read_b128 v[96:99], v6 offset:10240
  ds_read_b128 v[100:103], v6 offset:11264
  v_mfma_f32_16x16x32_bf16 v[28:31], v[112:115], a[40:43], v[28:31]
  v_mfma_f32_16x16x32_bf16 v[56:59], v[112:115], a[44:47], v[56:59]
  v_mfma_f32_16x16x32_bf16 v[32:35], v[116:119], a[40:43], v[32:35]
  s_add_u32 m0, s21, 45056
  s_nop 0
  buffer_load_dwordx4 v2, s[8:11], m0 offen sc1 lds
  v_mfma_f32_16x16x32_bf16 v[60:63], v[116:119], a[44:47], v[60:63]
  v_mfma_f32_16x16x32_bf16 v[36:39], v[120:123], a[40:43], v[36:39]
  v_mfma_f32_16x16x32_bf16 v[64:67], v[120:123], a[44:47], v[64:67]
  s_waitcnt vmcnt(23)
  s_barrier
  s_waitcnt lgkmcnt(0)
  v_mfma_f32_16x16x32_bf16 v[24:27], v[88:91], a[48:51], v[24:27]
  ds_read_b128 v[108:111], v6 offset:12288
  ds_read_b128 v[112:115], v6 offset:13312
  v_mfma_f32_16x16x32_bf16 v[52:55], v[88:91], a[52:55], v[52:55]
  ds_read_b128 v[116:119], v6 offset:14336
  ds_read_b128 v[120:123], v6 offset:15360
  v_mfma_f32_16x16x32_bf16 v[28:31], v[92:95], a[48:51], v[28:31]
  v_mfma_f32_16x16x32_bf16 v[56:59], v[92:95], a[52:55], v[56:59]
  v_mfma_f32_16x16x32_bf16 v[32:35], v[96:99], a[48:51], v[32:35]
  s_add_u32 m0, s21, 49152
  s_nop 0
  buffer_load_dwordx4 v2, s[8:11], m0 offen sc1 lds
  v_mfma_f32_16x16x32_bf16 v[60:63], v[96:99], a[52:55], v[60:63]
  v_mfma_f32_16x16x32_bf16 v[36:39], v[100:103], a[48:51], v[36:39]
  v_mfma_f32_16x16x32_bf16 v[64:67], v[100:103], a[52:55], v[64:67]
  s_waitcnt lgkmcnt(0)
  v_mfma_f32_16x16x32_bf16 v[24:27], v[108:111], a[56:59], v[24:27]
  ds_read_b128 v[88:91], v6 offset:16384
  ds_read_b128 v[92:95], v6 offset:17408
  v_mfma_f32_16x16x32_bf16 v[52:55], v[108:111], a[60:63], v[52:55]
  ds_read_b128 v[96:99], v6 offset:18432
  ds_read_b128 v[100:103], v6 offset:19456
  v_mfma_f32_16x16x32_bf16 v[28:31], v[112:115], a[56:59], v[28:31]
  v_mfma_f32_16x16x32_bf16 v[56:59], v[112:115], a[60:63], v[56:59]
  v_mfma_f32_16x16x32_bf16 v[32:35], v[116:119], a[56:59], v[32:35]
  s_add_u32 m0, s21, 53248
  s_nop 0
  buffer_load_dwordx4 v2, s[8:11], m0 offen sc1 lds
  v_mfma_f32_16x16x32_bf16 v[60:63], v[116:119], a[60:63], v[60:63]
  v_mfma_f32_16x16x32_bf16 v[36:39], v[120:123], a[56:59], v[36:39]
  v_mfma_f32_16x16x32_bf16 v[64:67], v[120:123], a[60:63], v[64:67]
  s_waitcnt vmcnt(21)
  s_barrier
  s_waitcnt lgkmcnt(0)
  v_mfma_f32_16x16x32_bf16 v[24:27], v[88:91], a[64:67], v[24:27]
  ds_read_b128 v[108:111], v2 offset:0
  ds_read_b128 v[112:115], v2 offset:1024
  s_add_u32 m0, s21, 57344
  s_nop 0
  buffer_load_dwordx4 v2, s[8:11], m0 offen sc1 lds
  buffer_load_dwordx4 v[188:191], v213, s[4:7], s18 offen offset:0 sc1
  v_mfma_f32_16x16x32_bf16 v[52:55], v[88:91], a[68:71], v[52:55]
  ds_read_b128 v[116:119], v2 offset:2048
  ds_read_b128 v[120:123], v2 offset:3072
  buffer_load_dwordx4 v[192:195], v213, s[4:7], s18 offen offset:16 sc1
  v_mfma_f32_16x16x32_bf16 v[28:31], v[92:95], a[64:67], v[28:31]
  buffer_load_dwordx4 v[196:199], v211, s[4:7], s19 offen sc1
  s_add_u32 s19, s19, 7680
  buffer_load_dwordx4 v[200:203], v211, s[4:7], s19 offen sc1
  s_add_u32 s19, s19, 7680
  v_mfma_f32_16x16x32_bf16 v[56:59], v[92:95], a[68:71], v[56:59]
  v_lshlrev_b32 v144, 16, v240
  v_mfma_f32_16x16x32_bf16 v[32:35], v[96:99], a[64:67], v[32:35]
  v_and_b32 v145, 0xffff0000, v240
  v_lshlrev_b32 v146, 16, v241
  v_mfma_f32_16x16x32_bf16 v[60:63], v[96:99], a[68:71], v[60:63]
  v_and_b32 v147, 0xffff0000, v241
  v_lshlrev_b32 v148, 16, v242
  v_mfma_f32_16x16x32_bf16 v[36:39], v[100:103], a[64:67], v[36:39]
  v_and_b32 v149, 0xffff0000, v242
  v_mfma_f32_16x16x32_bf16 v[64:67], v[100:103], a[68:71], v[64:67]
  v_lshlrev_b32 v150, 16, v243
  v_and_b32 v151, 0xffff0000, v243
  s_waitcnt lgkmcnt(0)
  v_mfma_f32_16x16x32_bf16 v[24:27], v[108:111], a[72:75], v[24:27]
  ds_read_b128 v[88:91], v2 offset:4096
  ds_read_b128 v[92:95], v2 offset:5120
  s_add_u32 m0, s21, 61440
  s_nop 0
  buffer_load_dwordx4 v2, s[8:11], m0 offen sc1 lds
  v_mfma_f32_16x16x32_bf16 v[52:55], v[108:111], a[76:79], v[52:55]
  ds_read_b128 v[96:99], v2 offset:6144
  ds_read_b128 v[100:103], v2 offset:7168
  buffer_load_dwordx4 v[204:207], v212, s[4:7], s19 offen sc1
  v_mfma_f32_16x16x32_bf16 v[28:31], v[112:115], a[72:75], v[28:31]
  v_lshlrev_b32 v152, 16, v244
  v_and_b32 v153, 0xffff0000, v244
  v_mfma_f32_16x16x32_bf16 v[56:59], v[112:115], a[76:79], v[56:59]
  v_lshlrev_b32 v154, 16, v245
  v_mfma_f32_16x16x32_bf16 v[32:35], v[116:119], a[72:75], v[32:35]
  v_and_b32 v155, 0xffff0000, v245
  v_mfma_f32_16x16x32_bf16 v[60:63], v[116:119], a[76:79], v[60:63]
  v_lshlrev_b32 v156, 16, v246
  v_mfma_f32_16x16x32_bf16 v[36:39], v[120:123], a[72:75], v[36:39]
  v_and_b32 v157, 0xffff0000, v246
  v_lshlrev_b32 v158, 16, v247
  v_mfma_f32_16x16x32_bf16 v[64:67], v[120:123], a[76:79], v[64:67]
  v_and_b32 v159, 0xffff0000, v247
  s_waitcnt vmcnt(24)
  s_barrier
  s_waitcnt lgkmcnt(0)
  v_mfma_f32_16x16x32_bf16 v[24:27], v[88:91], a[80:83], v[24:27]
  ds_read_b128 v[108:111], v2 offset:8192
  ds_read_b128 v[112:115], v2 offset:9216
  s_add_u32 m0, s21, 65536
  s_nop 0
  buffer_load_dwordx4 v2, s[8:11], m0 offen sc1 lds
  v_mfma_f32_16x16x32_bf16 v[52:55], v[88:91], a[84:87], v[52:55]
  ds_read_b128 v[116:119], v2 offset:10240
  ds_read_b128 v[120:123], v2 offset:11264
  v_lshlrev_b32 v160, 16, v248
  v_mfma_f32_16x16x32_bf16 v[28:31], v[92:95], a[80:83], v[28:31]
  v_and_b32 v161, 0xffff0000, v248
  v_mfma_f32_16x16x32_bf16 v[56:59], v[92:95], a[84:87], v[56:59]
  v_lshlrev_b32 v162, 16, v249
  v_mfma_f32_16x16x32_bf16 v[32:35], v[96:99], a[80:83], v[32:35]
  v_and_b32 v163, 0xffff0000, v249
  v_lshlrev_b32 v164, 16, v250
  v_mfma_f32_16x16x32_bf16 v[60:63], v[96:99], a[84:87], v[60:63]
  v_and_b32 v165, 0xffff0000, v250
  v_mfma_f32_16x16x32_bf16 v[36:39], v[100:103], a[80:83], v[36:39]
  v_lshlrev_b32 v166, 16, v251
  v_mfma_f32_16x16x32_bf16 v[64:67], v[100:103], a[84:87], v[64:67]
  v_and_b32 v167, 0xffff0000, v251
  s_waitcnt lgkmcnt(0)
  v_mfma_f32_16x16x32_bf16 v[24:27], v[108:111], a[88:91], v[24:27]
  ds_read_b128 v[88:91], v2 offset:12288
  ds_read_b128 v[92:95], v2 offset:13312
  s_add_u32 m0, s21, 69632
  s_nop 0
  buffer_load_dwordx4 v2, s[8:11], m0 offen sc1 lds
  v_mfma_f32_16x16x32_bf16 v[52:55], v[108:111], a[92:95], v[52:55]
  ds_read_b128 v[96:99], v2 offset:14336
  ds_read_b128 v[100:103], v2 offset:15360
  v_lshlrev_b32 v168, 16, v252
  v_mfma_f32_16x16x32_bf16 v[28:31], v[112:115], a[88:91], v[28:31]
  v_and_b32 v169, 0xffff0000, v252
  v_mfma_f32_16x16x32_bf16 v[56:59], v[112:115], a[92:95], v[56:59]
  v_lshlrev_b32 v170, 16, v253
  v_mfma_f32_16x16x32_bf16 v[32:35], v[116:119], a[88:91], v[32:35]
  v_and_b32 v171, 0xffff0000, v253
  v_lshlrev_b32 v172, 16, v254
  v_mfma_f32_16x16x32_bf16 v[60:63], v[116:119], a[92:95], v[60:63]
  v_and_b32 v173, 0xffff0000, v254
  v_mfma_f32_16x16x32_bf16 v[36:39], v[120:123], a[88:91], v[36:39]
  v_lshlrev_b32 v174, 16, v255
  v_mfma_f32_16x16x32_bf16 v[64:67], v[120:123], a[92:95], v[64:67]
  v_and_b32 v175, 0xffff0000, v255
  s_waitcnt vmcnt(22)
  s_barrier
  s_waitcnt lgkmcnt(0)
  v_mfma_f32_16x16x32_bf16 v[24:27], v[88:91], a[96:99], v[24:27]
  ds_read_b128 v[108:111], v2 offset:16384
  ds_read_b128 v[112:115], v2 offset:17408
  v_mfma_f32_16x16x32_bf16 v[52:55], v[88:91], a[100:103], v[52:55]
  ds_read_b128 v[116:119], v2 offset:18432
  ds_read_b128 v[120:123], v2 offset:19456
  v_mfma_f32_16x16x32_bf16 v[28:31], v[92:95], a[96:99], v[28:31]
  v_mfma_f32_16x16x32_bf16 v[56:59], v[92:95], a[100:103], v[56:59]
  v_mfma_f32_16x16x32_bf16 v[32:35], v[96:99], a[96:99], v[32:35]
  s_add_u32 m0, s21, 73728
  s_nop 0
  buffer_load_dwordx4 v2, s[8:11], m0 offen sc1 lds
  v_mfma_f32_16x16x32_bf16 v[60:63], v[96:99], a[100:103], v[60:63]
  v_mfma_f32_16x16x32_bf16 v[36:39], v[100:103], a[96:99], v[36:39]
  v_mfma_f32_16x16x32_bf16 v[64:67], v[100:103], a[100:103], v[64:67]
  s_waitcnt lgkmcnt(0)
  v_mfma_f32_16x16x32_bf16 v[24:27], v[108:111], a[104:107], v[24:27]
  ds_read_b128 v[88:91], v2 offset:20480
  ds_read_b128 v[92:95], v2 offset:21504
  v_mfma_f32_16x16x32_bf16 v[52:55], v[108:111], a[108:111], v[52:55]
  ds_read_b128 v[96:99], v2 offset:22528
  ds_read_b128 v[100:103], v2 offset:23552
  v_mfma_f32_16x16x32_bf16 v[28:31], v[112:115], a[104:107], v[28:31]
  v_mfma_f32_16x16x32_bf16 v[56:59], v[112:115], a[108:111], v[56:59]
  v_mfma_f32_16x16x32_bf16 v[32:35], v[116:119], a[104:107], v[32:35]
  s_add_u32 m0, s21, 77824
  s_nop 0
  buffer_load_dwordx4 v2, s[8:11], m0 offen sc1 lds
  v_mfma_f32_16x16x32_bf16 v[60:63], v[116:119], a[108:111], v[60:63]
  v_mfma_f32_16x16x32_bf16 v[36:39], v[120:123], a[104:107], v[36:39]
  v_mfma_f32_16x16x32_bf16 v[64:67], v[120:123], a[108:111], v[64:67]
  s_waitcnt vmcnt(20)
  s_barrier
  s_waitcnt lgkmcnt(0)
  v_mfma_f32_16x16x32_bf16 v[24:27], v[88:91], a[112:115], v[24:27]
  ds_read_b128 v[108:111], v2 offset:24576
  ds_read_b128 v[112:115], v2 offset:25600
  v_mfma_f32_16x16x32_bf16 v[52:55], v[88:91], a[116:119], v[52:55]
  ds_read_b128 v[116:119], v2 offset:26624
  ds_read_b128 v[120:123], v2 offset:27648
  v_mfma_f32_16x16x32_bf16 v[28:31], v[92:95], a[112:115], v[28:31]
  v_mfma_f32_16x16x32_bf16 v[56:59], v[92:95], a[116:119], v[56:59]
  v_mfma_f32_16x16x32_bf16 v[32:35], v[96:99], a[112:115], v[32:35]
  s_add_u32 m0, s21, 81920
  s_nop 0
  buffer_load_dwordx4 v2, s[8:11], m0 offen sc1 lds
  v_mfma_f32_16x16x32_bf16 v[60:63], v[96:99], a[116:119], v[60:63]
  v_mfma_f32_16x16x32_bf16 v[36:39], v[100:103], a[112:115], v[36:39]
  v_mfma_f32_16x16x32_bf16 v[64:67], v[100:103], a[116:119], v[64:67]
  s_waitcnt lgkmcnt(0)
  v_mfma_f32_16x16x32_bf16 v[24:27], v[108:111], a[120:123], v[24:27]
  ds_read_b128 v[88:91], v2 offset:28672
  ds_read_b128 v[92:95], v2 offset:29696
  v_mfma_f32_16x16x32_bf16 v[52:55], v[108:111], a[124:127], v[52:55]
  ds_read_b128 v[96:99], v2 offset:30720
  ds_read_b128 v[100:103], v2 offset:31744
  v_mfma_f32_16x16x32_bf16 v[28:31], v[112:115], a[120:123], v[28:31]
  s_add_u32 s8, s8, 86016
  s_addc_u32 s9, s9, 0
  v_mfma_f32_16x16x32_bf16 v[56:59], v[112:115], a[124:127], v[56:59]
  v_mfma_f32_16x16x32_bf16 v[32:35], v[116:119], a[120:123], v[32:35]
  v_mfma_f32_16x16x32_bf16 v[60:63], v[116:119], a[124:127], v[60:63]
  v_mfma_f32_16x16x32_bf16 v[36:39], v[120:123], a[120:123], v[36:39]
  s_add_u32 m0, s21, 0
  s_nop 0
  buffer_load_dwordx4 v2, s[8:11], m0 offen sc1 lds
  v_mfma_f32_16x16x32_bf16 v[64:67], v[120:123], a[124:127], v[64:67]
  s_waitcnt vmcnt(18)
  s_barrier
  s_waitcnt lgkmcnt(0)
  v_mfma_f32_16x16x32_bf16 v[24:27], v[88:91], a[128:131], v[24:27]
  ds_read_b128 v[108:111], v2 offset:32768
  ds_read_b128 v[112:115], v2 offset:33792
  v_mfma_f32_16x16x32_bf16 v[52:55], v[88:91], a[132:135], v[52:55]
  ds_read_b128 v[116:119], v2 offset:34816
  ds_read_b128 v[120:123], v2 offset:35840
  v_mfma_f32_16x16x32_bf16 v[28:31], v[92:95], a[128:131], v[28:31]
  v_mfma_f32_16x16x32_bf16 v[56:59], v[92:95], a[132:135], v[56:59]
  v_mfma_f32_16x16x32_bf16 v[32:35], v[96:99], a[128:131], v[32:35]
  s_add_u32 m0, s21, 4096
  s_nop 0
  buffer_load_dwordx4 v2, s[8:11], m0 offen sc1 lds
  v_mfma_f32_16x16x32_bf16 v[60:63], v[96:99], a[132:135], v[60:63]
  v_mfma_f32_16x16x32_bf16 v[36:39], v[100:103], a[128:131], v[36:39]
  v_mfma_f32_16x16x32_bf16 v[64:67], v[100:103], a[132:135], v[64:67]
  s_waitcnt lgkmcnt(0)
  v_mfma_f32_16x16x32_bf16 v[24:27], v[108:111], a[136:139], v[24:27]
  ds_read_b128 v[88:91], v2 offset:36864
  ds_read_b128 v[92:95], v2 offset:37888
  v_mfma_f32_16x16x32_bf16 v[52:55], v[108:111], a[140:143], v[52:55]
  ds_read_b128 v[96:99], v2 offset:38912
  ds_read_b128 v[100:103], v2 offset:39936
  v_mfma_f32_16x16x32_bf16 v[28:31], v[112:115], a[136:139], v[28:31]
  v_mfma_f32_16x16x32_bf16 v[56:59], v[112:115], a[140:143], v[56:59]
  v_mfma_f32_16x16x32_bf16 v[32:35], v[116:119], a[136:139], v[32:35]
  s_add_u32 m0, s21, 8192
  s_nop 0
  buffer_load_dwordx4 v2, s[8:11], m0 offen sc1 lds
  v_mfma_f32_16x16x32_bf16 v[60:63], v[116:119], a[140:143], v[60:63]
  v_mfma_f32_16x16x32_bf16 v[36:39], v[120:123], a[136:139], v[36:39]
  v_mfma_f32_16x16x32_bf16 v[64:67], v[120:123], a[140:143], v[64:67]
  s_waitcnt vmcnt(17)
  s_barrier
  s_waitcnt lgkmcnt(0)
  v_mfma_f32_16x16x32_bf16 v[24:27], v[88:91], a[144:147], v[24:27]
  ds_read_b128 v[108:111], v2 offset:40960
  ds_read_b128 v[112:115], v2 offset:41984
  v_mfma_f32_16x16x32_bf16 v[52:55], v[88:91], a[148:151], v[52:55]
  ds_read_b128 v[116:119], v2 offset:43008
  ds_read_b128 v[120:123], v2 offset:44032
  v_mfma_f32_16x16x32_bf16 v[28:31], v[92:95], a[144:147], v[28:31]
  v_mfma_f32_16x16x32_bf16 v[56:59], v[92:95], a[148:151], v[56:59]
  v_mfma_f32_16x16x32_bf16 v[32:35], v[96:99], a[144:147], v[32:35]
  s_add_u32 m0, s21, 12288
  s_nop 0
  buffer_load_dwordx4 v2, s[8:11], m0 offen sc1 lds
  v_mfma_f32_16x16x32_bf16 v[60:63], v[96:99], a[148:151], v[60:63]
  v_mfma_f32_16x16x32_bf16 v[36:39], v[100:103], a[144:147], v[36:39]
  v_mfma_f32_16x16x32_bf16 v[64:67], v[100:103], a[148:151], v[64:67]
  s_waitcnt lgkmcnt(0)
  v_mfma_f32_16x16x32_bf16 v[24:27], v[108:111], a[152:155], v[24:27]
  ds_read_b128 v[88:91], v2 offset:45056
  ds_read_b128 v[92:95], v2 offset:46080
  v_mfma_f32_16x16x32_bf16 v[52:55], v[108:111], a[156:159], v[52:55]
  ds_read_b128 v[96:99], v2 offset:47104
  v_mfma_f32_16x16x32_bf16 v[28:31], v[112:115], a[152:155], v[28:31]
  v_mfma_f32_16x16x32_bf16 v[56:59], v[112:115], a[156:159], v[56:59]
  v_mfma_f32_16x16x32_bf16 v[32:35], v[116:119], a[152:155], v[32:35]
  s_add_u32 m0, s21, 16384
  s_nop 0
  buffer_load_dwordx4 v2, s[8:11], m0 offen sc1 lds
  v_mfma_f32_16x16x32_bf16 v[60:63], v[116:119], a[156:159], v[60:63]
  v_mfma_f32_16x16x32_bf16 v[36:39], v[120:123], a[152:155], v[36:39]
  v_mfma_f32_16x16x32_bf16 v[64:67], v[120:123], a[156:159], v[64:67]
  s_waitcnt vmcnt(17)
  s_barrier
  s_waitcnt lgkmcnt(0)
  v_mfma_f32_16x16x32_bf16 v[40:43], v[88:91], a[160:163], v[216:219]
  ds_read_b128 v[108:111], v2 offset:48128
  ds_read_b128 v[112:115], v2 offset:49152
  s_add_u32 m0, s21, 20480
  s_nop 0
  buffer_load_dwordx4 v2, s[8:11], m0 offen sc1 lds
  v_mfma_f32_16x16x32_bf16 v[68:71], v[88:91], a[164:167], v[220:223]
  ds_read_b128 v[116:119], v2 offset:50176
  v_and_or_b32 v24, v24, s29, v20
  v_and_or_b32 v25, v25, s29, v21
  v_and_or_b32 v26, v26, s29, v22
  v_and_or_b32 v27, v27, s29, v23
  buffer_store_dwordx4 v[24:27], v2, s[4:7], s38 offen offset:0 sc1
  v_mfma_f32_16x16x32_bf16 v[44:47], v[92:95], a[160:163], v[216:219]
  v_mfma_f32_16x16x32_bf16 v[72:75], v[92:95], a[164:167], v[220:223]
  v_and_or_b32 v28, v28, s29, v20
  v_and_or_b32 v29, v29, s29, v21
  v_and_or_b32 v30, v30, s29, v22
  v_and_or_b32 v31, v31, s29, v23
  buffer_store_dwordx4 v[28:31], v2, s[4:7], s38 offen offset:1024 sc1
  v_mfma_f32_16x16x32_bf16 v[48:51], v[96:99], a[160:163], v[216:219]
  v_and_or_b32 v32, v32, s29, v20
  v_and_or_b32 v33, v33, s29, v21
  v_and_or_b32 v34, v34, s29, v22
  v_and_or_b32 v35, v35, s29, v23
  buffer_store_dwordx4 v[32:35], v2, s[4:7], s38 offen offset:2048 sc1
  v_mfma_f32_16x16x32_bf16 v[76:79], v[96:99], a[164:167], v[220:223]
  v_and_or_b32 v80, v36, s29, v20
  v_and_or_b32 v81, v37, s29, v21
  v_and_or_b32 v82, v38, s29, v22
  v_and_or_b32 v83, v39, s29, v23
  buffer_store_dwordx4 v[80:83], v2, s[4:7], s38 offen offset:3072 sc1
  s_waitcnt lgkmcnt(0)
  v_mfma_f32_16x16x32_bf16 v[40:43], v[108:111], a[168:171], v[40:43]
  ds_read_b128 v[88:91], v2 offset:51200
  ds_read_b128 v[92:95], v2 offset:52224
  s_add_u32 m0, s21, 24576
  s_nop 0
  buffer_load_dwordx4 v2, s[8:11], m0 offen sc1 lds
  v_mfma_f32_16x16x32_bf16 v[68:71], v[108:111], a[172:175], v[68:71]
  ds_read_b128 v[96:99], v2 offset:53248
  v_and_or_b32 v52, v52, s29, v20
  v_and_or_b32 v53, v53, s29, v21
  v_and_or_b32 v54, v54, s29, v22
  v_and_or_b32 v55, v55, s29, v23
  buffer_store_dwordx4 v[52:55], v186, s[4:7], s38 offen offset:0 sc1
  v_mfma_f32_16x16x32_bf16 v[44:47], v[112:115], a[168:171], v[44:47]
  v_mfma_f32_16x16x32_bf16 v[72:75], v[112:115], a[172:175], v[72:75]
  v_and_or_b32 v56, v56, s29, v20
  v_and_or_b32 v57, v57, s29, v21
  v_and_or_b32 v58, v58, s29, v22
  v_and_or_b32 v59, v59, s29, v23
  buffer_store_dwordx4 v[56:59], v186, s[4:7], s38 offen offset:1024 sc1
  v_mfma_f32_16x16x32_bf16 v[48:51], v[116:119], a[168:171], v[48:51]
  v_and_or_b32 v60, v60, s29, v20
  v_and_or_b32 v61, v61, s29, v21
  v_and_or_b32 v62, v62, s29, v22
  v_and_or_b32 v63, v63, s29, v23
  buffer_store_dwordx4 v[60:63], v186, s[4:7], s38 offen offset:2048 sc1
  v_mfma_f32_16x16x32_bf16 v[76:79], v[116:119], a[172:175], v[76:79]
  v_and_or_b32 v84, v64, s29, v20
  v_and_or_b32 v85, v65, s29, v21
  v_and_or_b32 v86, v66, s29, v22
  v_and_or_b32 v87, v67, s29, v23
  buffer_store_dwordx4 v[84:87], v186, s[4:7], s38 offen offset:3072 sc1
  s_waitcnt vmcnt(26)
  s_barrier
  s_waitcnt lgkmcnt(0)
  v_mfma_f32_16x16x32_bf16 v[40:43], v[88:91], a[176:179], v[40:43]
  ds_read_b128 v[108:111], v2 offset:54272
  ds_read_b128 v[112:115], v2 offset:55296
  v_mfma_f32_16x16x32_bf16 v[68:71], v[88:91], a[180:183], v[68:71]
  ds_read_b128 v[116:119], v2 offset:56320
  v_mfma_f32_16x16x32_bf16 v[44:47], v[92:95], a[176:179], v[44:47]
  v_mfma_f32_16x16x32_bf16 v[72:75], v[92:95], a[180:183], v[72:75]
  s_add_u32 m0, s21, 28672
  s_nop 0
  buffer_load_dwordx4 v2, s[8:11], m0 offen sc1 lds
  v_mfma_f32_16x16x32_bf16 v[48:51], v[96:99], a[176:179], v[48:51]
  v_mfma_f32_16x16x32_bf16 v[76:79], v[96:99], a[180:183], v[76:79]
  s_waitcnt lgkmcnt(0)
  v_mfma_f32_16x16x32_bf16 v[40:43], v[108:111], a[184:187], v[40:43]
  ds_read_b128 v[88:91], v2 offset:57344
  ds_read_b128 v[92:95], v2 offset:58368
  v_mfma_f32_16x16x32_bf16 v[68:71], v[108:111], a[188:191], v[68:71]
  ds_read_b128 v[96:99], v2 offset:59392
  v_mfma_f32_16x16x32_bf16 v[44:47], v[112:115], a[184:187], v[44:47]
  v_mfma_f32_16x16x32_bf16 v[72:75], v[112:115], a[188:191], v[72:75]
  v_mfma_f32_16x16x32_bf16 v[48:51], v[116:119], a[184:187], v[48:51]
  v_mfma_f32_16x16x32_bf16 v[76:79], v[116:119], a[188:191], v[76:79]
  s_waitcnt vmcnt(20)
  s_barrier
  s_waitcnt lgkmcnt(0)
  v_mfma_f32_16x16x32_bf16 v[40:43], v[88:91], a[192:195], v[40:43]
  ds_read_b128 v[108:111], v2 offset:60416
  ds_read_b128 v[112:115], v2 offset:61440
  v_mfma_f32_16x16x32_bf16 v[68:71], v[88:91], a[196:199], v[68:71]
  ds_read_b128 v[116:119], v2 offset:62464
  v_mfma_f32_16x16x32_bf16 v[44:47], v[92:95], a[192:195], v[44:47]
  v_mfma_f32_16x16x32_bf16 v[72:75], v[92:95], a[196:199], v[72:75]
  s_add_u32 m0, s21, 32768
  s_nop 0
  buffer_load_dwordx4 v2, s[8:11], m0 offen sc1 lds
  v_mfma_f32_16x16x32_bf16 v[48:51], v[96:99], a[192:195], v[48:51]
  v_mfma_f32_16x16x32_bf16 v[76:79], v[96:99], a[196:199], v[76:79]
  s_waitcnt lgkmcnt(0)
  v_mfma_f32_16x16x32_bf16 v[40:43], v[108:111], a[200:203], v[40:43]
  ds_read_b128 v[88:91], v2 offset:63488
  ds_read_b128 v[92:95], v2 offset:64512
  v_mfma_f32_16x16x32_bf16 v[68:71], v[108:111], a[204:207], v[68:71]
  ds_read_b128 v[96:99], v6 offset:0
  v_mfma_f32_16x16x32_bf16 v[44:47], v[112:115], a[200:203], v[44:47]
  v_mfma_f32_16x16x32_bf16 v[72:75], v[112:115], a[204:207], v[72:75]
  s_add_u32 m0, s21, 36864
  s_nop 0
  buffer_load_dwordx4 v2, s[8:11], m0 offen sc1 lds
  v_mfma_f32_16x16x32_bf16 v[48:51], v[116:119], a[200:203], v[48:51]
  v_mfma_f32_16x16x32_bf16 v[76:79], v[116:119], a[204:207], v[76:79]
  s_waitcnt vmcnt(21)
  s_barrier
  s_waitcnt lgkmcnt(0)
  v_mfma_f32_16x16x32_bf16 v[40:43], v[88:91], a[208:211], v[40:43]
  ds_read_b128 v[108:111], v6 offset:1024
  ds_read_b128 v[112:115], v6 offset:2048
  v_mfma_f32_16x16x32_bf16 v[68:71], v[88:91], a[212:215], v[68:71]
  ds_read_b128 v[116:119], v6 offset:3072
  v_mfma_f32_16x16x32_bf16 v[44:47], v[92:95], a[208:211], v[44:47]
  v_mfma_f32_16x16x32_bf16 v[72:75], v[92:95], a[212:215], v[72:75]
  s_add_u32 m0, s21, 40960
  s_nop 0
  buffer_load_dwordx4 v2, s[8:11], m0 offen sc1 lds
  v_mfma_f32_16x16x32_bf16 v[48:51], v[96:99], a[208:211], v[48:51]
  v_mfma_f32_16x16x32_bf16 v[76:79], v[96:99], a[212:215], v[76:79]
  s_waitcnt lgkmcnt(0)
  v_mfma_f32_16x16x32_bf16 v[40:43], v[108:111], a[216:219], v[40:43]
  ds_read_b128 v[88:91], v6 offset:4096
  ds_read_b128 v[92:95], v6 offset:5120
  v_mfma_f32_16x16x32_bf16 v[68:71], v[108:111], a[220:223], v[68:71]
  ds_read_b128 v[96:99], v6 offset:6144
  v_mfma_f32_16x16x32_bf16 v[44:47], v[112:115], a[216:219], v[44:47]
  v_mfma_f32_16x16x32_bf16 v[72:75], v[112:115], a[220:223], v[72:75]
  v_mfma_f32_16x16x32_bf16 v[48:51], v[116:119], a[216:219], v[48:51]
  v_mfma_f32_16x16x32_bf16 v[76:79], v[116:119], a[220:223], v[76:79]
  s_waitcnt vmcnt(20)
  s_barrier
  s_waitcnt lgkmcnt(0)
  v_mfma_f32_16x16x32_bf16 v[40:43], v[88:91], a[224:227], v[40:43]
  ds_read_b128 v[108:111], v6 offset:7168
  ds_read_b128 v[112:115], v6 offset:8192
  v_mfma_f32_16x16x32_bf16 v[68:71], v[88:91], a[228:231], v[68:71]
  ds_read_b128 v[116:119], v6 offset:9216
  v_mfma_f32_16x16x32_bf16 v[44:47], v[92:95], a[224:227], v[44:47]
  v_mfma_f32_16x16x32_bf16 v[72:75], v[92:95], a[228:231], v[72:75]
  s_add_u32 m0, s21, 45056
  s_nop 0
  buffer_load_dwordx4 v2, s[8:11], m0 offen sc1 lds
  v_mfma_f32_16x16x32_bf16 v[48:51], v[96:99], a[224:227], v[48:51]
  v_mfma_f32_16x16x32_bf16 v[76:79], v[96:99], a[228:231], v[76:79]
  s_waitcnt lgkmcnt(0)
  v_mfma_f32_16x16x32_bf16 v[40:43], v[108:111], a[232:235], v[40:43]
  ds_read_b128 v[88:91], v6 offset:10240
  ds_read_b128 v[92:95], v6 offset:11264
  v_mfma_f32_16x16x32_bf16 v[68:71], v[108:111], a[236:239], v[68:71]
  ds_read_b128 v[96:99], v6 offset:12288
  v_mfma_f32_16x16x32_bf16 v[44:47], v[112:115], a[232:235], v[44:47]
  v_mfma_f32_16x16x32_bf16 v[72:75], v[112:115], a[236:239], v[72:75]
  s_add_u32 m0, s21, 49152
  s_nop 0
  buffer_load_dwordx4 v2, s[8:11], m0 offen sc1 lds
  v_mfma_f32_16x16x32_bf16 v[48:51], v[116:119], a[232:235], v[48:51]
  v_mfma_f32_16x16x32_bf16 v[76:79], v[116:119], a[236:239], v[76:79]
  s_waitcnt vmcnt(21)
  s_barrier
  s_waitcnt lgkmcnt(0)
  v_mfma_f32_16x16x32_bf16 v[40:43], v[88:91], a[240:243], v[40:43]
  ds_read_b128 v[108:111], v6 offset:13312
  ds_read_b128 v[112:115], v6 offset:14336
  v_mfma_f32_16x16x32_bf16 v[68:71], v[88:91], a[244:247], v[68:71]
  ds_read_b128 v[116:119], v6 offset:15360
  v_mfma_f32_16x16x32_bf16 v[44:47], v[92:95], a[240:243], v[44:47]
  v_mfma_f32_16x16x32_bf16 v[72:75], v[92:95], a[244:247], v[72:75]
  s_add_u32 m0, s21, 53248
  s_nop 0
  buffer_load_dwordx4 v2, s[8:11], m0 offen sc1 lds
  v_mfma_f32_16x16x32_bf16 v[48:51], v[96:99], a[240:243], v[48:51]
  v_mfma_f32_16x16x32_bf16 v[76:79], v[96:99], a[244:247], v[76:79]
  s_waitcnt lgkmcnt(0)
  v_mfma_f32_16x16x32_bf16 v[40:43], v[108:111], a[248:251], v[40:43]
  ds_read_b128 v[88:91], v6 offset:16384
  ds_read_b128 v[92:95], v6 offset:17408
  v_mfma_f32_16x16x32_bf16 v[68:71], v[108:111], a[252:255], v[68:71]
  ds_read_b128 v[96:99], v6 offset:18432
  v_mfma_f32_16x16x32_bf16 v[44:47], v[112:115], a[248:251], v[44:47]
  v_mfma_f32_16x16x32_bf16 v[72:75], v[112:115], a[252:255], v[72:75]
  v_mfma_f32_16x16x32_bf16 v[48:51], v[116:119], a[248:251], v[48:51]
  v_mfma_f32_16x16x32_bf16 v[76:79], v[116:119], a[252:255], v[76:79]
  s_waitcnt vmcnt(20)
  s_barrier
  s_waitcnt lgkmcnt(0)
  v_mfma_f32_16x16x32_bf16 v[40:43], v[88:91], a[0:3], v[40:43]
  ds_read_b128 v[108:111], v6 offset:19456
  ds_read_b128 v[112:115], v2 offset:0
  v_mfma_f32_16x16x32_bf16 v[68:71], v[88:91], a[4:7], v[68:71]
  ds_read_b128 v[116:119], v2 offset:1024
  v_mfma_f32_16x16x32_bf16 v[44:47], v[92:95], a[0:3], v[44:47]
  v_mfma_f32_16x16x32_bf16 v[72:75], v[92:95], a[4:7], v[72:75]
  v_mfma_f32_16x16x32_bf16 v[48:51], v[96:99], a[0:3], v[48:51]
  v_mfma_f32_16x16x32_bf16 v[76:79], v[96:99], a[4:7], v[76:79]
  s_waitcnt lgkmcnt(0)
  v_mfma_f32_16x16x32_bf16 v[40:43], v[108:111], a[8:11], v[40:43]
  ds_read_b128 v[88:91], v2 offset:2048
  ds_read_b128 v[92:95], v2 offset:3072
  v_mfma_f32_16x16x32_bf16 v[68:71], v[108:111], a[12:15], v[68:71]
  ds_read_b128 v[96:99], v2 offset:4096
  v_mfma_f32_16x16x32_bf16 v[44:47], v[112:115], a[8:11], v[44:47]
  v_mfma_f32_16x16x32_bf16 v[72:75], v[112:115], a[12:15], v[72:75]
  v_mfma_f32_16x16x32_bf16 v[48:51], v[116:119], a[8:11], v[48:51]
  v_mfma_f32_16x16x32_bf16 v[76:79], v[116:119], a[12:15], v[76:79]
  s_waitcnt vmcnt(19)
  s_barrier
  s_waitcnt lgkmcnt(0)
  v_mfma_f32_16x16x32_bf16 v[40:43], v[88:91], a[16:19], v[40:43]
  ds_read_b128 v[108:111], v2 offset:5120
  ds_read_b128 v[112:115], v2 offset:6144
  buffer_load_dwordx4 v[24:27], v2, s[4:7], s30 offen offset:0 sc1
  v_mfma_f32_16x16x32_bf16 v[68:71], v[88:91], a[20:23], v[68:71]
  ds_read_b128 v[116:119], v2 offset:7168
  v_mfma_f32_16x16x32_bf16 v[44:47], v[92:95], a[16:19], v[44:47]
  buffer_load_dwordx4 v[28:31], v2, s[4:7], s30 offen offset:1024 sc1
  v_mfma_f32_16x16x32_bf16 v[72:75], v[92:95], a[20:23], v[72:75]
  buffer_load_dwordx4 v[32:35], v2, s[4:7], s30 offen offset:2048 sc1
  v_mfma_f32_16x16x32_bf16 v[48:51], v[96:99], a[16:19], v[48:51]
  v_mfma_f32_16x16x32_bf16 v[76:79], v[96:99], a[20:23], v[76:79]
  buffer_load_dwordx4 v[80:83], v2, s[4:7], s30 offen offset:3072 sc1
  s_waitcnt lgkmcnt(0)
  v_mfma_f32_16x16x32_bf16 v[40:43], v[108:111], a[24:27], v[40:43]
  ds_read_b128 v[88:91], v2 offset:8192
  ds_read_b128 v[92:95], v2 offset:9216
  buffer_load_dwordx4 v[52:55], v186, s[4:7], s30 offen offset:0 sc1
  v_mfma_f32_16x16x32_bf16 v[68:71], v[108:111], a[28:31], v[68:71]
  ds_read_b128 v[96:99], v2 offset:10240
  v_mfma_f32_16x16x32_bf16 v[44:47], v[112:115], a[24:27], v[44:47]
  buffer_load_dwordx4 v[56:59], v186, s[4:7], s30 offen offset:1024 sc1
  v_mfma_f32_16x16x32_bf16 v[72:75], v[112:115], a[28:31], v[72:75]
  buffer_load_dwordx4 v[60:63], v186, s[4:7], s30 offen offset:2048 sc1
  v_mfma_f32_16x16x32_bf16 v[48:51], v[116:119], a[24:27], v[48:51]
  v_mfma_f32_16x16x32_bf16 v[76:79], v[116:119], a[28:31], v[76:79]
  buffer_load_dwordx4 v[84:87], v186, s[4:7], s30 offen offset:3072 sc1
  s_waitcnt vmcnt(25)
  s_barrier
  s_waitcnt lgkmcnt(0)
  v_mfma_f32_16x16x32_bf16 v[40:43], v[88:91], a[32:35], v[40:43]
  ds_read_b128 v[108:111], v2 offset:11264
  ds_read_b128 v[112:115], v2 offset:12288
  v_mfma_f32_16x16x32_bf16 v[68:71], v[88:91], a[36:39], v[68:71]
  ds_read_b128 v[116:119], v2 offset:13312
  v_mfma_f32_16x16x32_bf16 v[44:47], v[92:95], a[32:35], v[44:47]
  v_mfma_f32_16x16x32_bf16 v[72:75], v[92:95], a[36:39], v[72:75]
  v_mfma_f32_16x16x32_bf16 v[48:51], v[96:99], a[32:35], v[48:51]
  v_mfma_f32_16x16x32_bf16 v[76:79], v[96:99], a[36:39], v[76:79]
  s_waitcnt lgkmcnt(0)
  v_mfma_f32_16x16x32_bf16 v[40:43], v[108:111], a[40:43], v[40:43]
  ds_read_b128 v[88:91], v2 offset:14336
  ds_read_b128 v[92:95], v2 offset:15360
  v_mfma_f32_16x16x32_bf16 v[68:71], v[108:111], a[44:47], v[68:71]
  ds_read_b128 v[96:99], v2 offset:16384
  v_mfma_f32_16x16x32_bf16 v[44:47], v[112:115], a[40:43], v[44:47]
  v_mfma_f32_16x16x32_bf16 v[72:75], v[112:115], a[44:47], v[72:75]
  v_mfma_f32_16x16x32_bf16 v[48:51], v[116:119], a[40:43], v[48:51]
  v_mfma_f32_16x16x32_bf16 v[76:79], v[116:119], a[44:47], v[76:79]
  s_waitcnt vmcnt(24)
  s_barrier
  s_waitcnt lgkmcnt(0)
  v_mfma_f32_16x16x32_bf16 v[40:43], v[88:91], a[48:51], v[40:43]
  ds_read_b128 v[108:111], v2 offset:17408
  ds_read_b128 v[112:115], v2 offset:18432
  v_mfma_f32_16x16x32_bf16 v[68:71], v[88:91], a[52:55], v[68:71]
  ds_read_b128 v[116:119], v2 offset:19456
  v_mfma_f32_16x16x32_bf16 v[44:47], v[92:95], a[48:51], v[44:47]
  v_mfma_f32_16x16x32_bf16 v[72:75], v[92:95], a[52:55], v[72:75]
  v_mfma_f32_16x16x32_bf16 v[48:51], v[96:99], a[48:51], v[48:51]
  v_mfma_f32_16x16x32_bf16 v[76:79], v[96:99], a[52:55], v[76:79]
  s_waitcnt lgkmcnt(0)
  v_mfma_f32_16x16x32_bf16 v[40:43], v[108:111], a[56:59], v[40:43]
  ds_read_b128 v[88:91], v2 offset:20480
  ds_read_b128 v[92:95], v2 offset:21504
  v_mfma_f32_16x16x32_bf16 v[68:71], v[108:111], a[60:63], v[68:71]
  ds_read_b128 v[96:99], v2 offset:22528
  v_mfma_f32_16x16x32_bf16 v[44:47], v[112:115], a[56:59], v[44:47]
  v_mfma_f32_16x16x32_bf16 v[72:75], v[112:115], a[60:63], v[72:75]
  v_mfma_f32_16x16x32_bf16 v[48:51], v[116:119], a[56:59], v[48:51]
  v_mfma_f32_16x16x32_bf16 v[76:79], v[116:119], a[60:63], v[76:79]
  s_waitcnt vmcnt(14)
  s_barrier
  s_waitcnt lgkmcnt(0)
  v_mfma_f32_16x16x32_bf16 v[40:43], v[88:91], a[64:67], v[40:43]
  ds_read_b128 v[108:111], v2 offset:23552
  ds_read_b128 v[112:115], v2 offset:24576
  v_mfma_f32_16x16x32_bf16 v[68:71], v[88:91], a[68:71], v[68:71]
  ds_read_b128 v[116:119], v2 offset:25600
  v_mfma_f32_16x16x32_bf16 v[44:47], v[92:95], a[64:67], v[44:47]
  v_mfma_f32_16x16x32_bf16 v[72:75], v[92:95], a[68:71], v[72:75]
  s_add_u32 m0, s21, 0
  s_add_u32 s24, s21, 57344
  buffer_load_dwordx4 v2, s[40:43], s24 offen sc1 lds
  v_mfma_f32_16x16x32_bf16 v[48:51], v[96:99], a[64:67], v[48:51]
  v_mfma_f32_16x16x32_bf16 v[76:79], v[96:99], a[68:71], v[76:79]
  s_waitcnt lgkmcnt(0)
  v_mfma_f32_16x16x32_bf16 v[40:43], v[108:111], a[72:75], v[40:43]
  ds_read_b128 v[88:91], v2 offset:26624
  ds_read_b128 v[92:95], v2 offset:27648
  v_mfma_f32_16x16x32_bf16 v[68:71], v[108:111], a[76:79], v[68:71]
  ds_read_b128 v[96:99], v2 offset:28672
  v_mfma_f32_16x16x32_bf16 v[44:47], v[112:115], a[72:75], v[44:47]
  v_mfma_f32_16x16x32_bf16 v[72:75], v[112:115], a[76:79], v[72:75]
  v_mfma_f32_16x16x32_bf16 v[48:51], v[116:119], a[72:75], v[48:51]
  v_mfma_f32_16x16x32_bf16 v[76:79], v[116:119], a[76:79], v[76:79]
  s_waitcnt vmcnt(14)
  s_barrier
  s_waitcnt lgkmcnt(0)
  v_mfma_f32_16x16x32_bf16 v[40:43], v[88:91], a[80:83], v[40:43]
  ds_read_b128 v[108:111], v2 offset:29696
  ds_read_b128 v[112:115], v2 offset:30720
  v_mfma_f32_16x16x32_bf16 v[68:71], v[88:91], a[84:87], v[68:71]
  ds_read_b128 v[116:119], v2 offset:31744
  v_mfma_f32_16x16x32_bf16 v[44:47], v[92:95], a[80:83], v[44:47]
  v_mfma_f32_16x16x32_bf16 v[72:75], v[92:95], a[84:87], v[72:75]
  v_mfma_f32_16x16x32_bf16 v[48:51], v[96:99], a[80:83], v[48:51]
  v_mfma_f32_16x16x32_bf16 v[76:79], v[96:99], a[84:87], v[76:79]
  s_waitcnt lgkmcnt(0)
  v_mfma_f32_16x16x32_bf16 v[40:43], v[108:111], a[88:91], v[40:43]
  ds_read_b128 v[88:91], v2 offset:32768
  ds_read_b128 v[92:95], v2 offset:33792
  v_mfma_f32_16x16x32_bf16 v[68:71], v[108:111], a[92:95], v[68:71]
  ds_read_b128 v[96:99], v2 offset:34816
  v_mfma_f32_16x16x32_bf16 v[44:47], v[112:115], a[88:91], v[44:47]
  v_mfma_f32_16x16x32_bf16 v[72:75], v[112:115], a[92:95], v[72:75]
  v_mfma_f32_16x16x32_bf16 v[48:51], v[116:119], a[88:91], v[48:51]
  v_mfma_f32_16x16x32_bf16 v[76:79], v[116:119], a[92:95], v[76:79]
  s_waitcnt vmcnt(12)
  s_barrier
  s_waitcnt lgkmcnt(0)
  v_mfma_f32_16x16x32_bf16 v[40:43], v[88:91], a[96:99], v[40:43]
  ds_read_b128 v[108:111], v2 offset:35840
  ds_read_b128 v[112:115], v2 offset:36864
  v_mfma_f32_16x16x32_bf16 v[68:71], v[88:91], a[100:103], v[68:71]
  ds_read_b128 v[116:119], v2 offset:37888
  v_mfma_f32_16x16x32_bf16 v[44:47], v[92:95], a[96:99], v[44:47]
  v_mfma_f32_16x16x32_bf16 v[72:75], v[92:95], a[100:103], v[72:75]
  s_add_u32 m0, s21, 4096
  s_add_u32 s24, s21, 61440
  buffer_load_dwordx4 v2, s[40:43], s24 offen sc1 lds
  v_mfma_f32_16x16x32_bf16 v[48:51], v[96:99], a[96:99], v[48:51]
  v_mfma_f32_16x16x32_bf16 v[76:79], v[96:99], a[100:103], v[76:79]
  s_waitcnt lgkmcnt(0)
  v_mfma_f32_16x16x32_bf16 v[40:43], v[108:111], a[104:107], v[40:43]
  ds_read_b128 v[88:91], v2 offset:38912
  ds_read_b128 v[92:95], v2 offset:39936
  v_mfma_f32_16x16x32_bf16 v[68:71], v[108:111], a[108:111], v[68:71]
  ds_read_b128 v[96:99], v2 offset:40960
  v_mfma_f32_16x16x32_bf16 v[44:47], v[112:115], a[104:107], v[44:47]
  v_mfma_f32_16x16x32_bf16 v[72:75], v[112:115], a[108:111], v[72:75]
  v_mfma_f32_16x16x32_bf16 v[48:51], v[116:119], a[104:107], v[48:51]
  v_mfma_f32_16x16x32_bf16 v[76:79], v[116:119], a[108:111], v[76:79]
  s_waitcnt vmcnt(12)
  s_barrier
  s_waitcnt lgkmcnt(0)
  v_mfma_f32_16x16x32_bf16 v[40:43], v[88:91], a[112:115], v[40:43]
  ds_read_b128 v[108:111], v2 offset:41984
  ds_read_b128 v[112:115], v2 offset:43008
  s_waitcnt vmcnt(9)
  v_xor_b32 v24, v24, v20
  v_mfma_f32_16x16x32_bf16 v[68:71], v[88:91], a[116:119], v[68:71]
  ds_read_b128 v[116:119], v2 offset:44032
  v_xor_b32 v25, v25, v21
  v_xor_b32 v26, v26, v22
  v_mfma_f32_16x16x32_bf16 v[44:47], v[92:95], a[112:115], v[44:47]
  v_xor_b32 v27, v27, v23
  v_mfma_f32_16x16x32_bf16 v[72:75], v[92:95], a[116:119], v[72:75]
  v_or_b32 v224, v24, v25
  v_mfma_f32_16x16x32_bf16 v[48:51], v[96:99], a[112:115], v[48:51]
  v_or_b32 v225, v26, v27
  s_waitcnt vmcnt(8)
  v_xor_b32 v28, v28, v20
  v_mfma_f32_16x16x32_bf16 v[76:79], v[96:99], a[116:119], v[76:79]
  v_xor_b32 v29, v29, v21
  s_waitcnt lgkmcnt(0)
  v_mfma_f32_16x16x32_bf16 v[40:43], v[108:111], a[120:123], v[40:43]
  ds_read_b128 v[88:91], v2 offset:45056
  ds_read_b128 v[92:95], v2 offset:46080
  v_xor_b32 v30, v30, v22
  v_mfma_f32_16x16x32_bf16 v[68:71], v[108:111], a[124:127], v[68:71]
  ds_read_b128 v[96:99], v2 offset:47104
  v_xor_b32 v31, v31, v23
  v_or3_b32 v224, v28, v29, v224
  v_mfma_f32_16x16x32_bf16 v[44:47], v[112:115], a[120:123], v[44:47]
  v_or3_b32 v225, v30, v31, v225
  v_mfma_f32_16x16x32_bf16 v[72:75], v[112:115], a[124:127], v[72:75]
  s_waitcnt vmcnt(7)
  v_xor_b32 v32, v32, v20
  v_mfma_f32_16x16x32_bf16 v[48:51], v[116:119], a[120:123], v[48:51]
  v_xor_b32 v33, v33, v21
  v_xor_b32 v34, v34, v22
  v_mfma_f32_16x16x32_bf16 v[76:79], v[116:119], a[124:127], v[76:79]
  v_xor_b32 v35, v35, v23
  s_barrier
  s_waitcnt lgkmcnt(0)
  v_mfma_f32_16x16x32_bf16 v[40:43], v[88:91], a[128:131], v[40:43]
  ds_read_b128 v[108:111], v2 offset:48128
  ds_read_b128 v[112:115], v2 offset:49152
  v_or3_b32 v224, v32, v33, v224
  v_mfma_f32_16x16x32_bf16 v[68:71], v[88:91], a[132:135], v[68:71]
  ds_read_b128 v[116:119], v2 offset:50176
  v_or3_b32 v225, v34, v35, v225
  s_waitcnt vmcnt(6)
  v_xor_b32 v80, v80, v20
  v_mfma_f32_16x16x32_bf16 v[44:47], v[92:95], a[128:131], v[44:47]
  v_xor_b32 v81, v81, v21
  v_mfma_f32_16x16x32_bf16 v[72:75], v[92:95], a[132:135], v[72:75]
  v_xor_b32 v82, v82, v22
  v_xor_b32 v83, v83, v23
  v_mfma_f32_16x16x32_bf16 v[48:51], v[96:99], a[128:131], v[48:51]
  v_or3_b32 v224, v80, v81, v224
  v_mfma_f32_16x16x32_bf16 v[76:79], v[96:99], a[132:135], v[76:79]
  v_or3_b32 v225, v82, v83, v225
  s_add_u32 m0, s21, 8192
  s_add_u32 s24, s21, 65536
  buffer_load_dwordx4 v2, s[40:43], s24 offen sc1 lds
  s_waitcnt lgkmcnt(0)
  v_mfma_f32_16x16x32_bf16 v[40:43], v[108:111], a[136:139], v[40:43]
  ds_read_b128 v[88:91], v2 offset:51200
  ds_read_b128 v[92:95], v2 offset:52224
  s_waitcnt vmcnt(6)
  v_xor_b32 v52, v52, v20
  v_mfma_f32_16x16x32_bf16 v[68:71], v[108:111], a[140:143], v[68:71]
  ds_read_b128 v[96:99], v2 offset:53248
  v_xor_b32 v53, v53, v21
  v_xor_b32 v54, v54, v22
  v_mfma_f32_16x16x32_bf16 v[44:47], v[112:115], a[136:139], v[44:47]
  v_xor_b32 v55, v55, v23
  v_mfma_f32_16x16x32_bf16 v[72:75], v[112:115], a[140:143], v[72:75]
  v_or3_b32 v224, v52, v53, v224
  v_mfma_f32_16x16x32_bf16 v[48:51], v[116:119], a[136:139], v[48:51]
  v_or3_b32 v225, v54, v55, v225
  s_waitcnt vmcnt(5)
  v_xor_b32 v56, v56, v20
  v_mfma_f32_16x16x32_bf16 v[76:79], v[116:119], a[140:143], v[76:79]
  v_xor_b32 v57, v57, v21
  s_barrier
  s_waitcnt lgkmcnt(0)
  v_mfma_f32_16x16x32_bf16 v[40:43], v[88:91], a[144:147], v[40:43]
  ds_read_b128 v[108:111], v2 offset:54272
  ds_read_b128 v[112:115], v2 offset:55296
  v_xor_b32 v58, v58, v22
  v_mfma_f32_16x16x32_bf16 v[68:71], v[88:91], a[148:151], v[68:71]
  ds_read_b128 v[116:119], v2 offset:56320
  v_xor_b32 v59, v59, v23
  v_or3_b32 v224, v56, v57, v224
  v_mfma_f32_16x16x32_bf16 v[44:47], v[92:95], a[144:147], v[44:47]
  v_or3_b32 v225, v58, v59, v225
  v_mfma_f32_16x16x32_bf16 v[72:75], v[92:95], a[148:151], v[72:75]
  s_waitcnt vmcnt(4)
  v_xor_b32 v60, v60, v20
  v_mfma_f32_16x16x32_bf16 v[48:51], v[96:99], a[144:147], v[48:51]
  v_xor_b32 v61, v61, v21
  v_xor_b32 v62, v62, v22
  v_mfma_f32_16x16x32_bf16 v[76:79], v[96:99], a[148:151], v[76:79]
  v_xor_b32 v63, v63, v23
  s_waitcnt lgkmcnt(0)
  v_mfma_f32_16x16x32_bf16 v[40:43], v[108:111], a[152:155], v[40:43]
  v_or3_b32 v224, v60, v61, v224
  v_mfma_f32_16x16x32_bf16 v[68:71], v[108:111], a[156:159], v[68:71]
  v_or3_b32 v225, v62, v63, v225
  s_waitcnt vmcnt(3)
  v_xor_b32 v84, v84, v20
  v_mfma_f32_16x16x32_bf16 v[44:47], v[112:115], a[152:155], v[44:47]
  v_xor_b32 v85, v85, v21
  v_mfma_f32_16x16x32_bf16 v[72:75], v[112:115], a[156:159], v[72:75]
  v_xor_b32 v86, v86, v22
  v_mfma_f32_16x16x32_bf16 v[48:51], v[116:119], a[152:155], v[48:51]
  v_xor_b32 v87, v87, v23
  v_or3_b32 v224, v84, v85, v224
  v_mfma_f32_16x16x32_bf16 v[76:79], v[116:119], a[156:159], v[76:79]
  v_or3_b32 v225, v86, v87, v225
  s_barrier
  s_mov_b32 s32, 0
  v_or_b32 v224, v224, v225
  v_and_b32 v224, 255, v224
  v_cmp_ne_u32 vcc, 0, v224
  s_nop 0
  s_cmp_eq_u64 vcc, 0
  s_cbranch_scc1 kg_x_ok
kg_x_again:
  s_sleep 2
  buffer_load_dwordx4 v[24:27], v2, s[4:7], s30 offen offset:0 sc1
  buffer_load_dwordx4 v[28:31], v2, s[4:7], s30 offen offset:1024 sc1
  buffer_load_dwordx4 v[32:35], v2, s[4:7], s30 offen offset:2048 sc1
  buffer_load_dwordx4 v[80:83], v2, s[4:7], s30 offen offset:3072 sc1
  buffer_load_dwordx4 v[52:55], v186, s[4:7], s30 offen offset:0 sc1
  buffer_load_dwordx4 v[56:59], v186, s[4:7], s30 offen offset:1024 sc1
  buffer_load_dwordx4 v[60:63], v186, s[4:7], s30 offen offset:2048 sc1
  buffer_load_dwordx4 v[84:87], v186, s[4:7], s30 offen offset:3072 sc1
  s_waitcnt vmcnt(7)
  v_xor_b32 v24, v24, v20
  v_xor_b32 v25, v25, v21
  v_xor_b32 v26, v26, v22
  v_xor_b32 v27, v27, v23
  v_or_b32 v224, v24, v25
  v_or_b32 v225, v26, v27
  s_waitcnt vmcnt(6)
  v_xor_b32 v28, v28, v20
  v_xor_b32 v29, v29, v21
  v_xor_b32 v30, v30, v22
  v_xor_b32 v31, v31, v23
  v_or3_b32 v224, v28, v29, v224
  v_or3_b32 v225, v30, v31, v225
  s_waitcnt vmcnt(5)
  v_xor_b32 v32, v32, v20
  v_xor_b32 v33, v33, v21
  v_xor_b32 v34, v34, v22
  v_xor_b32 v35, v35, v23
  v_or3_b32 v224, v32, v33, v224
  v_or3_b32 v225, v34, v35, v225
  s_waitcnt vmcnt(4)
  v_xor_b32 v80, v80, v20
  v_xor_b32 v81, v81, v21
  v_xor_b32 v82, v82, v22
  v_xor_b32 v83, v83, v23
  v_or3_b32 v224, v80, v81, v224
  v_or3_b32 v225, v82, v83, v225
  s_waitcnt vmcnt(3)
  v_xor_b32 v52, v52, v20
  v_xor_b32 v53, v53, v21
  v_xor_b32 v54, v54, v22
  v_xor_b32 v55, v55, v23
  v_or3_b32 v224, v52, v53, v224
  v_or3_b32 v225, v54, v55, v225
  s_waitcnt vmcnt(2)
  v_xor_b32 v56, v56, v20
  v_xor_b32 v57, v57, v21
  v_xor_b32 v58, v58, v22
  v_xor_b32 v59, v59, v23
  v_or3_b32 v224, v56, v57, v224
  v_or3_b32 v225, v58, v59, v225
  s_waitcnt vmcnt(1)
  v_xor_b32 v60, v60, v20
  v_xor_b32 v61, v61, v21
  v_xor_b32 v62, v62, v22
  v_xor_b32 v63, v63, v23
  v_or3_b32 v224, v60, v61, v224
  v_or3_b32 v225, v62, v63, v225
  s_waitcnt vmcnt(0)
  v_xor_b32 v84, v84, v20
  v_xor_b32 v85, v85, v21
  v_xor_b32 v86, v86, v22
  v_xor_b32 v87, v87, v23
  v_or3_b32 v224, v84, v85, v224
  v_or3_b32 v225, v86, v87, v225
  s_add_u32 s32, s32, 1
  v_or_b32 v224, v224, v225
  v_and_b32 v224, 255, v224
  v_cmp_ne_u32 vcc, 0, v224
  s_nop 0
  s_cmp_eq_u64 vcc, 0
  s_cbranch_scc1 kg_x_ok
  s_cmp_lt_u32 s32, 100000
  s_cbranch_scc1 kg_x_again
kg_x_ok:
  v_pk_add_f32 v[36:37], v[36:37], v[80:81]
  v_pk_add_f32 v[38:39], v[38:39], v[82:83]
  v_pk_add_f32 v[36:37], v[36:37], v[216:217]
  v_pk_add_f32 v[38:39], v[38:39], v[216:217]
  v_pk_mul_f32 v[36:37], v[36:37], v[168:169]
  v_pk_mul_f32 v[38:39], v[38:39], v[170:171]
  v_cvt_pk_bf16_f32 v140, v36, v37
  v_cvt_pk_bf16_f32 v141, v38, v39
  v_pk_add_f32 v[64:65], v[64:65], v[84:85]
  v_pk_add_f32 v[66:67], v[66:67], v[86:87]
  v_pk_add_f32 v[64:65], v[64:65], v[220:221]
  v_pk_add_f32 v[66:67], v[66:67], v[220:221]
  v_pk_mul_f32 v[64:65], v[64:65], v[172:173]
  v_pk_mul_f32 v[66:67], v[66:67], v[174:175]
  v_cvt_pk_bf16_f32 v142, v64, v65
  v_cvt_pk_bf16_f32 v143, v66, v67
  v_pk_add_f32 v[48:49], v[48:49], v[32:33]
  v_pk_add_f32 v[50:51], v[50:51], v[34:35]
  v_pk_mul_f32 v[48:49], v[48:49], v[160:161]
  v_pk_mul_f32 v[50:51], v[50:51], v[162:163]
  v_cvt_pk_bf16_f32 v136, v48, v49
  v_cvt_pk_bf16_f32 v137, v50, v51
  s_cmp_eq_u32 s26, 0
  s_cselect_b64 vcc, 0, -1
  v_permlane32_swap_b32 v140, v142
  v_permlane32_swap_b32 v141, v143
  v_cndmask_b32 v140, v140, v142, vcc
  v_cndmask_b32 v141, v141, v143, vcc
  v_mov_b32 v142, v140
  v_mov_b32 v143, v141
  v_lshrrev_b32 v4, 5, v1
  v_mul_u32_u24 v4, 28672, v4
  v_lshl_add_u32 v4, v8, 4, v4
  v_permlane16_swap_b32 v140, v142
  v_permlane16_swap_b32 v141, v143
  s_mov_b32 exec_lo, 0xffff
  s_mov_b32 exec_hi, 0xffff
  buffer_store_dwordx4 v[140:143], v4, s[4:7], s35 offen offset:1536 sc1
  s_mov_b64 exec, -1
  v_pk_add_f32 v[76:77], v[76:77], v[60:61]
  v_pk_add_f32 v[78:79], v[78:79], v[62:63]
  v_pk_mul_f32 v[76:77], v[76:77], v[164:165]
  v_pk_mul_f32 v[78:79], v[78:79], v[166:167]
  v_cvt_pk_bf16_f32 v138, v76, v77
  v_cvt_pk_bf16_f32 v139, v78, v79
  v_pk_add_f32 v[40:41], v[40:41], v[24:25]
  v_pk_add_f32 v[42:43], v[42:43], v[26:27]
  v_pk_mul_f32 v[40:41], v[40:41], v[144:145]
  v_pk_mul_f32 v[42:43], v[42:43], v[146:147]
  v_cvt_pk_bf16_f32 v128, v40, v41
  v_cvt_pk_bf16_f32 v129, v42, v43
  v_permlane16_swap_b32 v136, v138
  v_permlane16_swap_b32 v137, v139
  buffer_store_dwordx4 v[136:139], v208, s[4:7], s35 offen offset:1024 sc1
  v_pk_add_f32 v[44:45], v[44:45], v[28:29]
  v_pk_add_f32 v[46:47], v[46:47], v[30:31]
  v_pk_mul_f32 v[44:45], v[44:45], v[148:149]
  v_pk_mul_f32 v[46:47], v[46:47], v[150:151]
  v_cvt_pk_bf16_f32 v130, v44, v45
  v_cvt_pk_bf16_f32 v131, v46, v47
  buffer_store_dwordx4 v[128:131], v2, s[4:7], s35 offen sc1
  s_add_u32 s35, s35, 28672
  v_pk_add_f32 v[68:69], v[68:69], v[52:53]
  v_pk_add_f32 v[70:71], v[70:71], v[54:55]
  v_pk_mul_f32 v[68:69], v[68:69], v[152:153]
  v_pk_mul_f32 v[70:71], v[70:71], v[154:155]
  v_cvt_pk_bf16_f32 v132, v68, v69
  v_cvt_pk_bf16_f32 v133, v70, v71
  v_pk_add_f32 v[72:73], v[72:73], v[56:57]
  v_pk_add_f32 v[74:75], v[74:75], v[58:59]
  v_pk_mul_f32 v[72:73], v[72:73], v[156:157]
  v_pk_mul_f32 v[74:75], v[74:75], v[158:159]
  v_cvt_pk_bf16_f32 v134, v72, v73
  v_cvt_pk_bf16_f32 v135, v74, v75
  buffer_store_dwordx4 v[132:135], v2, s[4:7], s35 offen sc1
  s_add_u32 m0, s21, 12288
  s_add_u32 s24, s21, 69632
  buffer_load_dwordx4 v2, s[40:43], s24 offen sc1 lds
  s_add_u32 m0, s21, 16384
  s_add_u32 s24, s21, 73728
  buffer_load_dwordx4 v2, s[40:43], s24 offen sc1 lds
  s_add_u32 m0, s21, 20480
  s_add_u32 s24, s21, 77824
  buffer_load_dwordx4 v2, s[40:43], s24 offen sc1 lds
  s_add_u32 m0, s21, 24576
  s_add_u32 s24, s21, 81920
  buffer_load_dwordx4 v2, s[40:43], s24 offen sc1 lds
  s_add_u32 m0, s21, 28672
  s_add_u32 s24, s21, 86016
  buffer_load_dwordx4 v2, s[40:43], s24 offen sc1 lds
  s_add_u32 m0, s21, 32768
  s_add_u32 s24, s21, 90112
  buffer_load_dwordx4 v2, s[40:43], s24 offen sc1 lds
  s_load_dwordx2 s[12:13], s[0:1], 96
  s_mov_b32 s14, 2621440
  s_mov_b32 s15, 0x20000
  s_waitcnt lgkmcnt(0)
  v_mov_b32 v20, 0
  v_lshlrev_b32 v21, 15, v1
  s_and_b32 s32, s16, 0
  s_lshr_b32 s16, s16, 0
  s_lshl_b32 s16, s16, 5
  s_add_u32 s16, s16, s32
  s_lshl2_add_u32 s16, s16, 2932736
  s_lshl_b32 s17, s17, 7
  s_add_u32 s17, s17, 2932736
  s_waitcnt vmcnt(6)
  s_barrier
  s_cmp_lg_u32 s20, 0
  s_cbranch_scc1 kg_u_sent
  s_mov_b64 exec, 1
  buffer_store_dword v20, v21, s[4:7], s16 offen sc0 sc1
  s_mov_b64 exec, -1
kg_u_sent:
  s_add_u32 m0, s21, 36864
  s_add_u32 s24, s21, 94208
  buffer_load_dwordx4 v2, s[40:43], s24 offen sc1 lds
  s_add_u32 m0, s21, 40960
  s_add_u32 s24, s21, 98304
  buffer_load_dwordx4 v2, s[40:43], s24 offen sc1 lds
  s_add_u32 m0, s21, 45056
  s_add_u32 s24, s21, 102400
  buffer_load_dwordx4 v2, s[40:43], s24 offen sc1 lds
  s_add_u32 m0, s21, 49152
  s_add_u32 s24, s21, 106496
  buffer_load_dwordx4 v2, s[40:43], s24 offen sc1 lds
  s_add_u32 m0, s21, 53248
  s_add_u32 s24, s21, 110592
  buffer_load_dwordx4 v2, s[40:43], s24 offen sc1 lds
  s_add_u32 m0, s21, 57344
  s_add_u32 s24, s21, 114688
  buffer_load_dwordx4 v2, s[40:43], s24 offen sc1 lds
  s_add_u32 m0, s21, 61440
  s_add_u32 s24, s21, 118784
  buffer_load_dwordx4 v2, s[40:43], s24 offen sc1 lds
  s_add_u32 m0, s21, 65536
  s_add_u32 s24, s21, 122880
  buffer_load_dwordx4 v2, s[40:43], s24 offen sc1 lds
  s_add_u32 m0, s21, 69632
  s_add_u32 s24, s21, 126976
  buffer_load_dwordx4 v2, s[40:43], s24 offen sc1 lds
  s_add_u32 m0, s21, 73728
  s_add_u32 s24, s21, 131072
  buffer_load_dwordx4 v2, s[40:43], s24 offen sc1 lds
  s_add_u32 m0, s21, 77824
  s_add_u32 s24, s21, 135168
  buffer_load_dwordx4 v2, s[40:43], s24 offen sc1 lds
  s_add_u32 m0, s21, 81920
  s_add_u32 s24, s21, 139264
  buffer_load_dwordx4 v2, s[40:43], s24 offen sc1 lds
  s_cmp_lg_u32 s20, 0
  s_cbranch_scc1 kg_u_ok
  v_and_b32 v5, 15, v0
  v_lshlrev_b32 v5, 7, v5
  s_mov_b32 exec_lo, 0xffff
  s_mov_b32 exec_hi, 0
  s_nop 1
  buffer_load_dword v20, v5, s[4:7], s17 offen sc0 sc1
  s_mov_b32 s32, 0
  s_waitcnt vmcnt(0)
  v_cmp_eq_u32 vcc, -1, v20
  s_nop 0
  s_cmp_eq_u64 vcc, 0
  s_cbranch_scc1 kg_u_ok
kg_u_again:
  s_sleep 2
  buffer_load_dword v20, v5, s[4:7], s17 offen sc0 sc1
  s_add_u32 s32, s32, 1
  s_waitcnt vmcnt(0)
  v_cmp_eq_u32 vcc, -1, v20
  s_nop 0
  s_cmp_eq_u64 vcc, 0
  s_cbranch_scc1 kg_u_ok
  s_cmp_lt_u32 s32, 100000
  s_cbranch_scc1 kg_u_again
kg_u_ok:
  s_mov_b64 exec, -1
  s_barrier
  buffer_load_dwordx4 a[0:3], v2, s[4:7], s39 offen offset:0 sc1
  buffer_load_dwordx4 a[4:7], v2, s[4:7], s39 offen offset:1024 sc1
  buffer_load_dwordx4 a[8:11], v2, s[4:7], s39 offen offset:2048 sc1
  buffer_load_dwordx4 a[12:15], v2, s[4:7], s39 offen offset:3072 sc1
  s_add_u32 s39, s39, 4096
  ds_read_b128 v[88:91], v6 offset:20480
  ds_read_b128 v[92:95], v6 offset:21504
  ds_read_b128 v[96:99], v6 offset:22528
  ds_read_b128 v[100:103], v6 offset:23552
  ds_read_b128 v[104:107], v6 offset:24576
  v_lshlrev_b32 v48, 16, v196
  v_and_b32 v49, 0xffff0000, v196
  v_lshlrev_b32 v50, 16, v197
  v_and_b32 v51, 0xffff0000, v197
  v_lshlrev_b32 v52, 16, v198
  v_and_b32 v53, 0xffff0000, v198
  v_lshlrev_b32 v54, 16, v199
  v_and_b32 v55, 0xffff0000, v199
  v_lshlrev_b32 v56, 16, v200
  v_and_b32 v57, 0xffff0000, v200
  v_lshlrev_b32 v58, 16, v201
  v_and_b32 v59, 0xffff0000, v201
  v_lshlrev_b32 v60, 16, v202
  v_and_b32 v61, 0xffff0000, v202
  v_lshlrev_b32 v62, 16, v203
  v_and_b32 v63, 0xffff0000, v203
  v_lshlrev_b32 v64, 16, v204
  v_and_b32 v65, 0xffff0000, v204
  v_lshlrev_b32 v66, 16, v205
  v_and_b32 v67, 0xffff0000, v205
  v_lshlrev_b32 v68, 16, v206
  v_and_b32 v69, 0xffff0000, v206
  v_lshlrev_b32 v70, 16, v207
  v_and_b32 v71, 0xffff0000, v207
  buffer_load_dwordx4 a[16:19], v2, s[4:7], s39 offen offset:0 sc1
  buffer_load_dwordx4 a[20:23], v2, s[4:7], s39 offen offset:1024 sc1
  buffer_load_dwordx4 a[24:27], v2, s[4:7], s39 offen offset:2048 sc1
  buffer_load_dwordx4 a[28:31], v2, s[4:7], s39 offen offset:3072 sc1
  s_add_u32 s39, s39, 4096
  s_waitcnt lgkmcnt(0)
  s_waitcnt vmcnt(7)
  v_mfma_f32_16x16x32_bf16 v[144:147], v[88:91], a[0:3], 0
  ds_read_b128 v[108:111], v6 offset:25600
  ds_read_b128 v[112:115], v6 offset:26624
  buffer_load_dwordx4 a[32:35], v2, s[4:7], s39 offen offset:0 sc1
  v_mfma_f32_16x16x32_bf16 v[148:151], v[92:95], a[0:3], 0
  ds_read_b128 v[116:119], v6 offset:27648
  ds_read_b128 v[120:123], v6 offset:28672
  v_mfma_f32_16x16x32_bf16 v[152:155], v[96:99], a[0:3], 0
  ds_read_b128 v[124:127], v6 offset:29696
  buffer_load_dwordx4 a[36:39], v2, s[4:7], s39 offen offset:1024 sc1
  v_mfma_f32_16x16x32_bf16 v[156:159], v[100:103], a[0:3], 0
  v_mfma_f32_16x16x32_bf16 v[160:163], v[104:107], a[0:3], 0
  buffer_load_dwordx4 a[40:43], v2, s[4:7], s39 offen offset:2048 sc1
  s_waitcnt lgkmcnt(0)
  s_waitcnt vmcnt(9)
  v_mfma_f32_16x16x32_bf16 v[144:147], v[108:111], a[4:7], v[144:147]
  ds_read_b128 v[88:91], v6 offset:30720
  ds_read_b128 v[92:95], v6 offset:31744
  buffer_load_dwordx4 a[44:47], v2, s[4:7], s39 offen offset:3072 sc1
  s_add_u32 s39, s39, 4096
  v_mfma_f32_16x16x32_bf16 v[148:151], v[112:115], a[4:7], v[148:151]
  ds_read_b128 v[96:99], v6 offset:32768
  ds_read_b128 v[100:103], v6 offset:33792
  v_mfma_f32_16x16x32_bf16 v[152:155], v[116:119], a[4:7], v[152:155]
  ds_read_b128 v[104:107], v6 offset:34816
  buffer_load_dwordx4 a[48:51], v2, s[4:7], s39 offen offset:0 sc1
  v_mfma_f32_16x16x32_bf16 v[156:159], v[120:123], a[4:7], v[156:159]
  v_mfma_f32_16x16x32_bf16 v[160:163], v[124:127], a[4:7], v[160:163]
  buffer_load_dwordx4 a[52:55], v2, s[4:7], s39 offen offset:1024 sc1
  s_waitcnt lgkmcnt(0)
  s_waitcnt vmcnt(11)
  v_mfma_f32_16x16x32_bf16 v[144:147], v[88:91], a[8:11], v[144:147]
  ds_read_b128 v[108:111], v6 offset:35840
  ds_read_b128 v[112:115], v6 offset:36864
  buffer_load_dwordx4 a[56:59], v2, s[4:7], s39 offen offset:2048 sc1
  v_mfma_f32_16x16x32_bf16 v[148:151], v[92:95], a[8:11], v[148:151]
  ds_read_b128 v[116:119], v6 offset:37888
  ds_read_b128 v[120:123], v6 offset:38912
  v_mfma_f32_16x16x32_bf16 v[152:155], v[96:99], a[8:11], v[152:155]
  ds_read_b128 v[124:127], v6 offset:39936
  buffer_load_dwordx4 a[60:63], v2, s[4:7], s39 offen offset:3072 sc1
  s_add_u32 s39, s39, 4096
  v_mfma_f32_16x16x32_bf16 v[156:159], v[100:103], a[8:11], v[156:159]
  v_mfma_f32_16x16x32_bf16 v[160:163], v[104:107], a[8:11], v[160:163]
  buffer_load_dwordx4 a[64:67], v2, s[4:7], s39 offen offset:0 sc1
  s_waitcnt lgkmcnt(0)
  s_waitcnt vmcnt(13)
  v_mfma_f32_16x16x32_bf16 v[144:147], v[108:111], a[12:15], v[144:147]
  ds_read_b128 v[88:91], v6 offset:40960
  ds_read_b128 v[92:95], v6 offset:41984
  buffer_load_dwordx4 a[68:71], v2, s[4:7], s39 offen offset:1024 sc1
  v_mfma_f32_16x16x32_bf16 v[148:151], v[112:115], a[12:15], v[148:151]
  ds_read_b128 v[96:99], v6 offset:43008
  ds_read_b128 v[100:103], v6 offset:44032
  v_mfma_f32_16x16x32_bf16 v[152:155], v[116:119], a[12:15], v[152:155]
  ds_read_b128 v[104:107], v6 offset:45056
  buffer_load_dwordx4 a[72:75], v2, s[4:7], s39 offen offset:2048 sc1
  v_mfma_f32_16x16x32_bf16 v[156:159], v[120:123], a[12:15], v[156:159]
  v_mfma_f32_16x16x32_bf16 v[160:163], v[124:127], a[12:15], v[160:163]
  buffer_load_dwordx4 a[76:79], v2, s[4:7], s39 offen offset:3072 sc1
  s_add_u32 s39, s39, 4096
  s_waitcnt lgkmcnt(0)
  s_waitcnt vmcnt(15)
  v_mfma_f32_16x16x32_bf16 v[144:147], v[88:91], a[16:19], v[144:147]
  ds_read_b128 v[108:111], v6 offset:46080
  ds_read_b128 v[112:115], v6 offset:47104
  buffer_load_dwordx4 a[80:83], v2, s[4:7], s39 offen offset:0 sc1
  v_mfma_f32_16x16x32_bf16 v[148:151], v[92:95], a[16:19], v[148:151]
  ds_read_b128 v[116:119], v6 offset:48128
  ds_read_b128 v[120:123], v6 offset:49152
  v_mfma_f32_16x16x32_bf16 v[152:155], v[96:99], a[16:19], v[152:155]
  ds_read_b128 v[124:127], v6 offset:50176
  buffer_load_dwordx4 a[84:87], v2, s[4:7], s39 offen offset:1024 sc1
  v_mfma_f32_16x16x32_bf16 v[156:159], v[100:103], a[16:19], v[156:159]
  v_mfma_f32_16x16x32_bf16 v[160:163], v[104:107], a[16:19], v[160:163]
  buffer_load_dwordx4 a[88:91], v2, s[4:7], s39 offen offset:2048 sc1
  s_waitcnt lgkmcnt(0)
  s_waitcnt vmcnt(17)
  v_mfma_f32_16x16x32_bf16 v[144:147], v[108:111], a[20:23], v[144:147]
  ds_read_b128 v[88:91], v6 offset:51200
  ds_read_b128 v[92:95], v6 offset:52224
  buffer_load_dwordx4 a[92:95], v2, s[4:7], s39 offen offset:3072 sc1
  s_add_u32 s39, s39, 4096
  v_mfma_f32_16x16x32_bf16 v[148:151], v[112:115], a[20:23], v[148:151]
  ds_read_b128 v[96:99], v6 offset:53248
  ds_read_b128 v[100:103], v6 offset:54272
  v_mfma_f32_16x16x32_bf16 v[152:155], v[116:119], a[20:23], v[152:155]
  ds_read_b128 v[104:107], v6 offset:55296
  buffer_load_dwordx4 a[96:99], v2, s[4:7], s39 offen offset:0 sc1
  v_mfma_f32_16x16x32_bf16 v[156:159], v[120:123], a[20:23], v[156:159]
  v_mfma_f32_16x16x32_bf16 v[160:163], v[124:127], a[20:23], v[160:163]
  buffer_load_dwordx4 a[100:103], v2, s[4:7], s39 offen offset:1024 sc1
  s_waitcnt lgkmcnt(0)
  s_waitcnt vmcnt(19)
  v_mfma_f32_16x16x32_bf16 v[144:147], v[88:91], a[24:27], v[144:147]
  ds_read_b128 v[108:111], v6 offset:56320
  ds_read_b128 v[112:115], v6 offset:57344
  v_mfma_f32_16x16x32_bf16 v[148:151], v[92:95], a[24:27], v[148:151]
  ds_read_b128 v[116:119], v6 offset:58368
  ds_read_b128 v[120:123], v6 offset:59392
  buffer_load_dwordx4 a[104:107], v2, s[4:7], s39 offen offset:2048 sc1
  v_mfma_f32_16x16x32_bf16 v[152:155], v[96:99], a[24:27], v[152:155]
  ds_read_b128 v[124:127], v6 offset:60416
  v_mfma_f32_16x16x32_bf16 v[156:159], v[100:103], a[24:27], v[156:159]
  buffer_load_dwordx4 a[108:111], v2, s[4:7], s39 offen offset:3072 sc1
  s_add_u32 s39, s39, 4096
  v_mfma_f32_16x16x32_bf16 v[160:163], v[104:107], a[24:27], v[160:163]
  s_waitcnt lgkmcnt(0)
  s_waitcnt vmcnt(20)
  v_mfma_f32_16x16x32_bf16 v[144:147], v[108:111], a[28:31], v[144:147]
  ds_read_b128 v[88:91], v6 offset:61440
  ds_read_b128 v[92:95], v6 offset:62464
  v_mfma_f32_16x16x32_bf16 v[148:151], v[112:115], a[28:31], v[148:151]
  ds_read_b128 v[96:99], v6 offset:63488
  ds_read_b128 v[100:103], v6 offset:64512
  v_mfma_f32_16x16x32_bf16 v[152:155], v[116:119], a[28:31], v[152:155]
  ds_read_b128 v[104:107], v7 offset:0
  v_mfma_f32_16x16x32_bf16 v[156:159], v[120:123], a[28:31], v[156:159]
  v_mfma_f32_16x16x32_bf16 v[160:163], v[124:127], a[28:31], v[160:163]
  s_waitcnt lgkmcnt(0)
  s_waitcnt vmcnt(19)
  v_mfma_f32_16x16x32_bf16 v[144:147], v[88:91], a[32:35], v[144:147]
  ds_read_b128 v[108:111], v7 offset:1024
  ds_read_b128 v[112:115], v7 offset:2048
  v_mfma_f32_16x16x32_bf16 v[148:151], v[92:95], a[32:35], v[148:151]
  ds_read_b128 v[116:119], v7 offset:3072
  ds_read_b128 v[120:123], v7 offset:4096
  v_mfma_f32_16x16x32_bf16 v[152:155], v[96:99], a[32:35], v[152:155]
  ds_read_b128 v[124:127], v7 offset:5120
  v_mfma_f32_16x16x32_bf16 v[156:159], v[100:103], a[32:35], v[156:159]
  v_mfma_f32_16x16x32_bf16 v[160:163], v[104:107], a[32:35], v[160:163]
  s_barrier
  s_waitcnt lgkmcnt(0)
  s_waitcnt vmcnt(18)
  v_mfma_f32_16x16x32_bf16 v[144:147], v[108:111], a[36:39], v[144:147]
  ds_read_b128 v[88:91], v7 offset:6144
  ds_read_b128 v[92:95], v7 offset:7168
  v_mfma_f32_16x16x32_bf16 v[148:151], v[112:115], a[36:39], v[148:151]
  ds_read_b128 v[96:99], v7 offset:8192
  ds_read_b128 v[100:103], v7 offset:9216
  v_mfma_f32_16x16x32_bf16 v[152:155], v[116:119], a[36:39], v[152:155]
  ds_read_b128 v[104:107], v7 offset:10240
  v_mfma_f32_16x16x32_bf16 v[156:159], v[120:123], a[36:39], v[156:159]
  v_mfma_f32_16x16x32_bf16 v[160:163], v[124:127], a[36:39], v[160:163]
  s_waitcnt lgkmcnt(0)
  s_waitcnt vmcnt(17)
  v_mfma_f32_16x16x32_bf16 v[144:147], v[88:91], a[40:43], v[144:147]
  ds_read_b128 v[108:111], v7 offset:11264
  ds_read_b128 v[112:115], v2 offset:0
  v_mfma_f32_16x16x32_bf16 v[148:151], v[92:95], a[40:43], v[148:151]
  ds_read_b128 v[116:119], v2 offset:1024
  ds_read_b128 v[120:123], v2 offset:2048
  v_mfma_f32_16x16x32_bf16 v[152:155], v[96:99], a[40:43], v[152:155]
  ds_read_b128 v[124:127], v2 offset:3072
  v_mfma_f32_16x16x32_bf16 v[156:159], v[100:103], a[40:43], v[156:159]
  v_mfma_f32_16x16x32_bf16 v[160:163], v[104:107], a[40:43], v[160:163]
  s_waitcnt lgkmcnt(0)
  s_waitcnt vmcnt(16)
  v_mfma_f32_16x16x32_bf16 v[144:147], v[108:111], a[44:47], v[144:147]
  ds_read_b128 v[88:91], v2 offset:4096
  ds_read_b128 v[92:95], v2 offset:5120
  v_mfma_f32_16x16x32_bf16 v[148:151], v[112:115], a[44:47], v[148:151]
  ds_read_b128 v[96:99], v2 offset:6144
  ds_read_b128 v[100:103], v2 offset:7168
  v_mfma_f32_16x16x32_bf16 v[152:155], v[116:119], a[44:47], v[152:155]
  ds_read_b128 v[104:107], v2 offset:8192
  v_mfma_f32_16x16x32_bf16 v[156:159], v[120:123], a[44:47], v[156:159]
  v_mfma_f32_16x16x32_bf16 v[160:163], v[124:127], a[44:47], v[160:163]
  s_waitcnt lgkmcnt(0)
  s_waitcnt vmcnt(15)
  v_mfma_f32_16x16x32_bf16 v[144:147], v[88:91], a[48:51], v[144:147]
  ds_read_b128 v[108:111], v2 offset:9216
  ds_read_b128 v[112:115], v2 offset:10240
  v_mfma_f32_16x16x32_bf16 v[148:151], v[92:95], a[48:51], v[148:151]
  ds_read_b128 v[116:119], v2 offset:11264
  ds_read_b128 v[120:123], v2 offset:12288
  v_mfma_f32_16x16x32_bf16 v[152:155], v[96:99], a[48:51], v[152:155]
  ds_read_b128 v[124:127], v2 offset:13312
  v_mfma_f32_16x16x32_bf16 v[156:159], v[100:103], a[48:51], v[156:159]
  v_mfma_f32_16x16x32_bf16 v[160:163], v[104:107], a[48:51], v[160:163]
  s_waitcnt lgkmcnt(0)
  s_waitcnt vmcnt(14)
  v_mfma_f32_16x16x32_bf16 v[144:147], v[108:111], a[52:55], v[144:147]
  ds_read_b128 v[88:91], v2 offset:14336
  ds_read_b128 v[92:95], v2 offset:15360
  v_mfma_f32_16x16x32_bf16 v[148:151], v[112:115], a[52:55], v[148:151]
  ds_read_b128 v[96:99], v2 offset:16384
  ds_read_b128 v[100:103], v2 offset:17408
  v_mfma_f32_16x16x32_bf16 v[152:155], v[116:119], a[52:55], v[152:155]
  ds_read_b128 v[104:107], v2 offset:18432
  v_mfma_f32_16x16x32_bf16 v[156:159], v[120:123], a[52:55], v[156:159]
  v_mfma_f32_16x16x32_bf16 v[160:163], v[124:127], a[52:55], v[160:163]
  s_waitcnt lgkmcnt(0)
  s_waitcnt vmcnt(13)
  v_mfma_f32_16x16x32_bf16 v[144:147], v[88:91], a[56:59], v[144:147]
  ds_read_b128 v[108:111], v2 offset:19456
  ds_read_b128 v[112:115], v2 offset:20480
  v_mfma_f32_16x16x32_bf16 v[148:151], v[92:95], a[56:59], v[148:151]
  ds_read_b128 v[116:119], v2 offset:21504
  ds_read_b128 v[120:123], v2 offset:22528
  v_mfma_f32_16x16x32_bf16 v[152:155], v[96:99], a[56:59], v[152:155]
  ds_read_b128 v[124:127], v2 offset:23552
  v_mfma_f32_16x16x32_bf16 v[156:159], v[100:103], a[56:59], v[156:159]
  v_mfma_f32_16x16x32_bf16 v[160:163], v[104:107], a[56:59], v[160:163]
  s_waitcnt lgkmcnt(0)
  s_waitcnt vmcnt(12)
  v_mfma_f32_16x16x32_bf16 v[144:147], v[108:111], a[60:63], v[144:147]
  ds_read_b128 v[88:91], v2 offset:24576
  ds_read_b128 v[92:95], v2 offset:25600
  v_mfma_f32_16x16x32_bf16 v[148:151], v[112:115], a[60:63], v[148:151]
  ds_read_b128 v[96:99], v2 offset:26624
  ds_read_b128 v[100:103], v2 offset:27648
  v_mfma_f32_16x16x32_bf16 v[152:155], v[116:119], a[60:63], v[152:155]
  ds_read_b128 v[104:107], v2 offset:28672
  v_mfma_f32_16x16x32_bf16 v[156:159], v[120:123], a[60:63], v[156:159]
  v_mfma_f32_16x16x32_bf16 v[160:163], v[124:127], a[60:63], v[160:163]
  s_waitcnt lgkmcnt(0)
  s_waitcnt vmcnt(11)
  v_mfma_f32_16x16x32_bf16 v[144:147], v[88:91], a[64:67], v[144:147]
  ds_read_b128 v[108:111], v2 offset:29696
  ds_read_b128 v[112:115], v2 offset:30720
  v_mfma_f32_16x16x32_bf16 v[148:151], v[92:95], a[64:67], v[148:151]
  ds_read_b128 v[116:119], v2 offset:31744
  ds_read_b128 v[120:123], v2 offset:32768
  v_mfma_f32_16x16x32_bf16 v[152:155], v[96:99], a[64:67], v[152:155]
  ds_read_b128 v[124:127], v2 offset:33792
  v_mfma_f32_16x16x32_bf16 v[156:159], v[100:103], a[64:67], v[156:159]
  v_mfma_f32_16x16x32_bf16 v[160:163], v[104:107], a[64:67], v[160:163]
  s_waitcnt lgkmcnt(0)
  s_waitcnt vmcnt(10)
  v_mfma_f32_16x16x32_bf16 v[144:147], v[108:111], a[68:71], v[144:147]
  ds_read_b128 v[88:91], v2 offset:34816
  ds_read_b128 v[92:95], v2 offset:35840
  v_mfma_f32_16x16x32_bf16 v[148:151], v[112:115], a[68:71], v[148:151]
  ds_read_b128 v[96:99], v2 offset:36864
  ds_read_b128 v[100:103], v2 offset:37888
  v_mfma_f32_16x16x32_bf16 v[152:155], v[116:119], a[68:71], v[152:155]
  ds_read_b128 v[104:107], v2 offset:38912
  v_mfma_f32_16x16x32_bf16 v[156:159], v[120:123], a[68:71], v[156:159]
  v_mfma_f32_16x16x32_bf16 v[160:163], v[124:127], a[68:71], v[160:163]
  s_waitcnt lgkmcnt(0)
  s_waitcnt vmcnt(9)
  v_mfma_f32_16x16x32_bf16 v[144:147], v[88:91], a[72:75], v[144:147]
  ds_read_b128 v[108:111], v2 offset:39936
  ds_read_b128 v[112:115], v2 offset:40960
  v_mfma_f32_16x16x32_bf16 v[148:151], v[92:95], a[72:75], v[148:151]
  ds_read_b128 v[116:119], v2 offset:41984
  ds_read_b128 v[120:123], v2 offset:43008
  v_mfma_f32_16x16x32_bf16 v[152:155], v[96:99], a[72:75], v[152:155]
  ds_read_b128 v[124:127], v2 offset:44032
  v_mfma_f32_16x16x32_bf16 v[156:159], v[100:103], a[72:75], v[156:159]
  v_mfma_f32_16x16x32_bf16 v[160:163], v[104:107], a[72:75], v[160:163]
  s_waitcnt lgkmcnt(0)
  s_waitcnt vmcnt(8)
  v_mfma_f32_16x16x32_bf16 v[144:147], v[108:111], a[76:79], v[144:147]
  ds_read_b128 v[88:91], v2 offset:45056
  ds_read_b128 v[92:95], v2 offset:46080
  v_mfma_f32_16x16x32_bf16 v[148:151], v[112:115], a[76:79], v[148:151]
  ds_read_b128 v[96:99], v2 offset:47104
  ds_read_b128 v[100:103], v2 offset:48128
  v_mfma_f32_16x16x32_bf16 v[152:155], v[116:119], a[76:79], v[152:155]
  ds_read_b128 v[104:107], v2 offset:49152
  v_mfma_f32_16x16x32_bf16 v[156:159], v[120:123], a[76:79], v[156:159]
  v_mfma_f32_16x16x32_bf16 v[160:163], v[124:127], a[76:79], v[160:163]
  s_waitcnt lgkmcnt(0)
  s_waitcnt vmcnt(7)
  v_mfma_f32_16x16x32_bf16 v[144:147], v[88:91], a[80:83], v[144:147]
  ds_read_b128 v[108:111], v2 offset:50176
  ds_read_b128 v[112:115], v2 offset:51200
  v_mfma_f32_16x16x32_bf16 v[148:151], v[92:95], a[80:83], v[148:151]
  ds_read_b128 v[116:119], v2 offset:52224
  ds_read_b128 v[120:123], v2 offset:53248
  v_mfma_f32_16x16x32_bf16 v[152:155], v[96:99], a[80:83], v[152:155]
  ds_read_b128 v[124:127], v2 offset:54272
  v_mfma_f32_16x16x32_bf16 v[156:159], v[100:103], a[80:83], v[156:159]
  v_mfma_f32_16x16x32_bf16 v[160:163], v[104:107], a[80:83], v[160:163]
  s_waitcnt lgkmcnt(0)
  s_waitcnt vmcnt(6)
  v_mfma_f32_16x16x32_bf16 v[144:147], v[108:111], a[84:87], v[144:147]
  ds_read_b128 v[88:91], v2 offset:55296
  ds_read_b128 v[92:95], v2 offset:56320
  v_mfma_f32_16x16x32_bf16 v[148:151], v[112:115], a[84:87], v[148:151]
  ds_read_b128 v[96:99], v2 offset:57344
  ds_read_b128 v[100:103], v2 offset:58368
  v_mfma_f32_16x16x32_bf16 v[152:155], v[116:119], a[84:87], v[152:155]
  ds_read_b128 v[104:107], v2 offset:59392
  v_mfma_f32_16x16x32_bf16 v[156:159], v[120:123], a[84:87], v[156:159]
  v_mfma_f32_16x16x32_bf16 v[160:163], v[124:127], a[84:87], v[160:163]
  s_waitcnt lgkmcnt(0)
  s_waitcnt vmcnt(5)
  v_mfma_f32_16x16x32_bf16 v[144:147], v[88:91], a[88:91], v[144:147]
  ds_read_b128 v[108:111], v2 offset:60416
  ds_read_b128 v[112:115], v2 offset:61440
  v_mfma_f32_16x16x32_bf16 v[148:151], v[92:95], a[88:91], v[148:151]
  ds_read_b128 v[116:119], v2 offset:62464
  ds_read_b128 v[120:123], v2 offset:63488
  v_mfma_f32_16x16x32_bf16 v[152:155], v[96:99], a[88:91], v[152:155]
  ds_read_b128 v[124:127], v2 offset:64512
  v_mfma_f32_16x16x32_bf16 v[156:159], v[100:103], a[88:91], v[156:159]
  v_mfma_f32_16x16x32_bf16 v[160:163], v[104:107], a[88:91], v[160:163]
  s_waitcnt lgkmcnt(0)
  s_waitcnt vmcnt(4)
  v_mfma_f32_16x16x32_bf16 v[144:147], v[108:111], a[92:95], v[144:147]
  ds_read_b128 v[88:91], v6 offset:0
  ds_read_b128 v[92:95], v6 offset:1024
  v_mfma_f32_16x16x32_bf16 v[148:151], v[112:115], a[92:95], v[148:151]
  ds_read_b128 v[96:99], v6 offset:2048
  ds_read_b128 v[100:103], v6 offset:3072
  v_mfma_f32_16x16x32_bf16 v[152:155], v[116:119], a[92:95], v[152:155]
  ds_read_b128 v[104:107], v6 offset:4096
  v_mfma_f32_16x16x32_bf16 v[156:159], v[120:123], a[92:95], v[156:159]
  v_mfma_f32_16x16x32_bf16 v[160:163], v[124:127], a[92:95], v[160:163]
  s_waitcnt lgkmcnt(0)
  s_waitcnt vmcnt(3)
  v_mfma_f32_16x16x32_bf16 v[144:147], v[88:91], a[96:99], v[144:147]
  ds_read_b128 v[108:111], v6 offset:5120
  ds_read_b128 v[112:115], v6 offset:6144
  v_mfma_f32_16x16x32_bf16 v[148:151], v[92:95], a[96:99], v[148:151]
  ds_read_b128 v[116:119], v6 offset:7168
  ds_read_b128 v[120:123], v6 offset:8192
  v_mfma_f32_16x16x32_bf16 v[152:155], v[96:99], a[96:99], v[152:155]
  ds_read_b128 v[124:127], v6 offset:9216
  v_mfma_f32_16x16x32_bf16 v[156:159], v[100:103], a[96:99], v[156:159]
  v_mfma_f32_16x16x32_bf16 v[160:163], v[104:107], a[96:99], v[160:163]
  s_waitcnt lgkmcnt(0)
  s_waitcnt vmcnt(2)
  v_mfma_f32_16x16x32_bf16 v[144:147], v[108:111], a[100:103], v[144:147]
  ds_read_b128 v[88:91], v6 offset:10240
  ds_read_b128 v[92:95], v6 offset:11264
  v_mfma_f32_16x16x32_bf16 v[148:151], v[112:115], a[100:103], v[148:151]
  ds_read_b128 v[96:99], v6 offset:12288
  ds_read_b128 v[100:103], v6 offset:13312
  v_mfma_f32_16x16x32_bf16 v[152:155], v[116:119], a[100:103], v[152:155]
  ds_read_b128 v[104:107], v6 offset:14336
  v_mfma_f32_16x16x32_bf16 v[156:159], v[120:123], a[100:103], v[156:159]
  v_mfma_f32_16x16x32_bf16 v[160:163], v[124:127], a[100:103], v[160:163]
  s_waitcnt lgkmcnt(0)
  s_waitcnt vmcnt(1)
  v_mfma_f32_16x16x32_bf16 v[144:147], v[88:91], a[104:107], v[144:147]
  ds_read_b128 v[108:111], v6 offset:15360
  ds_read_b128 v[112:115], v6 offset:16384
  v_mfma_f32_16x16x32_bf16 v[148:151], v[92:95], a[104:107], v[148:151]
  ds_read_b128 v[116:119], v6 offset:17408
  ds_read_b128 v[120:123], v6 offset:18432
  v_mfma_f32_16x16x32_bf16 v[152:155], v[96:99], a[104:107], v[152:155]
  ds_read_b128 v[124:127], v6 offset:19456
  v_mfma_f32_16x16x32_bf16 v[156:159], v[100:103], a[104:107], v[156:159]
  v_mfma_f32_16x16x32_bf16 v[160:163], v[104:107], a[104:107], v[160:163]
  s_waitcnt lgkmcnt(0)
  s_waitcnt vmcnt(0)
  v_mfma_f32_16x16x32_bf16 v[144:147], v[108:111], a[108:111], v[144:147]
  v_mfma_f32_16x16x32_bf16 v[148:151], v[112:115], a[108:111], v[148:151]
  v_mfma_f32_16x16x32_bf16 v[152:155], v[116:119], a[108:111], v[152:155]
  v_mfma_f32_16x16x32_bf16 v[156:159], v[120:123], a[108:111], v[156:159]
  v_mfma_f32_16x16x32_bf16 v[160:163], v[124:127], a[108:111], v[160:163]
  s_nop 3
  ds_write_b128 v209, v[144:147] offset:0
  ds_write_b128 v209, v[148:151] offset:64
  ds_write_b128 v209, v[152:155] offset:128
  ds_write_b128 v209, v[156:159] offset:192
  ds_write_b128 v209, v[160:163] offset:256
  ds_read_b128 v[24:27], v210 offset:0
  ds_read_b128 v[28:31], v210 offset:16
  ds_read_b128 v[32:35], v210 offset:2016
  ds_read_b128 v[36:39], v210 offset:2032
  ds_read_b128 v[40:43], v210 offset:4032
  ds_read_b128 v[44:47], v210 offset:4048
  s_waitcnt lgkmcnt(5)
  v_pk_fma_f32 v[24:25], v[24:25], v[188:189], v[48:49]
  v_pk_fma_f32 v[26:27], v[26:27], v[190:191], v[50:51]
  s_waitcnt lgkmcnt(4)
  v_pk_fma_f32 v[28:29], v[28:29], v[192:193], v[52:53]
  v_pk_fma_f32 v[30:31], v[30:31], v[194:195], v[54:55]
  v_cvt_pk_bf16_f32 v196, v24, v25
  v_cvt_pk_bf16_f32 v197, v26, v27
  v_cvt_pk_bf16_f32 v198, v28, v29
  v_cvt_pk_bf16_f32 v199, v30, v31
  buffer_store_dwordx4 v[196:199], v211, s[12:15], s37 offen sc1
  s_add_u32 s37, s37, 7680
  s_waitcnt lgkmcnt(3)
  v_pk_fma_f32 v[32:33], v[32:33], v[188:189], v[56:57]
  v_pk_fma_f32 v[34:35], v[34:35], v[190:191], v[58:59]
  s_waitcnt lgkmcnt(2)
  v_pk_fma_f32 v[36:37], v[36:37], v[192:193], v[60:61]
  v_pk_fma_f32 v[38:39], v[38:39], v[194:195], v[62:63]
  v_cvt_pk_bf16_f32 v200, v32, v33
  v_cvt_pk_bf16_f32 v201, v34, v35
  v_cvt_pk_bf16_f32 v202, v36, v37
  v_cvt_pk_bf16_f32 v203, v38, v39
  buffer_store_dwordx4 v[200:203], v211, s[12:15], s37 offen sc1
  s_add_u32 s37, s37, 7680
  s_waitcnt lgkmcnt(1)
  v_pk_fma_f32 v[40:41], v[40:41], v[188:189], v[64:65]
  v_pk_fma_f32 v[42:43], v[42:43], v[190:191], v[66:67]
  s_waitcnt lgkmcnt(0)
  v_pk_fma_f32 v[44:45], v[44:45], v[192:193], v[68:69]
  v_pk_fma_f32 v[46:47], v[46:47], v[194:195], v[70:71]
  v_cvt_pk_bf16_f32 v204, v40, v41
  v_cvt_pk_bf16_f32 v205, v42, v43
  v_cvt_pk_bf16_f32 v206, v44, v45
  v_cvt_pk_bf16_f32 v207, v46, v47
  buffer_store_dwordx4 v[204:207], v212, s[12:15], s37 offen sc1
  s_endpgm
kg_done:
  s_endpgm
.p2align 8
.type ctab,@object
ctab:
.long 0x3f803f80,0x3f803f80,0x3f803f80,0x3f803f80,0x0,0x0,0x0,0x0
.long 0x3f733f80,0x3f163f4f,0x3f163e9e,0x3f733f4f,0xbe9e0000,0xbf4fbf16,0x3f4f3f73,0x3e9e3f16
.long 0x3f4f3f80,0xbe9e3e9e,0xbe9ebf4f,0x3f4f3e9e,0xbf160000,0xbf73bf73,0x3f733f16,0x3f163f73
.long 0x3f163f80,0xbf73be9e,0xbf73bf4f,0x3f16be9e,0xbf4f0000,0xbe9ebf73,0x3e9ebf16,0x3f4f3f73
.long 0x3e9e3f80,0xbf4fbf4f,0xbf4f3e9e,0x3e9ebf4f,0xbf730000,0x3f16bf16,0xbf16bf73,0x3f733f16
.long 0x3f80,0xbf80,0x3f80,0xbf80,0xbf800000,0x3f800000,0xbf800000,0x3f800000
.long 0xbe9e3f80,0x3f4fbf4f,0x3f4f3e9e,0xbe9ebf4f,0xbf730000,0x3f163f16,0xbf163f73,0x3f73bf16
.long 0xbf163f80,0x3f73be9e,0x3f73bf4f,0xbf16be9e,0xbf4f0000,0xbe9e3f73,0x3e9e3f16,0x3f4fbf73
.long 0x3f803f80,0x3f803f80,0x0,0x0,0x0,0x0,0x0,0x0
.long 0x3e9e,0xbf16be9e,0x0,0x0,0xbf80bf73,0xbf4fbf73,0x0,0x0
.long 0xbf80bf4f,0xbe9ebf4f,0x0,0x0,0xbf16,0x3f733f16,0x0,0x0
.long 0xbf4f,0x3f733f4f,0x0,0x0,0x3f803f16,0xbe9e3f16,0x0,0x0
.long 0x3f803e9e,0xbf4f3e9e,0x0,0x0,0x3f73,0xbf16bf73,0x0,0x0
.long 0x3f80,0xbf80,0x0,0x0,0xbf800000,0x3f800000,0x0,0x0
.long 0xbf803e9e,0x3f4f3e9e,0x0,0x0,0xbf73,0xbf163f73,0x0,0x0
.long 0xbf4f,0xbf733f4f,0x0,0x0,0x3f80bf16,0xbe9ebf16,0x0,0x0
.long 0x3f803f80,0x3f803f80,0x0,0x0,0x0,0x0,0x0,0x0
.long 0xbf73bf4f,0xbf73bf80,0x0,0x0,0xbe9ebf16,0x3e9e0000,0x0,0x0
.long 0x3f4f3e9e,0x3f4f3f80,0x0,0x0,0x3f163f73,0xbf160000,0x0,0x0
.long 0xbf163e9e,0xbf16bf80,0x0,0x0,0xbf4fbf73,0x3f4f0000,0x0,0x0
.long 0x3e9ebf4f,0x3e9e3f80,0x0,0x0,0x3f733f16,0xbf730000,0x0,0x0
.long 0x3f80,0xbf80,0x0,0x0,0xbf800000,0x3f800000,0x0,0x0
.long 0xbe9ebf4f,0xbe9e3f80,0x0,0x0,0x3f73bf16,0xbf730000,0x0,0x0
.long 0x3f163e9e,0x3f16bf80,0x0,0x0,0xbf4f3f73,0x3f4f0000,0x0,0x0
.long 0x3f803f80,0x3f803f80,0x0,0x0,0x0,0x0,0x0,0x0
.long 0xbf16bf4f,0xbe9e,0x0,0x0,0x3f4f3f16,0x3f803f73,0x0,0x0
.long 0xbe9e3e9e,0xbf80bf4f,0x0,0x0,0xbf73bf73,0xbf16,0x0,0x0
.long 0x3f733e9e,0x3f4f,0x0,0x0,0x3e9e3f73,0xbf80bf16,0x0,0x0
.long 0xbf4fbf4f,0x3f803e9e,0x0,0x0,0x3f16bf16,0x3f73,0x0,0x0
.long 0x3f80,0xbf80,0x0,0x0,0xbf800000,0x3f800000,0x0,0x0
.long 0x3f4fbf4f,0xbf803e9e,0x0,0x0,0x3f163f16,0xbf73,0x0,0x0
.long 0xbf733e9e,0x3f4f,0x0,0x0,0x3e9ebf73,0xbf803f16,0x0,0x0
.long 0x0,0x0,0x0,0x0,0x3f803f80,0x3f803f80,0x3f803f80,0x3f803f80
.long 0x3e9e0000,0x3f4f3f16,0xbf4fbf73,0xbe9ebf16,0x3f733f80,0x3f163f4f,0x3f163e9e,0x3f733f4f
.long 0x3f160000,0x3f733f73,0xbf73bf16,0xbf16bf73,0x3f4f3f80,0xbe9e3e9e,0xbe9ebf4f,0x3f4f3e9e
.long 0x3f4f0000,0x3e9e3f73,0xbe9e3f16,0xbf4fbf73,0x3f163f80,0xbf73be9e,0xbf73bf4f,0x3f16be9e
.long 0x3f730000,0xbf163f16,0x3f163f73,0xbf73bf16,0x3e9e3f80,0xbf4fbf4f,0xbf4f3e9e,0x3e9ebf4f
.long 0x3f800000,0xbf800000,0x3f800000,0xbf800000,0x3f80,0xbf80,0x3f80,0xbf80
.long 0x3f730000,0xbf16bf16,0x3f16bf73,0xbf733f16,0xbe9e3f80,0x3f4fbf4f,0x3f4f3e9e,0xbe9ebf4f
.long 0x3f4f0000,0x3e9ebf73,0xbe9ebf16,0xbf4f3f73,0xbf163f80,0x3f73be9e,0x3f73bf4f,0xbf16be9e
.long 0x0,0x0,0x0,0x0,0x3f803f80,0x3f803f80,0x0,0x0
.long 0x3f803f73,0x3f4f3f73,0x0,0x0,0x3e9e,0xbf16be9e,0x0,0x0
.long 0x3f16,0xbf73bf16,0x0,0x0,0xbf80bf4f,0xbe9ebf4f,0x0,0x0
.long 0xbf80bf16,0x3e9ebf16,0x0,0x0,0xbf4f,0x3f733f4f,0x0,0x0
.long 0xbf73,0x3f163f73,0x0,0x0,0x3f803e9e,0xbf4f3e9e,0x0,0x0
.long 0x3f800000,0xbf800000,0x0,0x0,0x3f80,0xbf80,0x0,0x0
.long 0x3f73,0x3f16bf73,0x0,0x0,0xbf803e9e,0x3f4f3e9e,0x0,0x0
.long 0xbf803f16,0x3e9e3f16,0x0,0x0,0xbf4f,0xbf733f4f,0x0,0x0
.long 0x0,0x0,0x0,0x0,0x3f803f80,0x3f803f80,0x0,0x0
.long 0x3e9e3f16,0xbe9e0000,0x0,0x0,0xbf73bf4f,0xbf73bf80,0x0,0x0
.long 0xbf16bf73,0x3f160000,0x0,0x0,0x3f4f3e9e,0x3f4f3f80,0x0,0x0
.long 0x3f4f3f73,0xbf4f0000,0x0,0x0,0xbf163e9e,0xbf16bf80,0x0,0x0
.long 0xbf73bf16,0x3f730000,0x0,0x0,0x3e9ebf4f,0x3e9e3f80,0x0,0x0
.long 0x3f800000,0xbf800000,0x0,0x0,0x3f80,0xbf80,0x0,0x0
.long 0xbf733f16,0x3f730000,0x0,0x0,0xbe9ebf4f,0xbe9e3f80,0x0,0x0
.long 0x3f4fbf73,0xbf4f0000,0x0,0x0,0x3f163e9e,0x3f16bf80,0x0,0x0
.long 0x0,0x0,0x0,0x0,0x3f803f80,0x3f803f80,0x0,0x0
.long 0xbf4fbf16,0xbf80bf73,0x0,0x0,0xbf16bf4f,0xbe9e,0x0,0x0
.long 0x3f733f73,0x3f16,0x0,0x0,0xbe9e3e9e,0xbf80bf4f,0x0,0x0
.long 0xbe9ebf73,0x3f803f16,0x0,0x0,0x3f733e9e,0x3f4f,0x0,0x0
.long 0xbf163f16,0xbf73,0x0,0x0,0xbf4fbf4f,0x3f803e9e,0x0,0x0
.long 0x3f800000,0xbf800000,0x0,0x0,0x3f80,0xbf80,0x0,0x0
.long 0xbf16bf16,0x3f73,0x0,0x0,0x3f4fbf4f,0xbf803e9e,0x0,0x0
.long 0xbe9e3f73,0x3f80bf16,0x0,0x0,0xbf733e9e,0x3f4f,0x0,0x0
.long 0xbf4f3f80,0x3e9e3e9e,0x3e9ebf4f,0xbf4f3e9e,0xbf160000,0xbf733f73,0x3f73bf16,0x3f16bf73
.long 0xbf733f80,0xbf163f4f,0xbf163e9e,0xbf733f4f,0xbe9e0000,0xbf4f3f16,0x3f4fbf73,0x3e9ebf16
.long 0xbf803f80,0xbf803f80,0xbf803f80,0xbf803f80,0x0,0x0,0x0,0x0
.long 0xbf733f80,0xbf163f4f,0xbf163e9e,0xbf733f4f,0x3e9e0000,0x3f4fbf16,0xbf4f3f73,0xbe9e3f16
.long 0xbf4f3f80,0x3e9e3e9e,0x3e9ebf4f,0xbf4f3e9e,0x3f160000,0x3f73bf73,0xbf733f16,0xbf163f73
.long 0xbf163f80,0x3f73be9e,0x3f73bf4f,0xbf16be9e,0x3f4f0000,0x3e9ebf73,0xbe9ebf16,0xbf4f3f73
.long 0xbe9e3f80,0x3f4fbf4f,0x3f4f3e9e,0xbe9ebf4f,0x3f730000,0xbf16bf16,0x3f16bf73,0xbf733f16
.long 0x3f80,0xbf80,0x3f80,0xbf80,0x3f800000,0xbf800000,0x3f800000,0xbf800000
.long 0x3f80bf4f,0x3e9ebf4f,0x0,0x0,0x3f16,0x3f73bf16,0x0,0x0
.long 0x3e9e,0x3f16be9e,0x0,0x0,0xbf803f73,0xbf4f3f73,0x0,0x0
.long 0xbf803f80,0xbf803f80,0x0,0x0,0x0,0x0,0x0,0x0
.long 0x3e9e,0x3f16be9e,0x0,0x0,0x3f80bf73,0x3f4fbf73,0x0,0x0
.long 0x3f80bf4f,0x3e9ebf4f,0x0,0x0,0xbf16,0xbf733f16,0x0,0x0
.long 0xbf4f,0xbf733f4f,0x0,0x0,0xbf803f16,0x3e9e3f16,0x0,0x0
.long 0xbf803e9e,0x3f4f3e9e,0x0,0x0,0x3f73,0x3f16bf73,0x0,0x0
.long 0x3f80,0xbf80,0x0,0x0,0x3f800000,0xbf800000,0x0,0x0
.long 0xbf4f3e9e,0xbf4f3f80,0x0,0x0,0x3f16bf73,0xbf160000,0x0,0x0
.long 0x3f73bf4f,0x3f73bf80,0x0,0x0,0xbe9e3f16,0x3e9e0000,0x0,0x0
.long 0xbf803f80,0xbf803f80,0x0,0x0,0x0,0x0,0x0,0x0
.long 0x3f73bf4f,0x3f73bf80,0x0,0x0,0x3e9ebf16,0xbe9e0000,0x0,0x0
.long 0xbf4f3e9e,0xbf4f3f80,0x0,0x0,0xbf163f73,0x3f160000,0x0,0x0
.long 0x3f163e9e,0x3f16bf80,0x0,0x0,0x3f4fbf73,0xbf4f0000,0x0,0x0
.long 0xbe9ebf4f,0xbe9e3f80,0x0,0x0,0xbf733f16,0x3f730000,0x0,0x0
.long 0x3f80,0xbf80,0x0,0x0,0x3f800000,0xbf800000,0x0,0x0
.long 0x3e9e3e9e,0x3f80bf4f,0x0,0x0,0xbf733f73,0x3f16,0x0,0x0
.long 0x3f16bf4f,0xbe9e,0x0,0x0,0x3f4fbf16,0x3f80bf73,0x0,0x0
.long 0xbf803f80,0xbf803f80,0x0,0x0,0x0,0x0,0x0,0x0
.long 0x3f16bf4f,0xbe9e,0x0,0x0,0xbf4f3f16,0xbf803f73,0x0,0x0
.long 0x3e9e3e9e,0x3f80bf4f,0x0,0x0,0x3f73bf73,0xbf16,0x0,0x0
.long 0xbf733e9e,0x3f4f,0x0,0x0,0xbe9e3f73,0x3f80bf16,0x0,0x0
.long 0x3f4fbf4f,0xbf803e9e,0x0,0x0,0xbf16bf16,0x3f73,0x0,0x0
.long 0x3f80,0xbf80,0x0,0x0,0x3f800000,0xbf800000,0x0,0x0
.long 0x3f160000,0x3f73bf73,0xbf733f16,0xbf163f73,0xbf4f3f80,0x3e9e3e9e,0x3e9ebf4f,0xbf4f3e9e
.long 0x3e9e0000,0x3f4fbf16,0xbf4f3f73,0xbe9e3f16,0xbf733f80,0xbf163f4f,0xbf163e9e,0xbf733f4f
.long 0x0,0x0,0x0,0x0,0xbf803f80,0xbf803f80,0xbf803f80,0xbf803f80
.long 0xbe9e0000,0xbf4f3f16,0x3f4fbf73,0x3e9ebf16,0xbf733f80,0xbf163f4f,0xbf163e9e,0xbf733f4f
.long 0xbf160000,0xbf733f73,0x3f73bf16,0x3f16bf73,0xbf4f3f80,0x3e9e3e9e,0x3e9ebf4f,0xbf4f3e9e
.long 0xbf4f0000,0xbe9e3f73,0x3e9e3f16,0x3f4fbf73,0xbf163f80,0x3f73be9e,0x3f73bf4f,0xbf16be9e
.long 0xbf730000,0x3f163f16,0xbf163f73,0x3f73bf16,0xbe9e3f80,0x3f4fbf4f,0x3f4f3e9e,0xbe9ebf4f
.long 0xbf800000,0x3f800000,0xbf800000,0x3f800000,0x3f80,0xbf80,0x3f80,0xbf80
.long 0xbf16,0xbf733f16,0x0,0x0,0x3f80bf4f,0x3e9ebf4f,0x0,0x0
.long 0x3f80bf73,0x3f4fbf73,0x0,0x0,0x3e9e,0x3f16be9e,0x0,0x0
.long 0x0,0x0,0x0,0x0,0xbf803f80,0xbf803f80,0x0,0x0
.long 0xbf803f73,0xbf4f3f73,0x0,0x0,0x3e9e,0x3f16be9e,0x0,0x0
.long 0x3f16,0x3f73bf16,0x0,0x0,0x3f80bf4f,0x3e9ebf4f,0x0,0x0
.long 0x3f80bf16,0xbe9ebf16,0x0,0x0,0xbf4f,0xbf733f4f,0x0,0x0
.long 0xbf73,0xbf163f73,0x0,0x0,0xbf803e9e,0x3f4f3e9e,0x0,0x0
.long 0xbf800000,0x3f800000,0x0,0x0,0x3f80,0xbf80,0x0,0x0
.long 0xbf163f73,0x3f160000,0x0,0x0,0xbf4f3e9e,0xbf4f3f80,0x0,0x0
.long 0x3e9ebf16,0xbe9e0000,0x0,0x0,0x3f73bf4f,0x3f73bf80,0x0,0x0
.long 0x0,0x0,0x0,0x0,0xbf803f80,0xbf803f80,0x0,0x0
.long 0xbe9e3f16,0x3e9e0000,0x0,0x0,0x3f73bf4f,0x3f73bf80,0x0,0x0
.long 0x3f16bf73,0xbf160000,0x0,0x0,0xbf4f3e9e,0xbf4f3f80,0x0,0x0
.long 0xbf4f3f73,0x3f4f0000,0x0,0x0,0x3f163e9e,0x3f16bf80,0x0,0x0
.long 0x3f73bf16,0xbf730000,0x0,0x0,0xbe9ebf4f,0xbe9e3f80,0x0,0x0
.long 0xbf800000,0x3f800000,0x0,0x0,0x3f80,0xbf80,0x0,0x0
.long 0x3f73bf73,0xbf16,0x0,0x0,0x3e9e3e9e,0x3f80bf4f,0x0,0x0
.long 0xbf4f3f16,0xbf803f73,0x0,0x0,0x3f16bf4f,0xbe9e,0x0,0x0
.long 0x0,0x0,0x0,0x0,0xbf803f80,0xbf803f80,0x0,0x0
.long 0x3f4fbf16,0x3f80bf73,0x0,0x0,0x3f16bf4f,0xbe9e,0x0,0x0
.long 0xbf733f73,0x3f16,0x0,0x0,0x3e9e3e9e,0x3f80bf4f,0x0,0x0
.long 0x3e9ebf73,0xbf803f16,0x0,0x0,0xbf733e9e,0x3f4f,0x0,0x0
.long 0x3f163f16,0xbf73,0x0,0x0,0x3f4fbf4f,0xbf803e9e,0x0,0x0
.long 0xbf800000,0x3f800000,0x0,0x0,0x3f80,0xbf80,0x0,0x0
.long 0x3e9e3f80,0xbf4fbf4f,0xbf4f3e9e,0x3e9ebf4f,0x3f730000,0xbf163f16,0x3f163f73,0xbf73bf16
.long 0x3f163f80,0xbf73be9e,0xbf73bf4f,0x3f16be9e,0x3f4f0000,0x3e9e3f73,0xbe9e3f16,0xbf4fbf73
.long 0x3f4f3f80,0xbe9e3e9e,0xbe9ebf4f,0x3f4f3e9e,0x3f160000,0x3f733f73,0xbf73bf16,0xbf16bf73
.long 0x3f733f80,0x3f163f4f,0x3f163e9e,0x3f733f4f,0x3e9e0000,0x3f4f3f16,0xbf4fbf73,0xbe9ebf16
.long 0x0,0x0,0x0,0x0,0x0,0x0,0x0,0x0
.long 0x0,0x0,0x0,0x0,0x0,0x0,0x0,0x0
.long 0x0,0x0,0x0,0x0,0x0,0x0,0x0,0x0
.long 0x0,0x0,0x0,0x0,0x0,0x0,0x0,0x0
.long 0x3f803e9e,0xbf4f3e9e,0x0,0x0,0xbf73,0x3f163f73,0x0,0x0
.long 0xbf4f,0x3f733f4f,0x0,0x0,0xbf80bf16,0x3e9ebf16,0x0,0x0
.long 0xbf80bf4f,0xbe9ebf4f,0x0,0x0,0x3f16,0xbf73bf16,0x0,0x0
.long 0x3e9e,0xbf16be9e,0x0,0x0,0x3f803f73,0x3f4f3f73,0x0,0x0
.long 0x0,0x0,0x0,0x0,0x0,0x0,0x0,0x0
.long 0x0,0x0,0x0,0x0,0x0,0x0,0x0,0x0
.long 0x0,0x0,0x0,0x0,0x0,0x0,0x0,0x0
.long 0x0,0x0,0x0,0x0,0x0,0x0,0x0,0x0
.long 0x3e9ebf4f,0x3e9e3f80,0x0,0x0,0xbf73bf16,0x3f730000,0x0,0x0
.long 0xbf163e9e,0xbf16bf80,0x0,0x0,0x3f4f3f73,0xbf4f0000,0x0,0x0
.long 0x3f4f3e9e,0x3f4f3f80,0x0,0x0,0xbf16bf73,0x3f160000,0x0,0x0
.long 0xbf73bf4f,0xbf73bf80,0x0,0x0,0x3e9e3f16,0xbe9e0000,0x0,0x0
.long 0x0,0x0,0x0,0x0,0x0,0x0,0x0,0x0
.long 0x0,0x0,0x0,0x0,0x0,0x0,0x0,0x0
.long 0x0,0x0,0x0,0x0,0x0,0x0,0x0,0x0
.long 0x0,0x0,0x0,0x0,0x0,0x0,0x0,0x0
.long 0xbf4fbf4f,0x3f803e9e,0x0,0x0,0xbf163f16,0xbf73,0x0,0x0
.long 0x3f733e9e,0x3f4f,0x0,0x0,0xbe9ebf73,0x3f803f16,0x0,0x0
.long 0xbe9e3e9e,0xbf80bf4f,0x0,0x0,0x3f733f73,0x3f16,0x0,0x0
.long 0xbf16bf4f,0xbe9e,0x0,0x0,0xbf4fbf16,0xbf80bf73,0x0,0x0
.long 0x0,0x0,0x0,0x0,0x0,0x0,0x0,0x0
.long 0x0,0x0,0x0,0x0,0x0,0x0,0x0,0x0
.long 0x0,0x0,0x0,0x0,0x0,0x0,0x0,0x0
.long 0x0,0x0,0x0,0x0,0x0,0x0,0x0,0x0
.long 0xbf730000,0x3f16bf16,0xbf16bf73,0x3f733f16,0x3e9e3f80,0xbf4fbf4f,0xbf4f3e9e,0x3e9ebf4f
.long 0xbf4f0000,0xbe9ebf73,0x3e9ebf16,0x3f4f3f73,0x3f163f80,0xbf73be9e,0xbf73bf4f,0x3f16be9e
.long 0xbf160000,0xbf73bf73,0x3f733f16,0x3f163f73,0x3f4f3f80,0xbe9e3e9e,0xbe9ebf4f,0x3f4f3e9e
.long 0xbe9e0000,0xbf4fbf16,0x3f4f3f73,0x3e9e3f16,0x3f733f80,0x3f163f4f,0x3f163e9e,0x3f733f4f
.long 0x0,0x0,0x0,0x0,0x0,0x0,0x0,0x0
.long 0x0,0x0,0x0,0x0,0x0,0x0,0x0,0x0
.long 0x0,0x0,0x0,0x0,0x0,0x0,0x0,0x0
.long 0x0,0x0,0x0,0x0,0x0,0x0,0x0,0x0
.long 0x3f73,0xbf16bf73,0x0,0x0,0x3f803e9e,0xbf4f3e9e,0x0,0x0
.long 0x3f803f16,0xbe9e3f16,0x0,0x0,0xbf4f,0x3f733f4f,0x0,0x0
.long 0xbf16,0x3f733f16,0x0,0x0,0xbf80bf4f,0xbe9ebf4f,0x0,0x0
.long 0xbf80bf73,0xbf4fbf73,0x0,0x0,0x3e9e,0xbf16be9e,0x0,0x0
.long 0x0,0x0,0x0,0x0,0x0,0x0,0x0,0x0
.long 0x0,0x0,0x0,0x0,0x0,0x0,0x0,0x0
.long 0x0,0x0,0x0,0x0,0x0,0x0,0x0,0x0
.long 0x0,0x0,0x0,0x0,0x0,0x0,0x0,0x0
.long 0x3f733f16,0xbf730000,0x0,0x0,0x3e9ebf4f,0x3e9e3f80,0x0,0x0
.long 0xbf4fbf73,0x3f4f0000,0x0,0x0,0xbf163e9e,0xbf16bf80,0x0,0x0
.long 0x3f163f73,0xbf160000,0x0,0x0,0x3f4f3e9e,0x3f4f3f80,0x0,0x0
.long 0xbe9ebf16,0x3e9e0000,0x0,0x0,0xbf73bf4f,0xbf73bf80,0x0,0x0
.long 0x0,0x0,0x0,0x0,0x0,0x0,0x0,0x0
.long 0x0,0x0,0x0,0x0,0x0,0x0,0x0,0x0
.long 0x0,0x0,0x0,0x0,0x0,0x0,0x0,0x0
.long 0x0,0x0,0x0,0x0,0x0,0x0,0x0,0x0
.long 0x3f16bf16,0x3f73,0x0,0x0,0xbf4fbf4f,0x3f803e9e,0x0,0x0
.long 0x3e9e3f73,0xbf80bf16,0x0,0x0,0x3f733e9e,0x3f4f,0x0,0x0
.long 0xbf73bf73,0xbf16,0x0,0x0,0xbe9e3e9e,0xbf80bf4f,0x0,0x0
.long 0x3f4f3f16,0x3f803f73,0x0,0x0,0xbf16bf4f,0xbe9e,0x0,0x0
.long 0x0,0x0,0x0,0x0,0x0,0x0,0x0,0x0
.long 0x0,0x0,0x0,0x0,0x0,0x0,0x0,0x0
.long 0x0,0x0,0x0,0x0,0x0,0x0,0x0,0x0
.long 0x0,0x0,0x0,0x0,0x0,0x0,0x0,0x0
.long 0x3f80,0x3f80,0x3f80,0x3f80,0x3f80,0xbf80,0x3e483f7b,0xbe48bf7b
.long 0x3f80,0x3f80,0x3ec43f6d,0x3ec43f6d,0x3f80,0xbf80,0x3f0e3f55,0xbf0ebf55
.long 0x3f80,0x3f80,0x3f353f35,0x3f353f35,0x3f80,0xbf80,0x3f553f0e,0xbf55bf0e
.long 0x3f80,0x3f80,0x3f6d3ec4,0x3f6d3ec4,0x3f80,0xbf80,0x3f7b3e48,0xbf7bbe48
.long 0x3f80,0x3f80,0x3f800000,0x3f800000,0x3f80,0xbf80,0x3f7bbe48,0xbf7b3e48
.long 0x3f80,0x3f80,0x3f6dbec4,0x3f6dbec4,0x3f80,0xbf80,0x3f55bf0e,0xbf553f0e
.long 0x3f80,0x3f80,0x3f35bf35,0x3f35bf35,0x3f80,0xbf80,0x3f0ebf55,0xbf0e3f55
.long 0x3f80,0x3f80,0x3ec4bf6d,0x3ec4bf6d,0x3f80,0xbf80,0x3e48bf7b,0xbe483f7b
.long 0x3f80,0x3f80,0x3f80,0x3f80,0x3ec43f6d,0xbec4bf6d,0x3f0e3f55,0xbf0ebf55
.long 0x3f353f35,0x3f353f35,0x3f6d3ec4,0x3f6d3ec4,0x3f6d3ec4,0xbf6dbec4,0x3f7bbe48,0xbf7b3e48
.long 0x3f800000,0x3f800000,0x3f35bf35,0x3f35bf35,0x3f6dbec4,0xbf6d3ec4,0x3e48bf7b,0xbe483f7b
.long 0x3f35bf35,0x3f35bf35,0xbec4bf6d,0xbec4bf6d,0x3ec4bf6d,0xbec43f6d,0xbf55bf0e,0x3f553f0e
.long 0xbf80,0xbf80,0xbf800000,0xbf800000,0xbec4bf6d,0x3ec43f6d,0xbf553f0e,0x3f55bf0e
.long 0xbf35bf35,0xbf35bf35,0xbec43f6d,0xbec43f6d,0xbf6dbec4,0x3f6d3ec4,0x3e483f7b,0xbe48bf7b
.long 0xbf800000,0xbf800000,0x3f353f35,0x3f353f35,0xbf6d3ec4,0x3f6dbec4,0x3f7b3e48,0xbf7bbe48
.long 0xbf353f35,0xbf353f35,0x3f6dbec4,0x3f6dbec4,0xbec43f6d,0x3ec4bf6d,0x3f0ebf55,0xbf0e3f55
.long 0x3f80,0x3f80,0x3f80,0x3f80,0x3f353f35,0xbf35bf35,0x3f553f0e,0xbf55bf0e
.long 0x3f800000,0x3f800000,0x3f6dbec4,0x3f6dbec4,0x3f35bf35,0xbf353f35,0x3e48bf7b,0xbe483f7b
.long 0xbf80,0xbf80,0xbf35bf35,0xbf35bf35,0xbf35bf35,0x3f353f35,0xbf7b3e48,0x3f7bbe48
.long 0xbf800000,0xbf800000,0xbec43f6d,0xbec43f6d,0xbf353f35,0x3f35bf35,0x3f0e3f55,0xbf0ebf55
.long 0x3f80,0x3f80,0x3f800000,0x3f800000,0x3f353f35,0xbf35bf35,0x3f0ebf55,0xbf0e3f55
.long 0x3f800000,0x3f800000,0xbec4bf6d,0xbec4bf6d,0x3f35bf35,0xbf353f35,0xbf7bbe48,0x3f7b3e48
.long 0xbf80,0xbf80,0xbf353f35,0xbf353f35,0xbf35bf35,0x3f353f35,0x3e483f7b,0xbe48bf7b
.long 0xbf800000,0xbf800000,0x3f6d3ec4,0x3f6d3ec4,0xbf353f35,0x3f35bf35,0x3f55bf0e,0xbf553f0e
.long 0x3f80,0x3f80,0x3f80,0x3f80,0x3f6d3ec4,0xbf6dbec4,0x3f7b3e48,0xbf7bbe48
.long 0x3f35bf35,0x3f35bf35,0x3ec4bf6d,0x3ec4bf6d,0xbec4bf6d,0x3ec43f6d,0xbf55bf0e,0x3f553f0e
.long 0xbf800000,0xbf800000,0xbf353f35,0xbf353f35,0xbec43f6d,0x3ec4bf6d,0x3f0e3f55,0xbf0ebf55
.long 0x3f353f35,0x3f353f35,0x3f6dbec4,0x3f6dbec4,0x3f6dbec4,0xbf6d3ec4,0xbe48bf7b,0x3e483f7b
.long 0xbf80,0xbf80,0xbf800000,0xbf800000,0xbf6dbec4,0x3f6d3ec4,0xbe483f7b,0x3e48bf7b
.long 0xbf353f35,0xbf353f35,0x3f6d3ec4,0x3f6d3ec4,0x3ec43f6d,0xbec4bf6d,0x3f0ebf55,0xbf0e3f55
.long 0x3f800000,0x3f800000,0xbf35bf35,0xbf35bf35,0x3ec4bf6d,0xbec43f6d,0xbf553f0e,0x3f55bf0e
.long 0xbf35bf35,0xbf35bf35,0x3ec43f6d,0x3ec43f6d,0xbf6d3ec4,0x3f6dbec4,0x3f7bbe48,0xbf7b3e48
.long 0x3f80,0x3f80,0x3f80,0x3f80,0x3f800000,0xbf800000,0x3f7bbe48,0xbf7b3e48
.long 0xbf80,0xbf80,0xbec4bf6d,0xbec4bf6d,0xbf800000,0x3f800000,0xbf553f0e,0x3f55bf0e
.long 0x3f80,0x3f80,0x3f353f35,0x3f353f35,0x3f800000,0xbf800000,0x3f0ebf55,0xbf0e3f55
.long 0xbf80,0xbf80,0xbf6dbec4,0xbf6dbec4,0xbf800000,0x3f800000,0xbe483f7b,0x3e48bf7b
.long 0x3f80,0x3f80,0x3f800000,0x3f800000,0x3f800000,0xbf800000,0xbe48bf7b,0x3e483f7b
.long 0xbf80,0xbf80,0xbf6d3ec4,0xbf6d3ec4,0xbf800000,0x3f800000,0x3f0e3f55,0xbf0ebf55
.long 0x3f80,0x3f80,0x3f35bf35,0x3f35bf35,0x3f800000,0xbf800000,0xbf55bf0e,0x3f553f0e
.long 0xbf80,0xbf80,0xbec43f6d,0xbec43f6d,0xbf800000,0x3f800000,0x3f7b3e48,0xbf7bbe48
.long 0x3f80,0x3f80,0x3f80,0x3f80,0x3f6dbec4,0xbf6d3ec4,0x3f55bf0e,0xbf553f0e
.long 0xbf35bf35,0xbf35bf35,0xbf6dbec4,0xbf6dbec4,0xbec43f6d,0x3ec4bf6d,0x3e483f7b,0xbe48bf7b
.long 0x3f800000,0x3f800000,0x3f35bf35,0x3f35bf35,0xbec4bf6d,0x3ec43f6d,0xbf7bbe48,0x3f7b3e48
.long 0xbf353f35,0xbf353f35,0x3ec43f6d,0x3ec43f6d,0x3f6d3ec4,0xbf6dbec4,0x3f0ebf55,0xbf0e3f55
.long 0xbf80,0xbf80,0xbf800000,0xbf800000,0xbf6d3ec4,0x3f6dbec4,0x3f0e3f55,0xbf0ebf55
.long 0x3f353f35,0x3f353f35,0x3ec4bf6d,0x3ec4bf6d,0x3ec4bf6d,0xbec43f6d,0xbf7b3e48,0x3f7bbe48
.long 0xbf800000,0xbf800000,0x3f353f35,0x3f353f35,0x3ec43f6d,0xbec4bf6d,0x3e48bf7b,0xbe483f7b
.long 0x3f35bf35,0x3f35bf35,0xbf6d3ec4,0xbf6d3ec4,0xbf6dbec4,0x3f6d3ec4,0x3f553f0e,0xbf55bf0e
.long 0x3f80,0x3f80,0x3f80,0x3f80,0x3f35bf35,0xbf353f35,0x3f0ebf55,0xbf0e3f55
.long 0xbf800000,0xbf800000,0xbf6d3ec4,0xbf6d3ec4,0x3f353f35,0xbf35bf35,0x3f7b3e48,0xbf7bbe48
.long 0xbf80,0xbf80,0xbf35bf35,0xbf35bf35,0xbf353f35,0x3f35bf35,0x3e483f7b,0xbe48bf7b
.long 0x3f800000,0x3f800000,0x3ec4bf6d,0x3ec4bf6d,0xbf35bf35,0x3f353f35,0xbf553f0e,0x3f55bf0e
.long 0x3f80,0x3f80,0x3f800000,0x3f800000,0x3f35bf35,0xbf353f35,0xbf55bf0e,0x3f553f0e
.long 0xbf800000,0xbf800000,0x3ec43f6d,0x3ec43f6d,0x3f353f35,0xbf35bf35,0x3e48bf7b,0xbe483f7b
.long 0xbf80,0xbf80,0xbf353f35,0xbf353f35,0xbf353f35,0x3f35bf35,0x3f7bbe48,0xbf7b3e48
.long 0x3f800000,0x3f800000,0xbf6dbec4,0xbf6dbec4,0xbf35bf35,0x3f353f35,0x3f0e3f55,0xbf0ebf55
.long 0x3f80,0x3f80,0x3f80,0x3f80,0x3ec4bf6d,0xbec43f6d,0x3e48bf7b,0xbe483f7b
.long 0xbf353f35,0xbf353f35,0xbec43f6d,0xbec43f6d,0x3f6dbec4,0xbf6d3ec4,0x3f0ebf55,0xbf0e3f55
.long 0xbf800000,0xbf800000,0xbf353f35,0xbf353f35,0x3f6d3ec4,0xbf6dbec4,0x3f55bf0e,0xbf553f0e
.long 0xbf35bf35,0xbf35bf35,0xbf6d3ec4,0xbf6d3ec4,0x3ec43f6d,0xbec4bf6d,0x3f7bbe48,0xbf7b3e48
.long 0xbf80,0xbf80,0xbf800000,0xbf800000,0xbec43f6d,0x3ec4bf6d,0x3f7b3e48,0xbf7bbe48
.long 0x3f35bf35,0x3f35bf35,0xbf6dbec4,0xbf6dbec4,0xbf6d3ec4,0x3f6dbec4,0x3f553f0e,0xbf55bf0e
.long 0x3f800000,0x3f800000,0xbf35bf35,0xbf35bf35,0xbf6dbec4,0x3f6d3ec4,0x3f0e3f55,0xbf0ebf55
.long 0x3f353f35,0x3f353f35,0xbec4bf6d,0xbec4bf6d,0xbec4bf6d,0x3ec43f6d,0x3e483f7b,0xbe48bf7b
.long 0x3f80,0x3f80,0xbf80,0xbf80,0x3f80,0xbf80,0xbe48bf7b,0x3e483f7b
.long 0x3f80,0x3f80,0xbec4bf6d,0xbec4bf6d,0x3f80,0xbf80,0xbf0ebf55,0x3f0e3f55
.long 0x3f80,0x3f80,0xbf35bf35,0xbf35bf35,0x3f80,0xbf80,0xbf55bf0e,0x3f553f0e
.long 0x3f80,0x3f80,0xbf6dbec4,0xbf6dbec4,0x3f80,0xbf80,0xbf7bbe48,0x3f7b3e48
.long 0x3f80,0x3f80,0xbf800000,0xbf800000,0x3f80,0xbf80,0xbf7b3e48,0x3f7bbe48
.long 0x3f80,0x3f80,0xbf6d3ec4,0xbf6d3ec4,0x3f80,0xbf80,0xbf553f0e,0x3f55bf0e
.long 0x3f80,0x3f80,0xbf353f35,0xbf353f35,0x3f80,0xbf80,0xbf0e3f55,0x3f0ebf55
.long 0x3f80,0x3f80,0xbec43f6d,0xbec43f6d,0x3f80,0xbf80,0xbe483f7b,0x3e48bf7b
.long 0x3f80,0x3f80,0xbf80,0xbf80,0x3ec43f6d,0xbec4bf6d,0xbf0ebf55,0x3f0e3f55
.long 0x3f353f35,0x3f353f35,0xbf6dbec4,0xbf6dbec4,0x3f6d3ec4,0xbf6dbec4,0xbf7b3e48,0x3f7bbe48
.long 0x3f800000,0x3f800000,0xbf353f35,0xbf353f35,0x3f6dbec4,0xbf6d3ec4,0xbe483f7b,0x3e48bf7b
.long 0x3f35bf35,0x3f35bf35,0x3ec43f6d,0x3ec43f6d,0x3ec4bf6d,0xbec43f6d,0x3f553f0e,0xbf55bf0e
.long 0xbf80,0xbf80,0x3f800000,0x3f800000,0xbec4bf6d,0x3ec43f6d,0x3f55bf0e,0xbf553f0e
.long 0xbf35bf35,0xbf35bf35,0x3ec4bf6d,0x3ec4bf6d,0xbf6dbec4,0x3f6d3ec4,0xbe48bf7b,0x3e483f7b
.long 0xbf800000,0xbf800000,0xbf35bf35,0xbf35bf35,0xbf6d3ec4,0x3f6dbec4,0xbf7bbe48,0x3f7b3e48
.long 0xbf353f35,0xbf353f35,0xbf6d3ec4,0xbf6d3ec4,0xbec43f6d,0x3ec4bf6d,0xbf0e3f55,0x3f0ebf55
.long 0x3f80,0x3f80,0xbf80,0xbf80,0x3f353f35,0xbf35bf35,0xbf55bf0e,0x3f553f0e
.long 0x3f800000,0x3f800000,0xbf6d3ec4,0xbf6d3ec4,0x3f35bf35,0xbf353f35,0xbe483f7b,0x3e48bf7b
.long 0xbf80,0xbf80,0x3f353f35,0x3f353f35,0xbf35bf35,0x3f353f35,0x3f7bbe48,0xbf7b3e48
.long 0xbf800000,0xbf800000,0x3ec4bf6d,0x3ec4bf6d,0xbf353f35,0x3f35bf35,0xbf0ebf55,0x3f0e3f55
.long 0x3f80,0x3f80,0xbf800000,0xbf800000,0x3f353f35,0xbf35bf35,0xbf0e3f55,0x3f0ebf55
.long 0x3f800000,0x3f800000,0x3ec43f6d,0x3ec43f6d,0x3f35bf35,0xbf353f35,0x3f7b3e48,0xbf7bbe48
.long 0xbf80,0xbf80,0x3f35bf35,0x3f35bf35,0xbf35bf35,0x3f353f35,0xbe48bf7b,0x3e483f7b
.long 0xbf800000,0xbf800000,0xbf6dbec4,0xbf6dbec4,0xbf353f35,0x3f35bf35,0xbf553f0e,0x3f55bf0e
.long 0x3f80,0x3f80,0xbf80,0xbf80,0x3f6d3ec4,0xbf6dbec4,0xbf7bbe48,0x3f7b3e48
.long 0x3f35bf35,0x3f35bf35,0xbec43f6d,0xbec43f6d,0xbec4bf6d,0x3ec43f6d,0x3f553f0e,0xbf55bf0e
.long 0xbf800000,0xbf800000,0x3f35bf35,0x3f35bf35,0xbec43f6d,0x3ec4bf6d,0xbf0ebf55,0x3f0e3f55
.long 0x3f353f35,0x3f353f35,0xbf6d3ec4,0xbf6d3ec4,0x3f6dbec4,0xbf6d3ec4,0x3e483f7b,0xbe48bf7b
.long 0xbf80,0xbf80,0x3f800000,0x3f800000,0xbf6dbec4,0x3f6d3ec4,0x3e48bf7b,0xbe483f7b
.long 0xbf353f35,0xbf353f35,0xbf6dbec4,0xbf6dbec4,0x3ec43f6d,0xbec4bf6d,0xbf0e3f55,0x3f0ebf55
.long 0x3f800000,0x3f800000,0x3f353f35,0x3f353f35,0x3ec4bf6d,0xbec43f6d,0x3f55bf0e,0xbf553f0e
.long 0xbf35bf35,0xbf35bf35,0xbec4bf6d,0xbec4bf6d,0xbf6d3ec4,0x3f6dbec4,0xbf7b3e48,0x3f7bbe48
.long 0x3f80,0x3f80,0xbf80,0xbf80,0x3f800000,0xbf800000,0xbf7b3e48,0x3f7bbe48
.long 0xbf80,0xbf80,0x3ec43f6d,0x3ec43f6d,0xbf800000,0x3f800000,0x3f55bf0e,0xbf553f0e
.long 0x3f80,0x3f80,0xbf35bf35,0xbf35bf35,0x3f800000,0xbf800000,0xbf0e3f55,0x3f0ebf55
.long 0xbf80,0xbf80,0x3f6d3ec4,0x3f6d3ec4,0xbf800000,0x3f800000,0x3e48bf7b,0xbe483f7b
.long 0x3f80,0x3f80,0xbf800000,0xbf800000,0x3f800000,0xbf800000,0x3e483f7b,0xbe48bf7b
.long 0xbf80,0xbf80,0x3f6dbec4,0x3f6dbec4,0xbf800000,0x3f800000,0xbf0ebf55,0x3f0e3f55
.long 0x3f80,0x3f80,0xbf353f35,0xbf353f35,0x3f800000,0xbf800000,0x3f553f0e,0xbf55bf0e
.long 0xbf80,0xbf80,0x3ec4bf6d,0x3ec4bf6d,0xbf800000,0x3f800000,0xbf7bbe48,0x3f7b3e48
.long 0x3f80,0x3f80,0xbf80,0xbf80,0x3f6dbec4,0xbf6d3ec4,0xbf553f0e,0x3f55bf0e
.long 0xbf35bf35,0xbf35bf35,0x3f6d3ec4,0x3f6d3ec4,0xbec43f6d,0x3ec4bf6d,0xbe48bf7b,0x3e483f7b
.long 0x3f800000,0x3f800000,0xbf353f35,0xbf353f35,0xbec4bf6d,0x3ec43f6d,0x3f7b3e48,0xbf7bbe48
.long 0xbf353f35,0xbf353f35,0xbec4bf6d,0xbec4bf6d,0x3f6d3ec4,0xbf6dbec4,0xbf0e3f55,0x3f0ebf55
.long 0xbf80,0xbf80,0x3f800000,0x3f800000,0xbf6d3ec4,0x3f6dbec4,0xbf0ebf55,0x3f0e3f55
.long 0x3f353f35,0x3f353f35,0xbec43f6d,0xbec43f6d,0x3ec4bf6d,0xbec43f6d,0x3f7bbe48,0xbf7b3e48
.long 0xbf800000,0xbf800000,0xbf35bf35,0xbf35bf35,0x3ec43f6d,0xbec4bf6d,0xbe483f7b,0x3e48bf7b
.long 0x3f35bf35,0x3f35bf35,0x3f6dbec4,0x3f6dbec4,0xbf6dbec4,0x3f6d3ec4,0xbf55bf0e,0x3f553f0e
.long 0x3f80,0x3f80,0xbf80,0xbf80,0x3f35bf35,0xbf353f35,0xbf0e3f55,0x3f0ebf55
.long 0xbf800000,0xbf800000,0x3f6dbec4,0x3f6dbec4,0x3f353f35,0xbf35bf35,0xbf7bbe48,0x3f7b3e48
.long 0xbf80,0xbf80,0x3f353f35,0x3f353f35,0xbf353f35,0x3f35bf35,0xbe48bf7b,0x3e483f7b
.long 0x3f800000,0x3f800000,0xbec43f6d,0xbec43f6d,0xbf35bf35,0x3f353f35,0x3f55bf0e,0xbf553f0e
.long 0x3f80,0x3f80,0xbf800000,0xbf800000,0x3f35bf35,0xbf353f35,0x3f553f0e,0xbf55bf0e
.long 0xbf800000,0xbf800000,0xbec4bf6d,0xbec4bf6d,0x3f353f35,0xbf35bf35,0xbe483f7b,0x3e48bf7b
.long 0xbf80,0xbf80,0x3f35bf35,0x3f35bf35,0xbf353f35,0x3f35bf35,0xbf7b3e48,0x3f7bbe48
.long 0x3f800000,0x3f800000,0x3f6d3ec4,0x3f6d3ec4,0xbf35bf35,0x3f353f35,0xbf0ebf55,0x3f0e3f55
.long 0x3f80,0x3f80,0xbf80,0xbf80,0x3ec4bf6d,0xbec43f6d,0xbe483f7b,0x3e48bf7b
.long 0xbf353f35,0xbf353f35,0x3ec4bf6d,0x3ec4bf6d,0x3f6dbec4,0xbf6d3ec4,0xbf0e3f55,0x3f0ebf55
.long 0xbf800000,0xbf800000,0x3f35bf35,0x3f35bf35,0x3f6d3ec4,0xbf6dbec4,0xbf553f0e,0x3f55bf0e
.long 0xbf35bf35,0xbf35bf35,0x3f6dbec4,0x3f6dbec4,0x3ec43f6d,0xbec4bf6d,0xbf7b3e48,0x3f7bbe48
.long 0xbf80,0xbf80,0x3f800000,0x3f800000,0xbec43f6d,0x3ec4bf6d,0xbf7bbe48,0x3f7b3e48
.long 0x3f35bf35,0x3f35bf35,0x3f6d3ec4,0x3f6d3ec4,0xbf6d3ec4,0x3f6dbec4,0xbf55bf0e,0x3f553f0e
.long 0x3f800000,0x3f800000,0x3f353f35,0x3f353f35,0xbf6dbec4,0x3f6d3ec4,0xbf0ebf55,0x3f0e3f55
.long 0x3f353f35,0x3f353f35,0x3ec43f6d,0x3ec43f6d,0xbec4bf6d,0x3ec43f6d,0xbe48bf7b,0x3e483f7b
.long 0x3f800000,0x0,0x3f800000,0x0,0x3f800000,0x0,0x3f7ffcd7,0x3c20d8d2
.long 0x3f800000,0x0,0x3f7ff35e,0x3ca0d6d6,0x3f800000,0x0,0x3f7fe394,0x3cf13d4c
.long 0x3f800000,0x0,0x3f7fcd79,0x3d20cee7,0x3f800000,0x0,0x3f7fb10f,0x3d48fb30
.long 0x3f800000,0x0,0x3f7f8e56,0x3d712283,0x3f800000,0x0,0x3f7f654e,0x3d8ca1f2
.long 0x3f800000,0x0,0x3f7f35f9,0x3da0af2a,0x3f800000,0x0,0x3f7f0059,0x3db4b86a
.long 0x3f800000,0x0,0x3f7ec46d,0x3dc8bd36,0x3f800000,0x0,0x3f7e8238,0x3ddcbd0d
.long 0x3f800000,0x0,0x3f7e39bc,0x3df0b772,0x3f800000,0x0,0x3f7deafa,0x3e0255f4
.long 0x3f800000,0x0,0x3f7d95f4,0x3e0c4cf7,0x3f800000,0x0,0x3f7d3aac,0x3e164083
.long 0x3f800000,0x0,0x3f800000,0x0,0x3f7ff35e,0x3ca0d6d6,0x3f7fe394,0x3cf13d4c
.long 0x3f7fcd79,0x3d20cee7,0x3f7f8e56,0x3d712283,0x3f7f8e56,0x3d712283,0x3f7f0059,0x3db4b86a
.long 0x3f7f35f9,0x3da0af2a,0x3f7e39bc,0x3df0b772,0x3f7ec46d,0x3dc8bd36,0x3f7d3aac,0x3e164083
.long 0x3f7e39bc,0x3df0b772,0x3f7c0361,0x3e3403f1,0x3f7d95f4,0x3e0c4cf7,0x3f7a9421,0x3e519f65
.long 0x3f7cd925,0x3e20305b,0x3f78ed3c,0x3e6f0c4d,0x3f7c0361,0x3e3403f1,0x3f770f11,0x3e862210
.long 0x3f7b14be,0x3e47c5c2,0x3f74fa0b,0x3e94a031,0x3f7a0d54,0x3e5b73dc,0x3f72ae9e,0x3ea2fd52
.long 0x3f78ed3c,0x3e6f0c4d,0x3f702d4f,0x3eb13641,0x3f77b493,0x3e814693,0x3f6d76aa,0x3ebf47d7
.long 0x3f766377,0x3e8afa3e,0x3f6a8b4b,0x3ecd2ef3,0x3f74fa0b,0x3e94a031,0x3f676bd8,0x3edae880
.long 0x3f800000,0x0,0x3f800000,0x0,0x3f7fcd79,0x3d20cee7,0x3f7fb10f,0x3d48fb30
.long 0x3f7f35f9,0x3da0af2a,0x3f7ec46d,0x3dc8bd36,0x3f7e39bc,0x3df0b772,0x3f7d3aac,0x3e164083
.long 0x3f7cd925,0x3e20305b,0x3f7b14be,0x3e47c5c2,0x3f7b14be,0x3e47c5c2,0x3f7853f8,0x3e78cfcc
.long 0x3f78ed3c,0x3e6f0c4d,0x3f74fa0b,0x3e94a031,0x3f766377,0x3e8afa3e,0x3f710908,0x3eac7cd4
.long 0x3f737871,0x3e9e377a,0x3f6c835e,0x3ec3ef15,0x3f702d4f,0x3eb13641,0x3f676bd8,0x3edae880
.long 0x3f6c835e,0x3ec3ef15,0x3f61c598,0x3ef15aea,0x3f687c12,0x3ed65a92,0x3f5b941a,0x3f039c3d
.long 0x3f641901,0x3ee87171,0x3f54db31,0x3f0e39da,0x3f5f5be6,0x3efa2c90,0x3f4d9f02,0x3f187fc0
.long 0x3f5a46a0,0x3f05c277,0x3f45e403,0x3f226799,0x3f54db31,0x3f0e39da,0x3f3daef9,0x3f2beb4a
.long 0x3f800000,0x0,0x3f800000,0x0,0x3f7f8e56,0x3d712283,0x3f7f654e,0x3d8ca1f2
.long 0x3f7e39bc,0x3df0b772,0x3f7d95f4,0x3e0c4cf7,0x3f7c0361,0x3e3403f1,0x3f7a9421,0x3e519f65
.long 0x3f78ed3c,0x3e6f0c4d,0x3f766377,0x3e8afa3e,0x3f74fa0b,0x3e94a031,0x3f710908,0x3eac7cd4
.long 0x3f702d4f,0x3eb13641,0x3f6a8b4b,0x3ecd2ef3,0x3f6a8b4b,0x3ecd2ef3,0x3f62f219,0x3eece91a
.long 0x3f641901,0x3ee87171,0x3f5a46a0,0x3f05c277,0x3f5cdc29,0x3f0172c3,0x3f50935b,0x3f146eba
.long 0x3f54db31,0x3f0e39da,0x3f45e403,0x3f226799,0x3f4c1d35,0x3f1a82a4,0x3f3a4582,0x3f2f9c32
.long 0x3f42a9f7,0x3f26423a,0x3f2dc5e3,0x3f3bfc8f,0x3f3889dc,0x3f316e2c,0x3f207440,0x3f4779bc
.long 0x3f2dc5e3,0x3f3bfc8f,0x3f1260b2,0x3f5205d4,0x3f226799,0x3f45e403,0x3f039c3d,0x3f5b941a
.long 0x3f800000,0x0,0x3f7cd925,0x3e20305b,0x3f800000,0x0,0x3f7c7160,0x3e2a1c3f
.long 0x3f800000,0x0,0x3f7c0361,0x3e3403f1,0x3f800000,0x0,0x3f7b8f2a,0x3e3de731
.long 0x3f800000,0x0,0x3f7b14be,0x3e47c5c2,0x3f800000,0x0,0x3f7a9421,0x3e519f65
.long 0x3f800000,0x0,0x3f7a0d54,0x3e5b73dc,0x3f800000,0x0,0x3f79805c,0x3e6542e9
.long 0x3f800000,0x0,0x3f78ed3c,0x3e6f0c4d,0x3f800000,0x0,0x3f7853f8,0x3e78cfcc
.long 0x3f800000,0x0,0x3f77b493,0x3e814693,0x3f800000,0x0,0x3f770f11,0x3e862210
.long 0x3f800000,0x0,0x3f766377,0x3e8afa3e,0x3f800000,0x0,0x3f75b1c9,0x3e8fcefe
.long 0x3f800000,0x0,0x3f74fa0b,0x3e94a031,0x3f800000,0x0,0x3f743c41,0x3e996dba
.long 0x3f737871,0x3e9e377a,0x3f641901,0x3ee87171,0x3f71decf,0x3ea7bf25,0x3f609384,0x3ef5c6c5
.long 0x3f702d4f,0x3eb13641,0x3f5cdc29,0x3f0172c3,0x3f6e641a,0x3eba9be1,0x3f58f3c4,0x3f07e565
.long 0x3f6c835e,0x3ec3ef15,0x3f54db31,0x3f0e39da,0x3f6a8b4b,0x3ecd2ef3,0x3f50935b,0x3f146eba
.long 0x3f687c12,0x3ed65a92,0x3f4c1d35,0x3f1a82a4,0x3f6655e7,0x3edf7108,0x3f4779bc,0x3f207440
.long 0x3f641901,0x3ee87171,0x3f42a9f7,0x3f26423a,0x3f61c598,0x3ef15aea,0x3f3daef9,0x3f2beb4a
.long 0x3f5f5be6,0x3efa2c90,0x3f3889dc,0x3f316e2c,0x3f5cdc29,0x3f0172c3,0x3f333bc6,0x3f36c9a9
.long 0x3f5a46a0,0x3f05c277,0x3f2dc5e3,0x3f3bfc8f,0x3f579b8c,0x3f0a04f8,0x3f28296a,0x3f4105b8
.long 0x3f54db31,0x3f0e39da,0x3f226799,0x3f45e403,0x3f5205d4,0x3f1260b2,0x3f1c81b9,0x3f4a965e
.long 0x3f4f1bbd,0x3f167918,0x3f3504f3,0x3f3504f3,0x3f490a88,0x3f1e7cf1,0x3f2beb4a,0x3f3daef9
.long 0x3f42a9f7,0x3f26423a,0x3f226799,0x3f45e403,0x3f3bfc8f,0x3f2dc5e3,0x3f187fc0,0x3f4d9f02
.long 0x3f3504f3,0x3f3504f3,0x3f0e39da,0x3f54db31,0x3f2dc5e3,0x3f3bfc8f,0x3f039c3d,0x3f5b941a
.long 0x3f26423a,0x3f42a9f7,0x3ef15aea,0x3f61c598,0x3f1e7cf1,0x3f490a88,0x3edae880,0x3f676bd8
.long 0x3f167918,0x3f4f1bbd,0x3ec3ef15,0x3f6c835e,0x3f0e39da,0x3f54db31,0x3eac7cd4,0x3f710908
.long 0x3f05c277,0x3f5a46a0,0x3e94a031,0x3f74fa0b,0x3efa2c90,0x3f5f5be6,0x3e78cfcc,0x3f7853f8
.long 0x3ee87171,0x3f641901,0x3e47c5c2,0x3f7b14be,0x3ed65a92,0x3f687c12,0x3e164083,0x3f7d3aac
.long 0x3ec3ef15,0x3f6c835e,0x3dc8bd36,0x3f7ec46d,0x3eb13641,0x3f702d4f,0x3d48fb30,0x3f7fb10f
.long 0x3f167918,0x3f4f1bbd,0x3ee87171,0x3f641901,0x3f0a04f8,0x3f579b8c,0x3ec8917e,0x3f6b8a3d
.long 0x3efa2c90,0x3f5f5be6,0x3ea7bf25,0x3f71decf,0x3edf7108,0x3f6655e7,0x3e862210,0x3f770f11
.long 0x3ec3ef15,0x3f6c835e,0x3e47c5c2,0x3f7b14be,0x3ea7bf25,0x3f71decf,0x3e0255f4,0x3f7deafa
.long 0x3e8afa3e,0x3f766377,0x3d712283,0x3f7f8e56,0x3e5b73dc,0x3f7a0d54,0xbc20d8d2,0x3f7ffcd7
.long 0x3e20305b,0x3f7cd925,0xbda0af2a,0x3f7f35f9,0x3dc8bd36,0x3f7ec46d,0xbe164083,0x3f7d3aac
.long 0x3d20cee7,0x3f7fcd79,0xbe5b73dc,0x3f7a0d54,0xbca0d6d6,0x3f7ff35e,0xbe8fcefe,0x3f75b1c9
.long 0xbda0af2a,0x3f7f35f9,0xbeb13641,0x3f702d4f,0xbe0c4cf7,0x3f7d95f4,0xbed1c759,0x3f698690
.long 0xbe47c5c2,0x3f7b14be,0xbef15aea,0x3f61c598,0xbe814693,0x3f77b493,0xbf07e565,0x3f58f3c4
.long 0x3f800000,0x0,0x3f800000,0x0,0x3f7f35f9,0x3da0af2a,0x3f7f0059,0x3db4b86a
.long 0x3f7cd925,0x3e20305b,0x3f7c0361,0x3e3403f1,0x3f78ed3c,0x3e6f0c4d,0x3f770f11,0x3e862210
.long 0x3f737871,0x3e9e377a,0x3f702d4f,0x3eb13641,0x3f6c835e,0x3ec3ef15,0x3f676bd8,0x3edae880
.long 0x3f641901,0x3ee87171,0x3f5cdc29,0x3f0172c3,0x3f5a46a0,0x3f05c277,0x3f50935b,0x3f146eba
.long 0x3f4f1bbd,0x3f167918,0x3f42a9f7,0x3f26423a,0x3f42a9f7,0x3f26423a,0x3f333bc6,0x3f36c9a9
.long 0x3f3504f3,0x3f3504f3,0x3f226799,0x3f45e403,0x3f26423a,0x3f42a9f7,0x3f104f0e,0x3f53731f
.long 0x3f167918,0x3f4f1bbd,0x3efa2c90,0x3f5f5be6,0x3f05c277,0x3f5a46a0,0x3ed1c759,0x3f698690
.long 0x3ee87171,0x3f641901,0x3ea7bf25,0x3f71decf,0x3ec3ef15,0x3f6c835e,0x3e78cfcc,0x3f7853f8
.long 0x3f800000,0x0,0x3f800000,0x0,0x3f7ec46d,0x3dc8bd36,0x3f7e8238,0x3ddcbd0d
.long 0x3f7b14be,0x3e47c5c2,0x3f7a0d54,0x3e5b73dc,0x3f74fa0b,0x3e94a031,0x3f72ae9e,0x3ea2fd52
.long 0x3f6c835e,0x3ec3ef15,0x3f687c12,0x3ed65a92,0x3f61c598,0x3ef15aea,0x3f5b941a,0x3f039c3d
.long 0x3f54db31,0x3f0e39da,0x3f4c1d35,0x3f1a82a4,0x3f45e403,0x3f226799,0x3f3a4582,0x3f2f9c32
.long 0x3f3504f3,0x3f3504f3,0x3f26423a,0x3f42a9f7,0x3f226799,0x3f45e403,0x3f104f0e,0x3f53731f
.long 0x3f0e39da,0x3f54db31,0x3ef15aea,0x3f61c598,0x3ef15aea,0x3f61c598,0x3ebf47d7,0x3f6d76aa
.long 0x3ec3ef15,0x3f6c835e,0x3e8afa3e,0x3f766377,0x3e94a031,0x3f74fa0b,0x3e2a1c3f,0x3f7c7160
.long 0x3e47c5c2,0x3f7b14be,0x3d712283,0x3f7f8e56,0x3dc8bd36,0x3f7ec46d,0xbd48fb30,0x3f7fb10f
.long 0x3f800000,0x0,0x3f800000,0x0,0x3f7e39bc,0x3df0b772,0x3f7deafa,0x3e0255f4
.long 0x3f78ed3c,0x3e6f0c4d,0x3f77b493,0x3e814693,0x3f702d4f,0x3eb13641,0x3f6d76aa,0x3ebf47d7
.long 0x3f641901,0x3ee87171,0x3f5f5be6,0x3efa2c90,0x3f54db31,0x3f0e39da,0x3f4d9f02,0x3f187fc0
.long 0x3f42a9f7,0x3f26423a,0x3f3889dc,0x3f316e2c,0x3f2dc5e3,0x3f3bfc8f,0x3f207440,0x3f4779bc
.long 0x3f167918,0x3f4f1bbd,0x3f05c277,0x3f5a46a0,0x3efa2c90,0x3f5f5be6,0x3ed1c759,0x3f698690
.long 0x3ec3ef15,0x3f6c835e,0x3e94a031,0x3f74fa0b,0x3e8afa3e,0x3f766377,0x3e2a1c3f,0x3f7c7160
.long 0x3e20305b,0x3f7cd925,0x3d20cee7,0x3f7fcd79,0x3d20cee7,0x3f7fcd79,0xbdb4b86a,0x3f7f0059
.long 0xbda0af2a,0x3f7f35f9,0xbe5b73dc,0x3f7a0d54,0xbe47c5c2,0x3f7b14be,0xbeac7cd4,0x3f710908
.long 0x3f800000,0x0,0x3f800000,0x0,0x3f7d95f4,0x3e0c4cf7,0x3f7d3aac,0x3e164083
.long 0x3f766377,0x3e8afa3e,0x3f74fa0b,0x3e94a031,0x3f6a8b4b,0x3ecd2ef3,0x3f676bd8,0x3edae880
.long 0x3f5a46a0,0x3f05c277,0x3f54db31,0x3f0e39da,0x3f45e403,0x3f226799,0x3f3daef9,0x3f2beb4a
.long 0x3f2dc5e3,0x3f3bfc8f,0x3f226799,0x3f45e403,0x3f1260b2,0x3f5205d4,0x3f039c3d,0x3f5b941a
.long 0x3ee87171,0x3f641901,0x3ec3ef15,0x3f6c835e,0x3ea7bf25,0x3f71decf,0x3e78cfcc,0x3f7853f8
.long 0x3e47c5c2,0x3f7b14be,0x3dc8bd36,0x3f7ec46d,0x3d712283,0x3f7f8e56,0xbd48fb30,0x3f7fb10f
.long 0xbda0af2a,0x3f7f35f9,0xbe47c5c2,0x3f7b14be,0xbe5b73dc,0x3f7a0d54,0xbeac7cd4,0x3f710908
.long 0xbeb13641,0x3f702d4f,0xbef15aea,0x3f61c598,0xbef15aea,0x3f61c598,0xbf187fc0,0x3f4d9f02
.long 0x3e9e377a,0x3f737871,0x3e20305b,0x3f7cd925,0x3e6f0c4d,0x3f78ed3c,0x3d8ca1f2,0x3f7f654e
.long 0x3e20305b,0x3f7cd925,0xbca0d6d6,0x3f7ff35e,0x3da0af2a,0x3f7f35f9,0xbddcbd0d,0x3f7e8238
.long 0x0,0x3f800000,0xbe47c5c2,0x3f7b14be,0xbda0af2a,0x3f7f35f9,0xbe8fcefe,0x3f75b1c9
.long 0xbe20305b,0x3f7cd925,0xbeba9be1,0x3f6e641a,0xbe6f0c4d,0x3f78ed3c,0xbee3f40d,0x3f653a48
.long 0xbe9e377a,0x3f737871,0xbf05c277,0x3f5a46a0,0xbec3ef15,0x3f6c835e,0xbf187fc0,0x3f4d9f02
.long 0xbee87171,0x3f641901,0xbf2a0c73,0x3f3f5cb5,0xbf05c277,0x3f5a46a0,0xbf3a4582,0x3f2f9c32
.long 0xbf167918,0x3f4f1bbd,0xbf490a88,0x3f1e7cf1,0xbf26423a,0x3f42a9f7,0xbf563e03,0x3f0c2124
.long 0xbf3504f3,0x3f3504f3,0xbf61c598,0x3ef15aea,0xbf42a9f7,0x3f26423a,0xbf6b8a3d,0x3ec8917e
.long 0x0,0x3f800000,0xbe20305b,0x3f7cd925,0xbdc8bd36,0x3f7ec46d,0xbe862210,0x3f770f11
.long 0xbe47c5c2,0x3f7b14be,0xbeba9be1,0x3f6e641a,0xbe94a031,0x3f74fa0b,0xbeece91a,0x3f62f219
.long 0xbec3ef15,0x3f6c835e,0xbf0e39da,0x3f54db31,0xbef15aea,0x3f61c598,0xbf2456f1,0x3f444969
.long 0xbf0e39da,0x3f54db31,0xbf3889dc,0x3f316e2c,0xbf226799,0x3f45e403,0xbf4a965e,0x3f1c81b9
.long 0xbf3504f3,0x3f3504f3,0xbf5a46a0,0x3f05c277,0xbf45e403,0x3f226799,0xbf676bd8,0x3edae880
.long 0xbf54db31,0x3f0e39da,0xbf71decf,0x3ea7bf25,0xbf61c598,0x3ef15aea,0xbf79805c,0x3e6542e9
.long 0xbf6c835e,0x3ec3ef15,0xbf7e39bc,0x3df0b772,0xbf74fa0b,0x3e94a031,0xbf7ffcd7,0x3c20d8d2
.long 0xbf7b14be,0x3e47c5c2,0xbf7ec46d,0xbdc8bd36,0xbf7ec46d,0x3dc8bd36,0xbf7a9421,0xbe519f65
.long 0xbe9e377a,0x3f737871,0xbee87171,0x3f641901,0xbed65a92,0x3f687c12,0xbf104f0e,0x3f53731f
.long 0xbf05c277,0x3f5a46a0,0xbf2a0c73,0x3f3f5cb5,0xbf1e7cf1,0x3f490a88,0xbf4105b8,0x3f28296a
.long 0xbf3504f3,0x3f3504f3,0xbf54db31,0x3f0e39da,0xbf490a88,0x3f1e7cf1,0xbf653a48,0x3ee3f40d
.long 0xbf5a46a0,0x3f05c277,0xbf71decf,0x3ea7bf25,0xbf687c12,0x3ed65a92,0xbf7a9421,0x3e519f65
.long 0xbf737871,0x3e9e377a,0xbf7f35f9,0x3da0af2a,0xbf7b14be,0x3e47c5c2,0xbf7fb10f,0xbd48fb30
.long 0xbf7f35f9,0x3da0af2a,0xbf7c0361,0xbe3403f1,0xbf7fcd79,0xbd20cee7,0xbf743c41,0xbe996dba
.long 0xbf7cd925,0xbe20305b,0xbf687c12,0xbed65a92,0xbf766377,0xbe8afa3e,0xbf58f3c4,0xbf07e565
.long 0xbf6c835e,0xbec3ef15,0xbf45e403,0xbf226799,0xbf5f5be6,0xbefa2c90,0xbf2f9c32,0xbf3a4582
.long 0xbf167918,0x3f4f1bbd,0xbf3504f3,0x3f3504f3,0xbf316e2c,0x3f3889dc,0xbf4d9f02,0x3f187fc0
.long 0xbf490a88,0x3f1e7cf1,0xbf61c598,0x3ef15aea,0xbf5cdc29,0x3f0172c3,0xbf710908,0x3eac7cd4
.long 0xbf6c835e,0x3ec3ef15,0xbf7b14be,0x3e47c5c2,0xbf77b493,0x3e814693,0xbf7fb10f,0x3d48fb30
.long 0xbf7e39bc,0x3df0b772,0xbf7ec46d,0xbdc8bd36,0xbf7ff35e,0xbca0d6d6,0xbf7853f8,0xbe78cfcc
.long 0xbf7cd925,0xbe20305b,0xbf6c835e,0xbec3ef15,0xbf74fa0b,0xbe94a031,0xbf5b941a,0xbf039c3d
.long 0xbf687c12,0xbed65a92,0xbf45e403,0xbf226799,0xbf579b8c,0xbf0a04f8,0xbf2beb4a,0xbf3daef9
.long 0xbf42a9f7,0xbf26423a,0xbf0e39da,0xbf54db31,0xbf2a0c73,0xbf3f5cb5,0xbedae880,0xbf676bd8
.long 0xbf0e39da,0xbf54db31,0xbe94a031,0xbf74fa0b,0xbedf7108,0xbf6655e7,0xbe164083,0xbf7d3aac
.long 0x3f800000,0x0,0x3f800000,0x0,0x3f7cd925,0x3e20305b,0x3f7c7160,0x3e2a1c3f
.long 0x3f737871,0x3e9e377a,0x3f71decf,0x3ea7bf25,0x3f641901,0x3ee87171,0x3f609384,0x3ef5c6c5
.long 0x3f4f1bbd,0x3f167918,0x3f490a88,0x3f1e7cf1,0x3f3504f3,0x3f3504f3,0x3f2beb4a,0x3f3daef9
.long 0x3f167918,0x3f4f1bbd,0x3f0a04f8,0x3f579b8c,0x3ee87171,0x3f641901,0x3ec8917e,0x3f6b8a3d
.long 0x3e9e377a,0x3f737871,0x3e6f0c4d,0x3f78ed3c,0x3e20305b,0x3f7cd925,0x3d8ca1f2,0x3f7f654e
.long 0x0,0x3f800000,0xbdc8bd36,0x3f7ec46d,0xbe20305b,0x3f7cd925,0xbe862210,0x3f770f11
.long 0xbe9e377a,0x3f737871,0xbed65a92,0x3f687c12,0xbee87171,0x3f641901,0xbf104f0e,0x3f53731f
.long 0xbf167918,0x3f4f1bbd,0xbf316e2c,0x3f3889dc,0xbf3504f3,0x3f3504f3,0xbf4d9f02,0x3f187fc0
.long 0x3f800000,0x0,0x3f800000,0x0,0x3f7c0361,0x3e3403f1,0x3f7b8f2a,0x3e3de731
.long 0x3f702d4f,0x3eb13641,0x3f6e641a,0x3eba9be1,0x3f5cdc29,0x3f0172c3,0x3f58f3c4,0x3f07e565
.long 0x3f42a9f7,0x3f26423a,0x3f3bfc8f,0x3f2dc5e3,0x3f226799,0x3f45e403,0x3f187fc0,0x3f4d9f02
.long 0x3efa2c90,0x3f5f5be6,0x3edf7108,0x3f6655e7,0x3ea7bf25,0x3f71decf,0x3e862210,0x3f770f11
.long 0x3e20305b,0x3f7cd925,0x3da0af2a,0x3f7f35f9,0xbca0d6d6,0x3f7ff35e,0xbddcbd0d,0x3f7e8238
.long 0xbe47c5c2,0x3f7b14be,0xbe94a031,0x3f74fa0b,0xbeba9be1,0x3f6e641a,0xbeece91a,0x3f62f219
.long 0xbf05c277,0x3f5a46a0,0xbf1e7cf1,0x3f490a88,0xbf2a0c73,0x3f3f5cb5,0xbf4105b8,0x3f28296a
.long 0xbf490a88,0x3f1e7cf1,0xbf5cdc29,0x3f0172c3,0xbf61c598,0x3ef15aea,0xbf710908,0x3eac7cd4
.long 0x3f800000,0x0,0x3f800000,0x0,0x3f7b14be,0x3e47c5c2,0x3f7a9421,0x3e519f65
.long 0x3f6c835e,0x3ec3ef15,0x3f6a8b4b,0x3ecd2ef3,0x3f54db31,0x3f0e39da,0x3f50935b,0x3f146eba
.long 0x3f3504f3,0x3f3504f3,0x3f2dc5e3,0x3f3bfc8f,0x3f0e39da,0x3f54db31,0x3f039c3d,0x3f5b941a
.long 0x3ec3ef15,0x3f6c835e,0x3ea7bf25,0x3f71decf,0x3e47c5c2,0x3f7b14be,0x3e0255f4,0x3f7deafa
.long 0x0,0x3f800000,0xbda0af2a,0x3f7f35f9,0xbe47c5c2,0x3f7b14be,0xbe8fcefe,0x3f75b1c9
.long 0xbec3ef15,0x3f6c835e,0xbef15aea,0x3f61c598,0xbf0e39da,0x3f54db31,0xbf2456f1,0x3f444969
.long 0xbf3504f3,0x3f3504f3,0xbf490a88,0x3f1e7cf1,0xbf54db31,0x3f0e39da,0xbf653a48,0x3ee3f40d
.long 0xbf6c835e,0x3ec3ef15,0xbf77b493,0x3e814693,0xbf7b14be,0x3e47c5c2,0xbf7fb10f,0x3d48fb30
.long 0x3f800000,0x0,0x3f800000,0x0,0x3f7a0d54,0x3e5b73dc,0x3f79805c,0x3e6542e9
.long 0x3f687c12,0x3ed65a92,0x3f6655e7,0x3edf7108,0x3f4c1d35,0x3f1a82a4,0x3f4779bc,0x3f207440
.long 0x3f26423a,0x3f42a9f7,0x3f1e7cf1,0x3f490a88,0x3ef15aea,0x3f61c598,0x3edae880,0x3f676bd8
.long 0x3e8afa3e,0x3f766377,0x3e5b73dc,0x3f7a0d54,0x3d712283,0x3f7f8e56,0xbc20d8d2,0x3f7ffcd7
.long 0xbe20305b,0x3f7cd925,0xbe6f0c4d,0x3f78ed3c,0xbeba9be1,0x3f6e641a,0xbee3f40d,0x3f653a48
.long 0xbf0e39da,0x3f54db31,0xbf226799,0x3f45e403,0xbf3889dc,0x3f316e2c,0xbf4a965e,0x3f1c81b9
.long 0xbf5a46a0,0x3f05c277,0xbf687c12,0x3ed65a92,0xbf71decf,0x3ea7bf25,0xbf7a9421,0x3e519f65
.long 0xbf7e39bc,0x3df0b772,0xbf7ff35e,0xbca0d6d6,0xbf7ec46d,0xbdc8bd36,0xbf7853f8,0xbe78cfcc
.long 0xbf4f1bbd,0x3f167918,0xbf641901,0x3ee87171,0xbf641901,0x3ee87171,0xbf743c41,0x3e996dba
.long 0xbf737871,0x3e9e377a,0xbf7d95f4,0x3e0c4cf7,0xbf7cd925,0x3e20305b,0xbf7fe394,0xbcf13d4c
.long 0xbf800000,0x0,0xbf7b14be,0xbe47c5c2,0xbf7cd925,0xbe20305b,0xbf6f4ba8,0xbeb5eb4f
.long 0xbf737871,0xbe9e377a,0xbf5cdc29,0xbf0172c3,0xbf641901,0xbee87171,0xbf444969,0xbf2456f1
.long 0xbf4f1bbd,0xbf167918,0xbf26423a,0xbf42a9f7,0xbf3504f3,0xbf3504f3,0xbf039c3d,0xbf5b941a
.long 0xbf167918,0xbf4f1bbd,0xbeba9be1,0xbf6e641a,0xbee87171,0xbf641901,0xbe519f65,0xbf7a9421
.long 0xbe9e377a,0xbf737871,0xbd20cee7,0xbf7fcd79,0xbe20305b,0xbf7cd925,0x3e0255f4,0xbf7deafa
.long 0x0,0xbf800000,0x3e94a031,0xbf74fa0b,0x3e20305b,0xbf7cd925,0x3ee3f40d,0xbf653a48
.long 0xbf737871,0x3e9e377a,0xbf7cd925,0x3e20305b,0xbf7d95f4,0x3e0c4cf7,0xbf7fe394,0xbcf13d4c
.long 0xbf7fcd79,0xbd20cee7,0xbf7a0d54,0xbe5b73dc,0xbf7a0d54,0xbe5b73dc,0xbf6b8a3d,0xbec8917e
.long 0xbf6c835e,0xbec3ef15,0xbf54db31,0xbf0e39da,0xbf579b8c,0xbf0a04f8,0xbf36c9a9,0xbf333bc6
.long 0xbf3bfc8f,0xbf2dc5e3,0xbf1260b2,0xbf5205d4,0xbf1a82a4,0xbf4c1d35,0xbed1c759,0xbf698690
.long 0xbee87171,0xbf641901,0xbe6f0c4d,0xbf78ed3c,0xbe94a031,0xbf74fa0b,0xbd48fb30,0xbf7fb10f
.long 0xbdf0b772,0xbf7e39bc,0x3e0c4cf7,0xbf7d95f4,0x3d712283,0xbf7f8e56,0x3ea2fd52,0xbf72ae9e
.long 0x3e6f0c4d,0xbf78ed3c,0x3efa2c90,0xbf5f5be6,0x3ecd2ef3,0xbf6a8b4b,0x3f2456f1,0xbf444969
.long 0x3f0e39da,0xbf54db31,0x3f45e403,0xbf226799,0x3f316e2c,0xbf3889dc,0x3f609384,0xbef5c6c5
.long 0xbf800000,0x0,0xbf7cd925,0xbe20305b,0xbf7b14be,0xbe47c5c2,0xbf6f4ba8,0xbeb5eb4f
.long 0xbf6c835e,0xbec3ef15,0xbf579b8c,0xbf0a04f8,0xbf54db31,0xbf0e39da,0xbf36c9a9,0xbf333bc6
.long 0xbf3504f3,0xbf3504f3,0xbf0e39da,0xbf54db31,0xbf0e39da,0xbf54db31,0xbebf47d7,0xbf6d76aa
.long 0xbec3ef15,0xbf6c835e,0xbe3403f1,0xbf7c0361,0xbe47c5c2,0xbf7b14be,0x3cf13d4c,0xbf7fe394
.long 0x0,0xbf800000,0x3e6f0c4d,0xbf78ed3c,0x3e47c5c2,0xbf7b14be,0x3edae880,0xbf676bd8
.long 0x3ec3ef15,0xbf6c835e,0x3f1a82a4,0xbf4c1d35,0x3f0e39da,0xbf54db31,0x3f4105b8,0xbf28296a
.long 0x3f3504f3,0xbf3504f3,0x3f5f5be6,0xbefa2c90,0x3f54db31,0xbf0e39da,0x3f743c41,0xbe996dba
.long 0x3f6c835e,0xbec3ef15,0x3f7ec46d,0xbdc8bd36,0x3f7b14be,0xbe47c5c2,0x3f7e8238,0x3ddcbd0d
.long 0xbf737871,0xbe9e377a,0xbf641901,0xbee87171,0xbf5cdc29,0xbf0172c3,0xbf444969,0xbf2456f1
.long 0xbf3bfc8f,0xbf2dc5e3,0xbf1a82a4,0xbf4c1d35,0xbf1260b2,0xbf5205d4,0xbed1c759,0xbf698690
.long 0xbec3ef15,0xbf6c835e,0xbe47c5c2,0xbf7b14be,0xbe3403f1,0xbf7c0361,0x3cf13d4c,0xbf7fe394
.long 0x3d20cee7,0xbf7fcd79,0x3e814693,0xbf77b493,0x3e814693,0xbf77b493,0x3eece91a,0xbf62f219
.long 0x3ee87171,0xbf641901,0x3f26423a,0xbf42a9f7,0x3f226799,0xbf45e403,0x3f4d9f02,0xbf187fc0
.long 0x3f490a88,0xbf1e7cf1,0x3f6a8b4b,0xbecd2ef3,0x3f6655e7,0xbedf7108,0x3f7b8f2a,0xbe3de731
.long 0x3f78ed3c,0xbe6f0c4d,0x3f7fcd79,0x3d20cee7,0x3f7ff35e,0xbca0d6d6,0x3f770f11,0x3e862210
.long 0x3f7b14be,0x3e47c5c2,0x3f61c598,0x3ef15aea,0x3f6a8b4b,0x3ecd2ef3,0x3f4105b8,0x3f28296a
.long 0x3f803f80,0x3f803f80,0x3f803f80,0x3f803f80,0x3f7f3f80,0x3f753f7b,0xbdc90000,0xbe95be48
.long 0x3f7b3f80,0x3f553f6d,0xbf7bbf80,0xbf55bf6d,0x3f753f80,0x3f223f55,0x3e950000,0x3f463f0e
.long 0x3f6d3f80,0x3ec43f35,0x3f6d3f80,0x3ec43f35,0x3f623f80,0x3dc93f0e,0xbef10000,0xbf7fbf55
.long 0x3f553f80,0xbe483ec4,0xbf55bf80,0x3e48bec4,0x3f463f80,0xbef13e48,0x3f220000,0x3f623f7b
.long 0x3f353f80,0xbf350000,0x3f353f80,0xbf350000,0x3f223f80,0xbf62be48,0xbf460000,0xbef1bf7b
.long 0x3f0e3f80,0xbf7bbec4,0xbf0ebf80,0x3f7b3ec4,0x3ef13f80,0xbf7fbf0e,0x3f620000,0xbdc93f55
.long 0x3ec43f80,0xbf6dbf35,0x3ec43f80,0xbf6dbf35,0x3e953f80,0xbf46bf55,0xbf750000,0x3f22bf0e
.long 0x3e483f80,0xbf0ebf6d,0xbe48bf80,0x3f0e3f6d,0x3dc93f80,0xbe95bf7b,0x3f7f0000,0xbf753e48
.long 0x3f803f80,0x3f803f80,0x3f803f80,0x3f803f80,0x3f623f6d,0x3f463f55,0xbef1bec4,0xbf22bf0e
.long 0x3f0e3f35,0x3e483ec4,0xbf0ebf35,0xbe48bec4,0x3dc93ec4,0xbef1be48,0x3f7f3f6d,0x3f623f7b
.long 0xbec40000,0xbf6dbf35,0xbec40000,0xbf6dbf35,0xbf46bec4,0xbf75bf7b,0xbf22bf6d,0x3e95be48
.long 0xbf7bbf35,0xbf0ebf6d,0x3f7b3f35,0x3f0e3f6d,0xbf75bf6d,0x3dc9bf0e,0xbe953ec4,0xbf7fbf55
.long 0xbf35bf80,0x3f350000,0xbf35bf80,0x3f350000,0xbe95bf6d,0x3f7f3f0e,0x3f753ec4,0x3dc93f55
.long 0x3e48bf35,0x3f553f6d,0xbe483f35,0xbf55bf6d,0x3f22bec4,0x3e953f7b,0xbf46bf6d,0x3f753e48
.long 0x3f6d0000,0xbec43f35,0x3f6d0000,0xbec43f35,0x3f7f3ec4,0xbf623e48,0xbdc93f6d,0xbef1bf7b
.long 0x3f553f35,0xbf7bbec4,0xbf55bf35,0x3f7b3ec4,0x3ef13f6d,0xbf22bf55,0x3f62bec4,0xbf463f0e
.long 0x3f803f80,0x3f803f80,0x3f803f80,0x3f803f80,0x3f223f35,0x3ef13f0e,0xbf46bf35,0xbf62bf55
.long 0xbe480000,0xbf0ebec4,0x3e480000,0x3f0e3ec4,0xbf62bf35,0xbf7fbf7b,0x3ef13f35,0xbdc93e48
.long 0xbf6dbf80,0xbec4bf35,0xbf6dbf80,0xbec4bf35,0xbe95bf35,0x3f223e48,0x3f753f35,0x3f463f7b
.long 0x3f0e0000,0x3f7b3f6d,0xbf0e0000,0xbf7bbf6d,0x3f7f3f35,0x3e953f55,0xbdc9bf35,0x3f753f0e
.long 0x3f353f80,0xbf350000,0x3f353f80,0xbf350000,0xbdc93f35,0xbf75bf55,0xbf7fbf35,0x3e95bf0e
.long 0xbf550000,0xbe48bf6d,0x3f550000,0x3e483f6d,0xbf75bf35,0x3f46be48,0xbe953f35,0xbf22bf7b
.long 0xbec4bf80,0x3f6d3f35,0xbec4bf80,0x3f6d3f35,0x3ef1bf35,0x3dc93f7b,0x3f623f35,0xbf7fbe48
.long 0x3f7b0000,0xbf553ec4,0xbf7b0000,0x3f55bec4,0x3f463f35,0xbf62bf0e,0x3f22bf35,0xbef13f55
.long 0x3f803f80,0x3f803f80,0x3f803f80,0x3f803f80,0x3e953ec4,0x3dc93e48,0xbf75bf6d,0xbf7fbf7b
.long 0xbf55bf35,0xbf7bbf6d,0x3f553f35,0x3f7b3f6d,0xbf46bf6d,0xbe95bf0e,0xbf22bec4,0xbf75bf55
.long 0x3ec40000,0x3f6d3f35,0x3ec40000,0x3f6d3f35,0x3f7f3f6d,0x3ef13f55,0xbdc93ec4,0xbf62bf0e
.long 0x3e483f35,0xbf55bec4,0xbe48bf35,0x3f553ec4,0xbf62bec4,0xbf22bf7b,0x3ef13f6d,0xbf46be48
.long 0xbf35bf80,0x3f350000,0xbf35bf80,0x3f350000,0x3ef1bec4,0x3f463f7b,0x3f623f6d,0xbf223e48
.long 0x3f7b3f35,0xbf0e3ec4,0xbf7bbf35,0x3f0ebec4,0x3dc93f6d,0xbf62bf55,0x3f7f3ec4,0xbef13f0e
.long 0xbf6d0000,0x3ec4bf35,0xbf6d0000,0x3ec4bf35,0xbf22bf6d,0x3f753f0e,0x3f46bec4,0xbe953f55
.long 0x3f0ebf35,0xbe483f6d,0xbf0e3f35,0x3e48bf6d,0x3f753ec4,0xbf7fbe48,0x3e95bf6d,0xbdc93f7b
.long 0x3f803f80,0x3f803f80,0x3f803f80,0x3f803f80,0xbf7fbf80,0xbf75bf7b,0x3dc90000,0x3e953e48
.long 0x3f7b3f80,0x3f553f6d,0xbf7bbf80,0xbf55bf6d,0xbf75bf80,0xbf22bf55,0xbe950000,0xbf46bf0e
.long 0x3f6d3f80,0x3ec43f35,0x3f6d3f80,0x3ec43f35,0xbf62bf80,0xbdc9bf0e,0x3ef10000,0x3f7f3f55
.long 0x3f553f80,0xbe483ec4,0xbf55bf80,0x3e48bec4,0xbf46bf80,0x3ef1be48,0xbf220000,0xbf62bf7b
.long 0x3f353f80,0xbf350000,0x3f353f80,0xbf350000,0xbf22bf80,0x3f623e48,0x3f460000,0x3ef13f7b
.long 0x3f0e3f80,0xbf7bbec4,0xbf0ebf80,0x3f7b3ec4,0xbef1bf80,0x3f7f3f0e,0xbf620000,0x3dc9bf55
.long 0x3ec43f80,0xbf6dbf35,0x3ec43f80,0xbf6dbf35,0xbe95bf80,0x3f463f55,0x3f750000,0xbf223f0e
.long 0x3e483f80,0xbf0ebf6d,0xbe48bf80,0x3f0e3f6d,0xbdc9bf80,0x3e953f7b,0xbf7f0000,0x3f75be48
.long 0x3f803f80,0x3f803f80,0x3f803f80,0x3f803f80,0xbf62bf6d,0xbf46bf55,0x3ef13ec4,0x3f223f0e
.long 0x3f0e3f35,0x3e483ec4,0xbf0ebf35,0xbe48bec4,0xbdc9bec4,0x3ef13e48,0xbf7fbf6d,0xbf62bf7b
.long 0xbec40000,0xbf6dbf35,0xbec40000,0xbf6dbf35,0x3f463ec4,0x3f753f7b,0x3f223f6d,0xbe953e48
.long 0xbf7bbf35,0xbf0ebf6d,0x3f7b3f35,0x3f0e3f6d,0x3f753f6d,0xbdc93f0e,0x3e95bec4,0x3f7f3f55
.long 0xbf35bf80,0x3f350000,0xbf35bf80,0x3f350000,0x3e953f6d,0xbf7fbf0e,0xbf75bec4,0xbdc9bf55
.long 0x3e48bf35,0x3f553f6d,0xbe483f35,0xbf55bf6d,0xbf223ec4,0xbe95bf7b,0x3f463f6d,0xbf75be48
.long 0x3f6d0000,0xbec43f35,0x3f6d0000,0xbec43f35,0xbf7fbec4,0x3f62be48,0x3dc9bf6d,0x3ef13f7b
.long 0x3f553f35,0xbf7bbec4,0xbf55bf35,0x3f7b3ec4,0xbef1bf6d,0x3f223f55,0xbf623ec4,0x3f46bf0e
.long 0x3f803f80,0x3f803f80,0x3f803f80,0x3f803f80,0xbf22bf35,0xbef1bf0e,0x3f463f35,0x3f623f55
.long 0xbe480000,0xbf0ebec4,0x3e480000,0x3f0e3ec4,0x3f623f35,0x3f7f3f7b,0xbef1bf35,0x3dc9be48
.long 0xbf6dbf80,0xbec4bf35,0xbf6dbf80,0xbec4bf35,0x3e953f35,0xbf22be48,0xbf75bf35,0xbf46bf7b
.long 0x3f0e0000,0x3f7b3f6d,0xbf0e0000,0xbf7bbf6d,0xbf7fbf35,0xbe95bf55,0x3dc93f35,0xbf75bf0e
.long 0x3f353f80,0xbf350000,0x3f353f80,0xbf350000,0x3dc9bf35,0x3f753f55,0x3f7f3f35,0xbe953f0e
.long 0xbf550000,0xbe48bf6d,0x3f550000,0x3e483f6d,0x3f753f35,0xbf463e48,0x3e95bf35,0x3f223f7b
.long 0xbec4bf80,0x3f6d3f35,0xbec4bf80,0x3f6d3f35,0xbef13f35,0xbdc9bf7b,0xbf62bf35,0x3f7f3e48
.long 0x3f7b0000,0xbf553ec4,0xbf7b0000,0x3f55bec4,0xbf46bf35,0x3f623f0e,0xbf223f35,0x3ef1bf55
.long 0x3f803f80,0x3f803f80,0x3f803f80,0x3f803f80,0xbe95bec4,0xbdc9be48,0x3f753f6d,0x3f7f3f7b
.long 0xbf55bf35,0xbf7bbf6d,0x3f553f35,0x3f7b3f6d,0x3f463f6d,0x3e953f0e,0x3f223ec4,0x3f753f55
.long 0x3ec40000,0x3f6d3f35,0x3ec40000,0x3f6d3f35,0xbf7fbf6d,0xbef1bf55,0x3dc9bec4,0x3f623f0e
.long 0x3e483f35,0xbf55bec4,0xbe48bf35,0x3f553ec4,0x3f623ec4,0x3f223f7b,0xbef1bf6d,0x3f463e48
.long 0xbf35bf80,0x3f350000,0xbf35bf80,0x3f350000,0xbef13ec4,0xbf46bf7b,0xbf62bf6d,0x3f22be48
.long 0x3f7b3f35,0xbf0e3ec4,0xbf7bbf35,0x3f0ebec4,0xbdc9bf6d,0x3f623f55,0xbf7fbec4,0x3ef1bf0e
.long 0xbf6d0000,0x3ec4bf35,0xbf6d0000,0x3ec4bf35,0x3f223f6d,0xbf75bf0e,0xbf463ec4,0x3e95bf55
.long 0x3f0ebf35,0xbe483f6d,0xbf0e3f35,0x3e48bf6d,0xbf75bec4,0x3f7f3e48,0xbe953f6d,0x3dc9bf7b
.long 0x3f80,0xbf80,0x3f80,0xbf80,0xbdc93f80,0x3e95bf7b,0xbf7f0000,0x3f753e48
.long 0xbe483f80,0x3f0ebf6d,0x3e48bf80,0xbf0e3f6d,0xbe953f80,0x3f46bf55,0x3f750000,0xbf22bf0e
.long 0xbec43f80,0x3f6dbf35,0xbec43f80,0x3f6dbf35,0xbef13f80,0x3f7fbf0e,0xbf620000,0x3dc93f55
.long 0xbf0e3f80,0x3f7bbec4,0x3f0ebf80,0xbf7b3ec4,0xbf223f80,0x3f62be48,0x3f460000,0x3ef1bf7b
.long 0xbf353f80,0x3f350000,0xbf353f80,0x3f350000,0xbf463f80,0x3ef13e48,0xbf220000,0xbf623f7b
.long 0xbf553f80,0x3e483ec4,0x3f55bf80,0xbe48bec4,0xbf623f80,0xbdc93f0e,0x3ef10000,0x3f7fbf55
.long 0xbf6d3f80,0xbec43f35,0xbf6d3f80,0xbec43f35,0xbf753f80,0xbf223f55,0xbe950000,0xbf463f0e
.long 0xbf7b3f80,0xbf553f6d,0x3f7bbf80,0x3f55bf6d,0xbf7f3f80,0xbf753f7b,0x3dc90000,0x3e95be48
.long 0x3f80,0xbf80,0x3f80,0xbf80,0xbef13f6d,0x3f22bf55,0xbf62bec4,0x3f463f0e
.long 0xbf553f35,0x3f7bbec4,0x3f55bf35,0xbf7b3ec4,0xbf7f3ec4,0x3f623e48,0x3dc93f6d,0x3ef1bf7b
.long 0xbf6d0000,0x3ec43f35,0xbf6d0000,0x3ec43f35,0xbf22bec4,0xbe953f7b,0x3f46bf6d,0xbf753e48
.long 0xbe48bf35,0xbf553f6d,0x3e483f35,0x3f55bf6d,0x3e95bf6d,0xbf7f3f0e,0xbf753ec4,0xbdc93f55
.long 0x3f35bf80,0xbf350000,0x3f35bf80,0xbf350000,0x3f75bf6d,0xbdc9bf0e,0x3e953ec4,0x3f7fbf55
.long 0x3f7bbf35,0x3f0ebf6d,0xbf7b3f35,0xbf0e3f6d,0x3f46bec4,0x3f75bf7b,0x3f22bf6d,0xbe95be48
.long 0x3ec40000,0x3f6dbf35,0x3ec40000,0x3f6dbf35,0xbdc93ec4,0x3ef1be48,0xbf7f3f6d,0xbf623f7b
.long 0xbf0e3f35,0xbe483ec4,0x3f0ebf35,0x3e48bec4,0xbf623f6d,0xbf463f55,0x3ef1bec4,0x3f22bf0e
.long 0x3f80,0xbf80,0x3f80,0xbf80,0xbf463f35,0x3f62bf0e,0xbf22bf35,0x3ef13f55
.long 0xbf7b0000,0x3f553ec4,0x3f7b0000,0xbf55bec4,0xbef1bf35,0xbdc93f7b,0xbf623f35,0x3f7fbe48
.long 0x3ec4bf80,0xbf6d3f35,0x3ec4bf80,0xbf6d3f35,0x3f75bf35,0xbf46be48,0x3e953f35,0x3f22bf7b
.long 0x3f550000,0x3e48bf6d,0xbf550000,0xbe483f6d,0x3dc93f35,0x3f75bf55,0x3f7fbf35,0xbe95bf0e
.long 0xbf353f80,0x3f350000,0xbf353f80,0x3f350000,0xbf7f3f35,0xbe953f55,0x3dc9bf35,0xbf753f0e
.long 0xbf0e0000,0xbf7b3f6d,0x3f0e0000,0x3f7bbf6d,0x3e95bf35,0xbf223e48,0xbf753f35,0xbf463f7b
.long 0x3f6dbf80,0x3ec4bf35,0x3f6dbf80,0x3ec4bf35,0x3f62bf35,0x3f7fbf7b,0xbef13f35,0x3dc93e48
.long 0x3e480000,0x3f0ebec4,0xbe480000,0xbf0e3ec4,0xbf223f35,0xbef13f0e,0x3f46bf35,0x3f62bf55
.long 0x3f80,0xbf80,0x3f80,0xbf80,0xbf753ec4,0x3f7fbe48,0xbe95bf6d,0x3dc93f7b
.long 0xbf0ebf35,0x3e483f6d,0x3f0e3f35,0xbe48bf6d,0x3f22bf6d,0xbf753f0e,0xbf46bec4,0x3e953f55
.long 0x3f6d0000,0xbec4bf35,0x3f6d0000,0xbec4bf35,0xbdc93f6d,0x3f62bf55,0xbf7f3ec4,0x3ef13f0e
.long 0xbf7b3f35,0x3f0e3ec4,0x3f7bbf35,0xbf0ebec4,0xbef1bec4,0xbf463f7b,0xbf623f6d,0x3f223e48
.long 0x3f35bf80,0xbf350000,0x3f35bf80,0xbf350000,0x3f62bec4,0x3f22bf7b,0xbef13f6d,0x3f46be48
.long 0xbe483f35,0x3f55bec4,0x3e48bf35,0xbf553ec4,0xbf7f3f6d,0xbef13f55,0x3dc93ec4,0x3f62bf0e
.long 0xbec40000,0xbf6d3f35,0xbec40000,0xbf6d3f35,0x3f46bf6d,0x3e95bf0e,0x3f22bec4,0x3f75bf55
.long 0x3f55bf35,0x3f7bbf6d,0xbf553f35,0xbf7b3f6d,0xbe953ec4,0xbdc93e48,0x3f75bf6d,0x3f7fbf7b
.long 0x3f80,0xbf80,0x3f80,0xbf80,0x3dc9bf80,0xbe953f7b,0x3f7f0000,0xbf75be48
.long 0xbe483f80,0x3f0ebf6d,0x3e48bf80,0xbf0e3f6d,0x3e95bf80,0xbf463f55,0xbf750000,0x3f223f0e
.long 0xbec43f80,0x3f6dbf35,0xbec43f80,0x3f6dbf35,0x3ef1bf80,0xbf7f3f0e,0x3f620000,0xbdc9bf55
.long 0xbf0e3f80,0x3f7bbec4,0x3f0ebf80,0xbf7b3ec4,0x3f22bf80,0xbf623e48,0xbf460000,0xbef13f7b
.long 0xbf353f80,0x3f350000,0xbf353f80,0x3f350000,0x3f46bf80,0xbef1be48,0x3f220000,0x3f62bf7b
.long 0xbf553f80,0x3e483ec4,0x3f55bf80,0xbe48bec4,0x3f62bf80,0x3dc9bf0e,0xbef10000,0xbf7f3f55
.long 0xbf6d3f80,0xbec43f35,0xbf6d3f80,0xbec43f35,0x3f75bf80,0x3f22bf55,0x3e950000,0x3f46bf0e
.long 0xbf7b3f80,0xbf553f6d,0x3f7bbf80,0x3f55bf6d,0x3f7fbf80,0x3f75bf7b,0xbdc90000,0xbe953e48
.long 0x3f80,0xbf80,0x3f80,0xbf80,0x3ef1bf6d,0xbf223f55,0x3f623ec4,0xbf46bf0e
.long 0xbf553f35,0x3f7bbec4,0x3f55bf35,0xbf7b3ec4,0x3f7fbec4,0xbf62be48,0xbdc9bf6d,0xbef13f7b
.long 0xbf6d0000,0x3ec43f35,0xbf6d0000,0x3ec43f35,0x3f223ec4,0x3e95bf7b,0xbf463f6d,0x3f75be48
.long 0xbe48bf35,0xbf553f6d,0x3e483f35,0x3f55bf6d,0xbe953f6d,0x3f7fbf0e,0x3f75bec4,0x3dc9bf55
.long 0x3f35bf80,0xbf350000,0x3f35bf80,0xbf350000,0xbf753f6d,0x3dc93f0e,0xbe95bec4,0xbf7f3f55
.long 0x3f7bbf35,0x3f0ebf6d,0xbf7b3f35,0xbf0e3f6d,0xbf463ec4,0xbf753f7b,0xbf223f6d,0x3e953e48
.long 0x3ec40000,0x3f6dbf35,0x3ec40000,0x3f6dbf35,0x3dc9bec4,0xbef13e48,0x3f7fbf6d,0x3f62bf7b
.long 0xbf0e3f35,0xbe483ec4,0x3f0ebf35,0x3e48bec4,0x3f62bf6d,0x3f46bf55,0xbef13ec4,0xbf223f0e
.long 0x3f80,0xbf80,0x3f80,0xbf80,0x3f46bf35,0xbf623f0e,0x3f223f35,0xbef1bf55
.long 0xbf7b0000,0x3f553ec4,0x3f7b0000,0xbf55bec4,0x3ef13f35,0x3dc9bf7b,0x3f62bf35,0xbf7f3e48
.long 0x3ec4bf80,0xbf6d3f35,0x3ec4bf80,0xbf6d3f35,0xbf753f35,0x3f463e48,0xbe95bf35,0xbf223f7b
.long 0x3f550000,0x3e48bf6d,0xbf550000,0xbe483f6d,0xbdc9bf35,0xbf753f55,0xbf7f3f35,0x3e953f0e
.long 0xbf353f80,0x3f350000,0xbf353f80,0x3f350000,0x3f7fbf35,0x3e95bf55,0xbdc93f35,0x3f75bf0e
.long 0xbf0e0000,0xbf7b3f6d,0x3f0e0000,0x3f7bbf6d,0xbe953f35,0x3f22be48,0x3f75bf35,0x3f46bf7b
.long 0x3f6dbf80,0x3ec4bf35,0x3f6dbf80,0x3ec4bf35,0xbf623f35,0xbf7f3f7b,0x3ef1bf35,0xbdc9be48
.long 0x3e480000,0x3f0ebec4,0xbe480000,0xbf0e3ec4,0x3f22bf35,0x3ef1bf0e,0xbf463f35,0xbf623f55
.long 0x3f80,0xbf80,0x3f80,0xbf80,0x3f75bec4,0xbf7f3e48,0x3e953f6d,0xbdc9bf7b
.long 0xbf0ebf35,0x3e483f6d,0x3f0e3f35,0xbe48bf6d,0xbf223f6d,0x3f75bf0e,0x3f463ec4,0xbe95bf55
.long 0x3f6d0000,0xbec4bf35,0x3f6d0000,0xbec4bf35,0x3dc9bf6d,0xbf623f55,0x3f7fbec4,0xbef1bf0e
.long 0xbf7b3f35,0x3f0e3ec4,0x3f7bbf35,0xbf0ebec4,0x3ef13ec4,0x3f46bf7b,0x3f62bf6d,0xbf22be48
.long 0x3f35bf80,0xbf350000,0x3f35bf80,0xbf350000,0xbf623ec4,0xbf223f7b,0x3ef1bf6d,0xbf463e48
.long 0xbe483f35,0x3f55bec4,0x3e48bf35,0xbf553ec4,0x3f7fbf6d,0x3ef1bf55,0xbdc9bec4,0xbf623f0e
.long 0xbec40000,0xbf6d3f35,0xbec40000,0xbf6d3f35,0xbf463f6d,0xbe953f0e,0xbf223ec4,0xbf753f55
.long 0x3f55bf35,0x3f7bbf6d,0xbf553f35,0xbf7b3f6d,0x3e95bec4,0x3dc9be48,0xbf753f6d,0xbf7f3f7b
.long 0xbf803f80,0xbf803f80,0xbf803f80,0xbf803f80,0xbdc90000,0xbe95be48,0xbf7fbf80,0xbf75bf7b
.long 0xbe480000,0xbf0ebec4,0x3e480000,0x3f0e3ec4,0xbe950000,0xbf46bf0e,0x3f753f80,0x3f223f55
.long 0xbec40000,0xbf6dbf35,0xbec40000,0xbf6dbf35,0xbef10000,0xbf7fbf55,0xbf62bf80,0xbdc9bf0e
.long 0xbf0e0000,0xbf7bbf6d,0x3f0e0000,0x3f7b3f6d,0xbf220000,0xbf62bf7b,0x3f463f80,0xbef13e48
.long 0xbf350000,0xbf35bf80,0xbf350000,0xbf35bf80,0xbf460000,0xbef1bf7b,0xbf22bf80,0x3f623e48
.long 0xbf550000,0xbe48bf6d,0x3f550000,0x3e483f6d,0xbf620000,0x3dc9bf55,0x3ef13f80,0xbf7fbf0e
.long 0xbf6d0000,0x3ec4bf35,0xbf6d0000,0x3ec4bf35,0xbf750000,0x3f22bf0e,0xbe95bf80,0x3f463f55
.long 0xbf7b0000,0x3f55bec4,0x3f7b0000,0xbf553ec4,0xbf7f0000,0x3f75be48,0x3dc93f80,0xbe95bf7b
.long 0xbf803f80,0xbf803f80,0xbf803f80,0xbf803f80,0xbef1bec4,0xbf22bf0e,0xbf62bf6d,0xbf46bf55
.long 0xbf55bf35,0xbf7bbf6d,0x3f553f35,0x3f7b3f6d,0xbf7fbf6d,0xbf62bf7b,0x3dc93ec4,0xbef1be48
.long 0xbf6dbf80,0xbec4bf35,0xbf6dbf80,0xbec4bf35,0xbf22bf6d,0x3e95be48,0x3f463ec4,0x3f753f7b
.long 0xbe48bf35,0x3f553ec4,0x3e483f35,0xbf55bec4,0x3e95bec4,0x3f7f3f55,0xbf75bf6d,0x3dc9bf0e
.long 0x3f350000,0x3f353f80,0x3f350000,0x3f353f80,0x3f753ec4,0x3dc93f55,0x3e953f6d,0xbf7fbf0e
.long 0x3f7b3f35,0xbf0e3ec4,0xbf7bbf35,0x3f0ebec4,0x3f463f6d,0xbf75be48,0x3f22bec4,0x3e953f7b
.long 0x3ec43f80,0xbf6dbf35,0x3ec43f80,0xbf6dbf35,0xbdc93f6d,0xbef1bf7b,0xbf7fbec4,0x3f62be48
.long 0xbf0e3f35,0x3e48bf6d,0x3f0ebf35,0xbe483f6d,0xbf623ec4,0x3f46bf0e,0x3ef13f6d,0xbf22bf55
.long 0xbf803f80,0xbf803f80,0xbf803f80,0xbf803f80,0xbf46bf35,0xbf62bf55,0xbf22bf35,0xbef1bf0e
.long 0xbf7bbf80,0xbf55bf6d,0x3f7b3f80,0x3f553f6d,0xbef1bf35,0x3dc9be48,0xbf62bf35,0xbf7fbf7b
.long 0x3ec40000,0x3f6d3f35,0x3ec40000,0x3f6d3f35,0x3f753f35,0x3f463f7b,0x3e953f35,0xbf22be48
.long 0x3f553f80,0xbe483ec4,0xbf55bf80,0x3e48bec4,0x3dc93f35,0xbf75bf0e,0x3f7f3f35,0x3e953f55
.long 0xbf350000,0xbf35bf80,0xbf350000,0xbf35bf80,0xbf7fbf35,0x3e95bf0e,0x3dc9bf35,0x3f753f55
.long 0xbf0ebf80,0x3f7b3ec4,0x3f0e3f80,0xbf7bbec4,0x3e95bf35,0x3f223f7b,0xbf75bf35,0x3f46be48
.long 0x3f6d0000,0xbec43f35,0x3f6d0000,0xbec43f35,0x3f623f35,0xbf7fbe48,0xbef13f35,0xbdc9bf7b
.long 0x3e483f80,0xbf0ebf6d,0xbe48bf80,0x3f0e3f6d,0xbf223f35,0x3ef1bf55,0x3f463f35,0xbf62bf0e
.long 0xbf803f80,0xbf803f80,0xbf803f80,0xbf803f80,0xbf75bf6d,0xbf7fbf7b,0xbe95bec4,0xbdc9be48
.long 0xbf0ebf35,0xbe48bec4,0x3f0e3f35,0x3e483ec4,0x3f223ec4,0x3f753f55,0xbf46bf6d,0xbe95bf0e
.long 0x3f6d3f80,0x3ec43f35,0x3f6d3f80,0x3ec43f35,0xbdc93ec4,0xbf62bf0e,0xbf7fbf6d,0xbef1bf55
.long 0xbf7bbf35,0xbf0ebf6d,0x3f7b3f35,0x3f0e3f6d,0xbef1bf6d,0x3f463e48,0xbf62bec4,0xbf22bf7b
.long 0x3f350000,0x3f353f80,0x3f350000,0x3f353f80,0x3f623f6d,0xbf223e48,0xbef13ec4,0xbf46bf7b
.long 0xbe483f35,0xbf55bf6d,0x3e48bf35,0x3f553f6d,0xbf7fbec4,0x3ef1bf0e,0x3dc93f6d,0xbf62bf55
.long 0xbec4bf80,0x3f6d3f35,0xbec4bf80,0x3f6d3f35,0x3f46bec4,0xbe953f55,0x3f223f6d,0xbf75bf0e
.long 0x3f553f35,0xbf7bbec4,0xbf55bf35,0x3f7b3ec4,0xbe953f6d,0x3dc9bf7b,0x3f753ec4,0xbf7fbe48
.long 0xbf803f80,0xbf803f80,0xbf803f80,0xbf803f80,0x3dc90000,0x3e953e48,0x3f7f3f80,0x3f753f7b
.long 0xbe480000,0xbf0ebec4,0x3e480000,0x3f0e3ec4,0x3e950000,0x3f463f0e,0xbf75bf80,0xbf22bf55
.long 0xbec40000,0xbf6dbf35,0xbec40000,0xbf6dbf35,0x3ef10000,0x3f7f3f55,0x3f623f80,0x3dc93f0e
.long 0xbf0e0000,0xbf7bbf6d,0x3f0e0000,0x3f7b3f6d,0x3f220000,0x3f623f7b,0xbf46bf80,0x3ef1be48
.long 0xbf350000,0xbf35bf80,0xbf350000,0xbf35bf80,0x3f460000,0x3ef13f7b,0x3f223f80,0xbf62be48
.long 0xbf550000,0xbe48bf6d,0x3f550000,0x3e483f6d,0x3f620000,0xbdc93f55,0xbef1bf80,0x3f7f3f0e
.long 0xbf6d0000,0x3ec4bf35,0xbf6d0000,0x3ec4bf35,0x3f750000,0xbf223f0e,0x3e953f80,0xbf46bf55
.long 0xbf7b0000,0x3f55bec4,0x3f7b0000,0xbf553ec4,0x3f7f0000,0xbf753e48,0xbdc9bf80,0x3e953f7b
.long 0xbf803f80,0xbf803f80,0xbf803f80,0xbf803f80,0x3ef13ec4,0x3f223f0e,0x3f623f6d,0x3f463f55
.long 0xbf55bf35,0xbf7bbf6d,0x3f553f35,0x3f7b3f6d,0x3f7f3f6d,0x3f623f7b,0xbdc9bec4,0x3ef13e48
.long 0xbf6dbf80,0xbec4bf35,0xbf6dbf80,0xbec4bf35,0x3f223f6d,0xbe953e48,0xbf46bec4,0xbf75bf7b
.long 0xbe48bf35,0x3f553ec4,0x3e483f35,0xbf55bec4,0xbe953ec4,0xbf7fbf55,0x3f753f6d,0xbdc93f0e
.long 0x3f350000,0x3f353f80,0x3f350000,0x3f353f80,0xbf75bec4,0xbdc9bf55,0xbe95bf6d,0x3f7f3f0e
.long 0x3f7b3f35,0xbf0e3ec4,0xbf7bbf35,0x3f0ebec4,0xbf46bf6d,0x3f753e48,0xbf223ec4,0xbe95bf7b
.long 0x3ec43f80,0xbf6dbf35,0x3ec43f80,0xbf6dbf35,0x3dc9bf6d,0x3ef13f7b,0x3f7f3ec4,0xbf623e48
.long 0xbf0e3f35,0x3e48bf6d,0x3f0ebf35,0xbe483f6d,0x3f62bec4,0xbf463f0e,0xbef1bf6d,0x3f223f55
.long 0xbf803f80,0xbf803f80,0xbf803f80,0xbf803f80,0x3f463f35,0x3f623f55,0x3f223f35,0x3ef13f0e
.long 0xbf7bbf80,0xbf55bf6d,0x3f7b3f80,0x3f553f6d,0x3ef13f35,0xbdc93e48,0x3f623f35,0x3f7f3f7b
.long 0x3ec40000,0x3f6d3f35,0x3ec40000,0x3f6d3f35,0xbf75bf35,0xbf46bf7b,0xbe95bf35,0x3f223e48
.long 0x3f553f80,0xbe483ec4,0xbf55bf80,0x3e48bec4,0xbdc9bf35,0x3f753f0e,0xbf7fbf35,0xbe95bf55
.long 0xbf350000,0xbf35bf80,0xbf350000,0xbf35bf80,0x3f7f3f35,0xbe953f0e,0xbdc93f35,0xbf75bf55
.long 0xbf0ebf80,0x3f7b3ec4,0x3f0e3f80,0xbf7bbec4,0xbe953f35,0xbf22bf7b,0x3f753f35,0xbf463e48
.long 0x3f6d0000,0xbec43f35,0x3f6d0000,0xbec43f35,0xbf62bf35,0x3f7f3e48,0x3ef1bf35,0x3dc93f7b
.long 0x3e483f80,0xbf0ebf6d,0xbe48bf80,0x3f0e3f6d,0x3f22bf35,0xbef13f55,0xbf46bf35,0x3f623f0e
.long 0xbf803f80,0xbf803f80,0xbf803f80,0xbf803f80,0x3f753f6d,0x3f7f3f7b,0x3e953ec4,0x3dc93e48
.long 0xbf0ebf35,0xbe48bec4,0x3f0e3f35,0x3e483ec4,0xbf22bec4,0xbf75bf55,0x3f463f6d,0x3e953f0e
.long 0x3f6d3f80,0x3ec43f35,0x3f6d3f80,0x3ec43f35,0x3dc9bec4,0x3f623f0e,0x3f7f3f6d,0x3ef13f55
.long 0xbf7bbf35,0xbf0ebf6d,0x3f7b3f35,0x3f0e3f6d,0x3ef13f6d,0xbf46be48,0x3f623ec4,0x3f223f7b
.long 0x3f350000,0x3f353f80,0x3f350000,0x3f353f80,0xbf62bf6d,0x3f22be48,0x3ef1bec4,0x3f463f7b
.long 0xbe483f35,0xbf55bf6d,0x3e48bf35,0x3f553f6d,0x3f7f3ec4,0xbef13f0e,0xbdc9bf6d,0x3f623f55
.long 0xbec4bf80,0x3f6d3f35,0xbec4bf80,0x3f6d3f35,0xbf463ec4,0x3e95bf55,0xbf22bf6d,0x3f753f0e
.long 0x3f553f35,0xbf7bbec4,0xbf55bf35,0x3f7b3ec4,0x3e95bf6d,0xbdc93f7b,0xbf75bec4,0x3f7f3e48
.long 0xbf800000,0x3f800000,0xbf800000,0x3f800000,0xbf7f0000,0x3f753e48,0x3dc9bf80,0xbe953f7b
.long 0xbf7b0000,0x3f553ec4,0x3f7b0000,0xbf55bec4,0xbf750000,0x3f223f0e,0xbe953f80,0x3f46bf55
.long 0xbf6d0000,0x3ec43f35,0xbf6d0000,0x3ec43f35,0xbf620000,0x3dc93f55,0x3ef1bf80,0xbf7f3f0e
.long 0xbf550000,0xbe483f6d,0x3f550000,0x3e48bf6d,0xbf460000,0xbef13f7b,0xbf223f80,0x3f62be48
.long 0xbf350000,0xbf353f80,0xbf350000,0xbf353f80,0xbf220000,0xbf623f7b,0x3f46bf80,0xbef1be48
.long 0xbf0e0000,0xbf7b3f6d,0x3f0e0000,0x3f7bbf6d,0xbef10000,0xbf7f3f55,0xbf623f80,0xbdc93f0e
.long 0xbec40000,0xbf6d3f35,0xbec40000,0xbf6d3f35,0xbe950000,0xbf463f0e,0x3f75bf80,0x3f22bf55
.long 0xbe480000,0xbf0e3ec4,0x3e480000,0x3f0ebec4,0xbdc90000,0xbe953e48,0xbf7f3f80,0xbf753f7b
.long 0xbf800000,0x3f800000,0xbf800000,0x3f800000,0xbf62bec4,0x3f463f0e,0x3ef1bf6d,0xbf223f55
.long 0xbf0ebf35,0x3e483f6d,0x3f0e3f35,0xbe48bf6d,0xbdc9bf6d,0xbef13f7b,0xbf7f3ec4,0x3f623e48
.long 0x3ec4bf80,0xbf6d3f35,0x3ec4bf80,0xbf6d3f35,0x3f46bf6d,0xbf753e48,0x3f223ec4,0x3e95bf7b
.long 0x3f7bbf35,0xbf0ebec4,0xbf7b3f35,0x3f0e3ec4,0x3f75bec4,0x3dc9bf55,0x3e95bf6d,0xbf7f3f0e
.long 0x3f350000,0x3f35bf80,0x3f350000,0x3f35bf80,0x3e953ec4,0x3f7fbf55,0xbf753f6d,0x3dc93f0e
.long 0xbe483f35,0x3f55bec4,0x3e48bf35,0xbf553ec4,0xbf223f6d,0x3e953e48,0x3f46bec4,0x3f75bf7b
.long 0xbf6d3f80,0xbec43f35,0xbf6d3f80,0xbec43f35,0xbf7f3f6d,0xbf623f7b,0x3dc9bec4,0xbef13e48
.long 0xbf553f35,0xbf7b3f6d,0x3f55bf35,0x3f7bbf6d,0xbef13ec4,0xbf223f0e,0xbf623f6d,0xbf463f55
.long 0xbf800000,0x3f800000,0xbf800000,0x3f800000,0xbf22bf35,0x3ef13f55,0x3f46bf35,0xbf623f0e
.long 0x3e48bf80,0xbf0e3f6d,0xbe483f80,0x3f0ebf6d,0x3f62bf35,0xbf7f3e48,0xbef1bf35,0xbdc93f7b
.long 0x3f6d0000,0xbec4bf35,0x3f6d0000,0xbec4bf35,0x3e953f35,0x3f22bf7b,0xbf753f35,0x3f463e48
.long 0xbf0e3f80,0x3f7bbec4,0x3f0ebf80,0xbf7b3ec4,0xbf7f3f35,0x3e953f0e,0x3dc93f35,0x3f75bf55
.long 0xbf350000,0xbf353f80,0xbf350000,0xbf353f80,0x3dc9bf35,0xbf753f0e,0x3f7fbf35,0x3e95bf55
.long 0x3f55bf80,0xbe48bec4,0xbf553f80,0x3e483ec4,0x3f75bf35,0x3f46bf7b,0x3e95bf35,0xbf223e48
.long 0x3ec40000,0x3f6dbf35,0x3ec40000,0x3f6dbf35,0xbef13f35,0x3dc93e48,0xbf623f35,0xbf7f3f7b
.long 0xbf7b3f80,0xbf553f6d,0x3f7bbf80,0x3f55bf6d,0xbf463f35,0xbf623f55,0xbf223f35,0xbef13f0e
.long 0xbf800000,0x3f800000,0xbf800000,0x3f800000,0xbe95bf6d,0x3dc93f7b,0x3f75bec4,0xbf7f3e48
.long 0x3f55bf35,0xbf7b3ec4,0xbf553f35,0x3f7bbec4,0x3f463ec4,0xbe95bf55,0x3f22bf6d,0xbf753f0e
.long 0xbec43f80,0x3f6dbf35,0xbec43f80,0x3f6dbf35,0xbf7f3ec4,0x3ef13f0e,0x3dc9bf6d,0xbf623f55
.long 0xbe48bf35,0xbf553f6d,0x3e483f35,0x3f55bf6d,0x3f62bf6d,0xbf22be48,0xbef1bec4,0xbf463f7b
.long 0x3f350000,0x3f35bf80,0x3f350000,0x3f35bf80,0xbef13f6d,0x3f46be48,0xbf623ec4,0xbf223f7b
.long 0xbf7b3f35,0xbf0e3f6d,0x3f7bbf35,0x3f0ebf6d,0xbdc9bec4,0xbf623f0e,0xbf7f3f6d,0xbef13f55
.long 0x3f6dbf80,0x3ec4bf35,0x3f6dbf80,0x3ec4bf35,0x3f22bec4,0x3f75bf55,0xbf463f6d,0xbe953f0e
.long 0xbf0e3f35,0xbe483ec4,0x3f0ebf35,0x3e48bec4,0xbf753f6d,0xbf7f3f7b,0xbe953ec4,0xbdc93e48
.long 0xbf800000,0x3f800000,0xbf800000,0x3f800000,0x3f7f0000,0xbf75be48,0xbdc93f80,0x3e95bf7b
.long 0xbf7b0000,0x3f553ec4,0x3f7b0000,0xbf55bec4,0x3f750000,0xbf22bf0e,0x3e95bf80,0xbf463f55
.long 0xbf6d0000,0x3ec43f35,0xbf6d0000,0x3ec43f35,0x3f620000,0xbdc9bf55,0xbef13f80,0x3f7fbf0e
.long 0xbf550000,0xbe483f6d,0x3f550000,0x3e48bf6d,0x3f460000,0x3ef1bf7b,0x3f22bf80,0xbf623e48
.long 0xbf350000,0xbf353f80,0xbf350000,0xbf353f80,0x3f220000,0x3f62bf7b,0xbf463f80,0x3ef13e48
.long 0xbf0e0000,0xbf7b3f6d,0x3f0e0000,0x3f7bbf6d,0x3ef10000,0x3f7fbf55,0x3f62bf80,0x3dc9bf0e
.long 0xbec40000,0xbf6d3f35,0xbec40000,0xbf6d3f35,0x3e950000,0x3f46bf0e,0xbf753f80,0xbf223f55
.long 0xbe480000,0xbf0e3ec4,0x3e480000,0x3f0ebec4,0x3dc90000,0x3e95be48,0x3f7fbf80,0x3f75bf7b
.long 0xbf800000,0x3f800000,0xbf800000,0x3f800000,0x3f623ec4,0xbf46bf0e,0xbef13f6d,0x3f22bf55
.long 0xbf0ebf35,0x3e483f6d,0x3f0e3f35,0xbe48bf6d,0x3dc93f6d,0x3ef1bf7b,0x3f7fbec4,0xbf62be48
.long 0x3ec4bf80,0xbf6d3f35,0x3ec4bf80,0xbf6d3f35,0xbf463f6d,0x3f75be48,0xbf22bec4,0xbe953f7b
.long 0x3f7bbf35,0xbf0ebec4,0xbf7b3f35,0x3f0e3ec4,0xbf753ec4,0xbdc93f55,0xbe953f6d,0x3f7fbf0e
.long 0x3f350000,0x3f35bf80,0x3f350000,0x3f35bf80,0xbe95bec4,0xbf7f3f55,0x3f75bf6d,0xbdc9bf0e
.long 0xbe483f35,0x3f55bec4,0x3e48bf35,0xbf553ec4,0x3f22bf6d,0xbe95be48,0xbf463ec4,0xbf753f7b
.long 0xbf6d3f80,0xbec43f35,0xbf6d3f80,0xbec43f35,0x3f7fbf6d,0x3f62bf7b,0xbdc93ec4,0x3ef1be48
.long 0xbf553f35,0xbf7b3f6d,0x3f55bf35,0x3f7bbf6d,0x3ef1bec4,0x3f22bf0e,0x3f62bf6d,0x3f46bf55
.long 0xbf800000,0x3f800000,0xbf800000,0x3f800000,0x3f223f35,0xbef1bf55,0xbf463f35,0x3f62bf0e
.long 0x3e48bf80,0xbf0e3f6d,0xbe483f80,0x3f0ebf6d,0xbf623f35,0x3f7fbe48,0x3ef13f35,0x3dc9bf7b
.long 0x3f6d0000,0xbec4bf35,0x3f6d0000,0xbec4bf35,0xbe95bf35,0xbf223f7b,0x3f75bf35,0xbf46be48
.long 0xbf0e3f80,0x3f7bbec4,0x3f0ebf80,0xbf7b3ec4,0x3f7fbf35,0xbe95bf0e,0xbdc9bf35,0xbf753f55
.long 0xbf350000,0xbf353f80,0xbf350000,0xbf353f80,0xbdc93f35,0x3f75bf0e,0xbf7f3f35,0xbe953f55
.long 0x3f55bf80,0xbe48bec4,0xbf553f80,0x3e483ec4,0xbf753f35,0xbf463f7b,0xbe953f35,0x3f22be48
.long 0x3ec40000,0x3f6dbf35,0x3ec40000,0x3f6dbf35,0x3ef1bf35,0xbdc9be48,0x3f62bf35,0x3f7fbf7b
.long 0xbf7b3f80,0xbf553f6d,0x3f7bbf80,0x3f55bf6d,0x3f46bf35,0x3f62bf55,0x3f22bf35,0x3ef1bf0e
.long 0xbf800000,0x3f800000,0xbf800000,0x3f800000,0x3e953f6d,0xbdc9bf7b,0xbf753ec4,0x3f7fbe48
.long 0x3f55bf35,0xbf7b3ec4,0xbf553f35,0x3f7bbec4,0xbf46bec4,0x3e953f55,0xbf223f6d,0x3f75bf0e
.long 0xbec43f80,0x3f6dbf35,0xbec43f80,0x3f6dbf35,0x3f7fbec4,0xbef1bf0e,0xbdc93f6d,0x3f62bf55
.long 0xbe48bf35,0xbf553f6d,0x3e483f35,0x3f55bf6d,0xbf623f6d,0x3f223e48,0x3ef13ec4,0x3f46bf7b
.long 0x3f350000,0x3f35bf80,0x3f350000,0x3f35bf80,0x3ef1bf6d,0xbf463e48,0x3f62bec4,0x3f22bf7b
.long 0xbf7b3f35,0xbf0e3f6d,0x3f7bbf35,0x3f0ebf6d,0x3dc93ec4,0x3f62bf0e,0x3f7fbf6d,0x3ef1bf55
.long 0x3f6dbf80,0x3ec4bf35,0x3f6dbf80,0x3ec4bf35,0xbf223ec4,0xbf753f55,0x3f46bf6d,0x3e95bf0e
.long 0xbf0e3f35,0xbe483ec4,0x3f0ebf35,0x3e48bec4,0x3f75bf6d,0x3f7fbf7b,0x3e95bec4,0x3dc9be48
.size ctab, 24576
code_end:
.section .rodata,"a"
.p2align 6
.amdhsa_kernel kg_kernel
  .amdhsa_next_free_vgpr 512
  .amdhsa_next_free_sgpr 44
  .amdhsa_accum_offset 256
  .amdhsa_group_segment_fixed_size 0
  .amdhsa_kernarg_size 120
  .amdhsa_user_sgpr_count 2
  .amdhsa_user_sgpr_kernarg_segment_ptr 1
  .amdhsa_system_sgpr_workgroup_id_x 1
  .amdhsa_float_denorm_mode_32 3
.end_amdhsa_kernel
```
